```python
import torch

def _softmax(x, axis=-1):
    return torch.softmax(x, dim=axis)
def _gelu(x):
    return torch.nn.functional.gelu(x, approximate="tanh")
def _silu(x):
    return torch.nn.functional.silu(x)
def _sigmoid(x):
    return torch.sigmoid(x)
def _layernorm(x, axis=-1, eps=1e-5):
    m = x.mean(dim=axis, keepdim=True)
    v = x.var(dim=axis, keepdim=True, unbiased=False)
    return (x - m) / torch.sqrt(v + eps)
def _scatter_add(tgt, idx, src, axis=0):
    return tgt.clone().index_add_(axis, idx, src)
def _segment_sum(src, seg, n):
    out = torch.zeros((n,) + src.shape[1:], dtype=src.dtype)
    return out.index_add_(0, seg, src)
def _pad(x, pw):
    flat = tuple(v for pair in reversed(pw) for v in pair)
    return torch.nn.functional.pad(x, flat)

kernel_name = 'standalone__mha_block_cached__near_ridge'

def setup_inputs():

    _w = (lambda a: (lambda t: t.to(torch.bfloat16) if t.is_floating_point() else t)(torch.as_tensor(a)))
    B, Sq, D = 8, 224, 576
    H, Sk, Dh = 32, 512, 128
    return {
        "x": _w((lambda *s: torch.randn(*s, dtype=torch.bfloat16) * 0.8)(B, Sq, D)),
        "k_cache": _w((lambda *s: torch.randn(*s, dtype=torch.bfloat16) * 0.8)(B, H, Sk, Dh)),
        "v_cache": _w((lambda *s: torch.randn(*s, dtype=torch.bfloat16) * 0.05)(B, H, Sk, Dh)),
        "wq": _w((lambda *s: torch.randn(*s, dtype=torch.bfloat16) * 0.8)(D, H * Dh) * (D ** -0.5)),
        "wo": _w((lambda *s: torch.randn(*s, dtype=torch.bfloat16) * 0.05)(H * Dh, D) * ((H * Dh) ** -0.5)),
    }

def reference(x, k_cache, v_cache, wq, wo):
    B, Sq, D = x.shape
    H, Dh = 32, 128
    q = (lambda x, *d: x.permute(*d))((x @ wq).reshape(B, Sq, H, Dh), 0, 2, 1, 3)
    scores = torch.einsum("bhqd,bhkd->bhqk", q, k_cache) * (Dh ** -0.5)
    p = _softmax(scores, axis=-1)
    o = torch.einsum("bhqk,bhkd->bhqd", p, v_cache)
    return (lambda x, *d: x.permute(*d))(o, 0, 2, 1, 3).reshape(B, Sq, H * Dh) @ wo
```

```asm
; @launch grid=(256,1,1) block=(256,1,1) lds=163840
.amdgcn_target "amdgcn-amd-amdhsa--gfx950"
.text
.globl standalone__mha_block_cached__near_ridge_kernel
.p2align 8
.type standalone__mha_block_cached__near_ridge_kernel,@function
standalone__mha_block_cached__near_ridge_kernel:
	s_cmp_ge_u32 s2, 256
	s_cbranch_scc1 L_end
	s_load_dwordx8 s[72:79], s[0:1], 0
	s_getpc_b64 s[70:71]
	v_and_b32 v49, 15, v0
	s_lshr_b32 s65, s2, 3
	v_lshl_add_u32 v49, v49, 5, s65
	v_lshlrev_b32 v49, 7, v49
	global_load_dword v51, v49, s[70:71]
	s_load_dwordx2 s[24:25], s[0:1], 32
	s_load_dwordx2 s[28:29], s[0:1], 40
	s_load_dwordx2 s[32:33], s[0:1], 48
	s_load_dwordx2 s[20:21], s[0:1], 56
	v_and_b32 v1, 63, v0
	v_lshrrev_b32 v20, 6, v0
	s_and_b32 s64, s2, 7
	v_readfirstlane_b32 s40, v20
	s_lshr_b32 s65, s2, 3
	s_and_b32 s70, s64, 1
	s_lshl_b32 s70, s70, 2
	s_lshr_b32 s71, s65, 3
	s_add_u32 s43, s70, s71
	s_lshr_b32 s70, s64, 1
	s_lshl_b32 s70, s70, 3
	s_and_b32 s71, s65, 7
	s_add_u32 s44, s70, s71
	v_lshrrev_b32 v21, 3, v0
	v_mul_u32_u24 v28, 1152, v21
	v_and_b32 v22, 7, v1
	v_bfe_u32 v23, v0, 4, 3
	v_xor_b32 v22, v22, v23
	v_lshl_add_u32 v28, v22, 4, v28
	v_bfe_u32 v21, v1, 2, 3
	v_bfe_u32 v22, v1, 4, 1
	v_lshlrev_b32 v22, 1, v22
	v_and_b32 v23, 3, v1
	v_xor_b32 v23, v23, v22
	v_lshrrev_b32 v22, 5, v1
	v_lshlrev_b32 v26, 6, v22
	v_lshl_add_u32 v27, v23, 4, v26
	v_and_b32 v24, 3, v21
	v_lshrrev_b32 v25, 2, v21
	v_lshl_add_u32 v24, v25, 3, v24
	v_lshl_add_u32 v29, v24, 13, v27
	s_and_b32 s41, s40, 1
	s_lshr_b32 s42, s40, 1
	s_lshl_b32 s47, s40, 10
	s_lshl_b32 s45, s42, 15
	s_lshl_b32 s70, s41, 7
	s_add_u32 s45, s45, s70
	s_lshl_b32 s46, s40, 11
	s_mov_b32 s70, 0
	s_lshl_b32 s37, s70, 7
	s_lshl_b32 s70, s70, 19
	s_add_u32 s36, s45, s70
	s_mul_i32 s70, s43, 258048
	s_lshl_b32 s71, s44, 8
	s_mov_b32 s6, 258048
	s_mov_b32 s7, 0x20000
	s_sub_u32 s10, 4718592, s71
	s_mov_b32 s11, 0x20000
	s_waitcnt lgkmcnt(0)
	s_add_u32 s4, s72, s70
	s_addc_u32 s5, s73, 0
	s_add_u32 s8, s78, s71
	s_addc_u32 s9, s79, 0
	v_lshlrev_b32 v48, 3, v0
	v_add_u32 v48, s43, v48
	v_lshrrev_b32 v49, 1, v48
	v_lshlrev_b32 v49, 13, v49
	v_and_b32 v48, 1, v48
	v_lshl_add_u32 v49, v48, 7, v49
	v_lshlrev_b32 v48, 5, v1
	v_add_u32 v48, s44, v48
	v_lshlrev_b32 v48, 7, v48
	s_cmp_lt_u32 s40, 3
	s_cbranch_scc0 L_tx
	buffer_load_dword v50, v49, s[8:11], 0 offen
	s_branch L_td
L_tx:
	buffer_load_dword v50, v48, s[4:7], 0 offen
L_td:
	s_add_u32 m0, s46, 0
	s_add_u32 s50, s36, 0
	buffer_load_dwordx4 v29, s[8:11], s50 offen lds
	s_add_u32 m0, s46, 1024
	s_add_u32 s50, s36, 131072
	buffer_load_dwordx4 v29, s[8:11], s50 offen lds
	s_add_u32 m0, s46, 8192
	s_add_u32 s50, s36, 262144
	buffer_load_dwordx4 v29, s[8:11], s50 offen lds
	s_add_u32 m0, s46, 9216
	s_add_u32 s50, s36, 393216
	buffer_load_dwordx4 v29, s[8:11], s50 offen lds
	s_add_u32 m0, s47, 16384
	s_add_u32 s50, s37, 0
	buffer_load_dwordx4 v28, s[4:7], s50 offen lds
	s_add_u32 s36, s36, 524288
	s_add_u32 m0, s47, 20480
	s_add_u32 s50, s37, 36864
	buffer_load_dwordx4 v28, s[4:7], s50 offen lds
	s_sub_u32 s39, s36, 4718592
	s_add_u32 m0, s47, 24576
	s_add_u32 s50, s37, 73728
	buffer_load_dwordx4 v28, s[4:7], s50 offen lds
	s_min_u32 s36, s36, s39
	s_add_u32 m0, s47, 28672
	s_add_u32 s50, s37, 110592
	buffer_load_dwordx4 v28, s[4:7], s50 offen lds
	s_add_u32 m0, s47, 32768
	s_add_u32 s50, s37, 147456
	buffer_load_dwordx4 v28, s[4:7], s50 offen lds
	s_add_u32 m0, s47, 36864
	s_add_u32 s50, s37, 184320
	buffer_load_dwordx4 v28, s[4:7], s50 offen lds
	s_add_u32 m0, s47, 40960
	s_add_u32 s50, s37, 221184
	buffer_load_dwordx4 v28, s[4:7], s50 offen lds
	s_lshl_b32 s70, s43, 5
	s_add_u32 s70, s70, s44
	s_lshl_b32 s70, s70, 17
	s_add_u32 s12, s74, s70
	s_addc_u32 s13, s75, 0
	s_mov_b32 s14, 0x20000
	s_mov_b32 s15, 0x20000
	s_add_u32 s16, s76, s70
	s_addc_u32 s17, s77, 0
	s_mov_b32 s18, 0x20000
	s_mov_b32 s19, 0x20000
	s_mov_b32 s22, 14680064
	s_mov_b32 s23, 0x20000
	s_mov_b32 s26, 4718592
	s_mov_b32 s27, 0x20000
	s_mov_b32 s30, 2064384
	s_mov_b32 s31, 0x20000
	s_mov_b32 s34, 256
	s_mov_b32 s35, 0x20000
	s_add_u32 s37, s37, 128
	s_add_u32 m0, s46, 45056
	s_add_u32 s50, s36, 0
	buffer_load_dwordx4 v29, s[8:11], s50 offen lds
	s_sub_u32 s39, s37, 1152
	s_add_u32 m0, s46, 46080
	s_add_u32 s50, s36, 131072
	buffer_load_dwordx4 v29, s[8:11], s50 offen lds
	s_min_u32 s37, s37, s39
	s_add_u32 m0, s46, 53248
	s_add_u32 s50, s36, 262144
	buffer_load_dwordx4 v29, s[8:11], s50 offen lds
	s_add_u32 m0, s46, 54272
	s_add_u32 s50, s36, 393216
	buffer_load_dwordx4 v29, s[8:11], s50 offen lds
	s_add_u32 m0, s47, 61440
	s_add_u32 s50, s37, 0
	buffer_load_dwordx4 v28, s[4:7], s50 offen lds
	s_add_u32 s36, s36, 524288
	s_add_u32 m0, s47, 65536
	s_add_u32 s50, s37, 36864
	buffer_load_dwordx4 v28, s[4:7], s50 offen lds
	s_sub_u32 s39, s36, 4718592
	s_add_u32 m0, s47, 69632
	s_add_u32 s50, s37, 73728
	buffer_load_dwordx4 v28, s[4:7], s50 offen lds
	s_min_u32 s36, s36, s39
	s_add_u32 m0, s47, 73728
	s_add_u32 s50, s37, 110592
	buffer_load_dwordx4 v28, s[4:7], s50 offen lds
	s_add_u32 m0, s47, 77824
	s_add_u32 s50, s37, 147456
	buffer_load_dwordx4 v28, s[4:7], s50 offen lds
	s_add_u32 m0, s47, 81920
	s_add_u32 s50, s37, 184320
	buffer_load_dwordx4 v28, s[4:7], s50 offen lds
	s_add_u32 m0, s47, 86016
	s_add_u32 s50, s37, 221184
	buffer_load_dwordx4 v28, s[4:7], s50 offen lds
	v_lshlrev_b32 v2, 4, v1
	v_lshlrev_b32 v24, 8, v21
	v_add_u32 v4, v24, v27
	v_add_u32 v3, v24, v26
	v_and_b32 v24, 1, v23
	v_lshl_add_u32 v3, v24, 5, v3
	v_lshrrev_b32 v24, 1, v23
	v_lshl_add_u32 v3, v24, 4, v3
	v_mul_u32_u24 v5, 1152, v21
	v_add_u32 v5, v5, v27
	s_lshl_b32 s70, s41, 7
	s_lshl_b32 s71, s42, 12
	s_add_u32 s70, s70, s71
	v_bfe_u32 v24, v1, 2, 2
	v_lshlrev_b32 v3, 8, v24
	v_lshrrev_b32 v24, 4, v1
	v_lshl_add_u32 v3, v24, 6, v3
	v_and_b32 v24, 3, v1
	s_lshl_b32 s70, s41, 1
	v_xor_b32 v24, s70, v24
	v_lshl_add_u32 v4, v24, 4, v3
	v_and_b32 v25, 1, v24
	v_lshl_add_u32 v3, v25, 5, v3
	v_lshrrev_b32 v25, 1, v24
	v_lshl_add_u32 v3, v25, 4, v3
	s_lshl_b32 s70, s41, 10
	s_add_u32 s70, s70, s71
	v_add_u32 v3, s70, v3
	v_add_u32 v4, s70, v4
	s_lshl_b32 s72, s43, 1
	s_add_u32 s72, s72, s44
	s_and_b32 s72, s72, 15
	s_lshl_b32 s63, s72, 13
	s_lshl_b32 s48, s41, 10
	s_add_u32 s48, s48, s71
	v_lshrrev_b32 v20, 4, v1
	v_and_b32 v21, 15, v1
	v_lshrrev_b32 v23, 2, v21
	v_lshlrev_b32 v22, 6, v23
	v_and_b32 v23, 3, v21
	v_lshl_add_u32 v22, v23, 3, v22
	v_and_b32 v23, 1, v20
	v_mul_u32_u24 v23, 288, v23
	v_add_u32 v22, v23, v22
	v_lshrrev_b32 v23, 1, v20
	v_lshl_add_u32 v30, v23, 10, v22
	v_mov_b32 v7, v30
	v_lshl_add_u32 v22, v23, 11, v22
	s_lshl_b32 s70, s41, 11
	s_sub_u32 s71, 0x800, s70
	v_add_u32 v32, s71, v30
	v_add_u32 v30, s70, v30
	v_xor_b32 v31, 32, v30
	v_xor_b32 v33, 32, v32
	v_lshrrev_b32 v24, 3, v21
	v_lshlrev_b32 v23, 11, v24
	v_and_b32 v24, 7, v21
	v_lshl_add_u32 v23, v24, 6, v23
	v_bfe_u32 v24, v21, 2, 1
	v_lshlrev_b32 v24, 1, v24
	v_xor_b32 v24, v24, v20
	v_lshl_add_u32 v23, v24, 4, v23
	v_lshrrev_b32 v25, 2, v21
	v_lshlrev_b32 v23, 10, v25
	v_and_b32 v26, 3, v21
	v_lshl_add_u32 v23, v26, 6, v23
	v_lshl_add_u32 v23, v24, 4, v23
	v_lshlrev_b32 v22, 10, v20
	v_lshl_add_u32 v22, v25, 6, v22
	v_lshl_add_u32 v22, v26, 3, v22
	v_and_b32 v25, 1, v20
	v_lshl_add_u32 v22, v25, 5, v22
	v_lshrrev_b32 v24, 1, v21
	v_xor_b32 v24, v24, v20
	v_lshlrev_b32 v38, 7, v21
	v_lshl_add_u32 v38, v24, 4, v38
	v_mov_b32 v24, v22
	v_mov_b32 v25, v23
	s_lshl_b32 s70, s41, 14
	s_sub_u32 s71, 0x4000, s70
	s_lshl_b32 s72, s41, 9
	v_add_u32 v25, s72, v25
	v_add_u32 v8, s70, v25
	v_xor_b32 v12, 0x200, v8
	v_add_u32 v16, s70, v24
	v_xor_b32 v20, 32, v16
	v_add_u32 v9, 0x10000, v8
	v_add_u32 v13, 0x10000, v12
	v_add_u32 v17, 0x10000, v16
	v_add_u32 v21, 0x10000, v20
	v_add_u32 v10, s71, v25
	v_xor_b32 v14, 0x200, v10
	v_add_u32 v18, s71, v24
	v_xor_b32 v22, 32, v18
	v_add_u32 v11, 0x10000, v10
	v_add_u32 v15, 0x10000, v14
	v_add_u32 v19, 0x10000, v18
	v_add_u32 v23, 0x10000, v22
	s_mul_i32 s70, s42, 7
	s_lshl_b32 s71, s41, 2
	s_add_u32 s71, s71, s70
	s_add_u32 s70, s70, 3
	s_lshl_b32 s72, s70, 11
	s_add_u32 s72, s72, 0x4000
	v_add_u32 v40, s72, v38
	s_lshl_b32 s72, s71, 11
	s_add_u32 s72, s72, 0x4000
	v_add_u32 v38, s72, v38
	v_xor_b32 v39, 64, v38
	v_xor_b32 v41, 64, v40
	s_mul_i32 s72, s43, 14
	s_add_u32 s71, s71, s72
	s_add_u32 s70, s70, s72
	s_lshl_b32 s73, s44, 12
	s_lshl_b32 s71, s71, 17
	s_lshl_b32 s70, s70, 17
	s_add_u32 s52, s71, s73
	s_add_u32 s53, s52, 0x20000
	s_add_u32 s54, s52, 0x40000
	s_add_u32 s55, s70, s73
	s_mov_b32 s56, 0x3e0293ee
	s_mov_b32 s57, 0x3e0293ee
	s_and_b32 s70, s64, 1
	s_lshl_b32 s70, s70, 5
	s_add_u32 s70, s70, s65
	s_and_b32 s38, s70, 0
	s_mul_hi_u32 s59, s70, 0x24924925
	s_mul_i32 s71, s59, 7
	s_sub_u32 s60, s70, s71
	s_cmp_eq_u32 s70, 63
	s_cselect_b32 s60, 7, s60
	s_min_u32 s59, s59, 8
	s_lshr_b32 s71, s64, 1
	s_lshl_b32 s51, s71, 1
	s_cmp_gt_u32 s60, 3
	s_addc_u32 s51, s51, 0
	s_mul_i32 s71, s71, 7
	s_add_u32 s58, s71, s60
	s_mul_i32 s61, s40, 1179648
	s_lshl_b32 s71, s59, 7
	s_add_u32 s61, s61, s71
	s_lshl_b32 s62, s40, 13
	s_lshl_b32 s66, s58, 19
	s_lshl_b32 s71, s40, 15
	s_add_u32 s66, s66, s71
	s_lshl_b32 s67, s58, 19
	s_lshl_b32 s71, s40, 15
	s_add_u32 s67, s67, s71
	s_add_u32 s67, s67, 131072
	s_lshl_b32 s68, s58, 19
	s_lshl_b32 s71, s40, 15
	s_add_u32 s68, s68, s71
	s_add_u32 s68, s68, 262144
	s_lshl_b32 s69, s58, 19
	s_lshl_b32 s71, s40, 15
	s_add_u32 s69, s69, s71
	s_add_u32 s69, s69, 393216
	v_lshlrev_b32 v60, 7, v0
	v_mov_b32 v24, 0x7fffff00
	v_cmp_gt_u32 vcc, 144, v0
	s_lshl_b32 s70, s40, 12
	s_add_u32 s70, s70, 147456
	v_cndmask_b32 v60, v24, v60, vcc
	s_xor_b32 s71, s70, 0x1000
	v_add_u32 v62, s70, v2
	v_add_u32 v63, s71, v2
	s_add_u32 s70, s62, 0x10000
	v_add_u32 v0, s70, v7
	v_xor_b32 v1, 32, v0
	v_add_u32 v6, 0x10000, v0
	v_xor_b32 v7, 32, v6
	v_mov_b32 v24, 0
	v_mov_b32 v25, 0
	v_mov_b32 v26, 0
	v_mov_b32 v27, 0
	v_add_u32 v34, 0, v30
	v_add_u32 v35, 0, v31
	v_add_u32 v36, 0, v32
	v_add_u32 v37, 0, v33
	v_add_u32 v42, 0, v38
	v_add_u32 v43, 0, v39
	v_add_u32 v44, 0, v40
	v_add_u32 v45, 0, v41
	s_waitcnt vmcnt(11)
	s_barrier
	ds_read_b128 a[160:163], v42 offset:0
	ds_read_b128 a[164:167], v42 offset:2048
	ds_read_b128 a[168:171], v42 offset:4096
	ds_read_b128 a[172:175], v44 offset:0
	ds_read_b64_tr_b16 a[128:129], v34 offset:0
	ds_read_b64_tr_b16 a[130:131], v34 offset:4096
	ds_read_b64_tr_b16 a[132:133], v35 offset:0
	ds_read_b64_tr_b16 a[134:135], v35 offset:4096
	ds_read_b64_tr_b16 a[136:137], v34 offset:512
	ds_read_b64_tr_b16 a[138:139], v34 offset:4608
	ds_read_b64_tr_b16 a[140:141], v35 offset:512
	ds_read_b64_tr_b16 a[142:143], v35 offset:4608
	ds_read_b64_tr_b16 a[144:145], v36 offset:0
	ds_read_b64_tr_b16 a[146:147], v36 offset:4096
	ds_read_b64_tr_b16 a[148:149], v37 offset:0
	ds_read_b64_tr_b16 a[150:151], v37 offset:4096
	ds_read_b64_tr_b16 a[152:153], v36 offset:512
	ds_read_b64_tr_b16 a[154:155], v36 offset:4608
	ds_read_b64_tr_b16 a[156:157], v37 offset:512
	ds_read_b64_tr_b16 a[158:159], v37 offset:4608
	s_waitcnt lgkmcnt(14)
	v_mfma_f32_16x16x32_bf16 v[128:131], a[128:131], a[160:163], 0
	s_add_u32 s37, s37, 128
	s_add_u32 m0, s46, 90112
	s_add_u32 s50, s36, 0
	buffer_load_dwordx4 v29, s[8:11], s50 offen lds
	v_mfma_f32_16x16x32_bf16 v[160:163], a[128:131], a[164:167], 0
	s_sub_u32 s39, s37, 1152
	ds_read_b128 a[176:179], v43 offset:0
	v_mfma_f32_16x16x32_bf16 v[192:195], a[128:131], a[168:171], 0
	s_add_u32 m0, s46, 91136
	ds_read_b128 a[180:183], v43 offset:2048
	v_mfma_f32_16x16x32_bf16 v[224:227], a[128:131], a[172:175], 0
	s_waitcnt lgkmcnt(14)
	ds_read_b128 a[184:187], v43 offset:4096
	v_mfma_f32_16x16x32_bf16 v[132:135], a[132:135], a[160:163], 0
	s_add_u32 s50, s36, 131072
	buffer_load_dwordx4 v29, s[8:11], s50 offen lds
	v_mfma_f32_16x16x32_bf16 v[164:167], a[132:135], a[164:167], 0
	s_min_u32 s37, s37, s39
	ds_read_b128 a[188:191], v45 offset:0
	v_mfma_f32_16x16x32_bf16 v[196:199], a[132:135], a[168:171], 0
	s_add_u32 m0, s46, 98304
	ds_read_b64_tr_b16 a[128:129], v34 offset:8192
	v_mfma_f32_16x16x32_bf16 v[228:231], a[132:135], a[172:175], 0
	s_waitcnt lgkmcnt(15)
	ds_read_b64_tr_b16 a[130:131], v34 offset:12288
	v_mfma_f32_16x16x32_bf16 v[136:139], a[136:139], a[160:163], 0
	s_add_u32 s50, s36, 262144
	buffer_load_dwordx4 v29, s[8:11], s50 offen lds
	v_mfma_f32_16x16x32_bf16 v[168:171], a[136:139], a[164:167], 0
	s_add_u32 m0, s46, 99328
	ds_read_b64_tr_b16 a[132:133], v35 offset:8192
	v_mfma_f32_16x16x32_bf16 v[200:203], a[136:139], a[168:171], 0
	s_add_u32 s50, s36, 393216
	ds_read_b64_tr_b16 a[134:135], v35 offset:12288
	v_mfma_f32_16x16x32_bf16 v[232:235], a[136:139], a[172:175], 0
	s_waitcnt lgkmcnt(15)
	ds_read_b64_tr_b16 a[136:137], v34 offset:8704
	v_mfma_f32_16x16x32_bf16 v[140:143], a[140:143], a[160:163], 0
	buffer_load_dwordx4 v29, s[8:11], s50 offen lds
	v_mfma_f32_16x16x32_bf16 v[172:175], a[140:143], a[164:167], 0
	s_add_u32 m0, s47, 106496
	ds_read_b64_tr_b16 a[138:139], v34 offset:12800
	v_mfma_f32_16x16x32_bf16 v[204:207], a[140:143], a[168:171], 0
	s_add_u32 s50, s37, 0
	v_mfma_f32_16x16x32_bf16 v[236:239], a[140:143], a[172:175], 0
	s_waitcnt lgkmcnt(15)
	ds_read_b64_tr_b16 a[140:141], v35 offset:8704
	v_mfma_f32_16x16x32_bf16 v[144:147], a[144:147], a[160:163], 0
	buffer_load_dwordx4 v28, s[4:7], s50 offen lds
	v_mfma_f32_16x16x32_bf16 v[176:179], a[144:147], a[164:167], 0
	s_add_u32 s36, s36, 524288
	ds_read_b64_tr_b16 a[142:143], v35 offset:12800
	v_mfma_f32_16x16x32_bf16 v[208:211], a[144:147], a[168:171], 0
	s_waitcnt lgkmcnt(15)
	ds_read_b64_tr_b16 a[144:145], v36 offset:8192
	v_mfma_f32_16x16x32_bf16 v[148:151], a[148:151], a[160:163], 0
	s_add_u32 m0, s47, 110592
	ds_read_b64_tr_b16 a[146:147], v36 offset:12288
	v_mfma_f32_16x16x32_bf16 v[180:183], a[148:151], a[164:167], 0
	s_add_u32 s50, s37, 36864
	buffer_load_dwordx4 v28, s[4:7], s50 offen lds
	v_mfma_f32_16x16x32_bf16 v[212:215], a[148:151], a[168:171], 0
	s_waitcnt lgkmcnt(15)
	ds_read_b64_tr_b16 a[148:149], v37 offset:8192
	v_mfma_f32_16x16x32_bf16 v[152:155], a[152:155], a[160:163], 0
	s_sub_u32 s39, s36, 4718592
	ds_read_b64_tr_b16 a[150:151], v37 offset:12288
	v_mfma_f32_16x16x32_bf16 v[184:187], a[152:155], a[164:167], 0
	s_add_u32 m0, s47, 114688
	v_mfma_f32_16x16x32_bf16 v[216:219], a[152:155], a[168:171], 0
	s_waitcnt lgkmcnt(15)
	s_add_u32 s50, s37, 73728
	buffer_load_dwordx4 v28, s[4:7], s50 offen lds
	v_mfma_f32_16x16x32_bf16 v[156:159], a[156:159], a[160:163], 0
	ds_read_b64_tr_b16 a[152:153], v36 offset:8704
	v_mfma_f32_16x16x32_bf16 v[188:191], a[156:159], a[164:167], 0
	s_min_u32 s36, s36, s39
	ds_read_b64_tr_b16 a[154:155], v36 offset:12800
	v_mfma_f32_16x16x32_bf16 v[220:223], a[156:159], a[168:171], 0
	s_waitcnt lgkmcnt(12)
	ds_read_b64_tr_b16 a[156:157], v37 offset:8704
	v_mfma_f32_16x16x32_bf16 v[128:131], a[128:131], a[176:179], v[128:131]
	s_add_u32 m0, s47, 118784
	ds_read_b64_tr_b16 a[158:159], v37 offset:12800
	v_mfma_f32_16x16x32_bf16 v[160:163], a[128:131], a[180:183], v[160:163]
	s_add_u32 s50, s37, 110592
	buffer_load_dwordx4 v28, s[4:7], s50 offen lds
	v_mfma_f32_16x16x32_bf16 v[192:195], a[128:131], a[184:187], v[192:195]
	v_add_u32 v34, 45056, v30
	v_add_u32 v35, 45056, v31
	v_mfma_f32_16x16x32_bf16 v[224:227], a[128:131], a[188:191], v[224:227]
	s_waitcnt lgkmcnt(12)
	v_add_u32 v36, 45056, v32
	v_add_u32 v37, 45056, v33
	v_mfma_f32_16x16x32_bf16 v[132:135], a[132:135], a[176:179], v[132:135]
	s_add_u32 m0, s47, 122880
	v_add_u32 v42, 45056, v38
	v_add_u32 v43, 45056, v39
	v_mfma_f32_16x16x32_bf16 v[164:167], a[132:135], a[180:183], v[164:167]
	s_add_u32 s50, s37, 147456
	v_add_u32 v44, 45056, v40
	v_add_u32 v45, 45056, v41
	v_mfma_f32_16x16x32_bf16 v[196:199], a[132:135], a[184:187], v[196:199]
	buffer_load_dwordx4 v28, s[4:7], s50 offen lds
	v_mfma_f32_16x16x32_bf16 v[228:231], a[132:135], a[188:191], v[228:231]
	s_waitcnt lgkmcnt(10)
	v_mfma_f32_16x16x32_bf16 v[136:139], a[136:139], a[176:179], v[136:139]
	s_waitcnt vmcnt(9) lgkmcnt(0)
	s_barrier
	s_add_u32 m0, s47, 126976
	s_add_u32 s50, s37, 184320
	buffer_load_dwordx4 v28, s[4:7], s50 offen lds
	v_mfma_f32_16x16x32_bf16 v[168:171], a[136:139], a[180:183], v[168:171]
	s_add_u32 m0, s47, 131072
	ds_read_b128 a[160:163], v42 offset:0
	v_mfma_f32_16x16x32_bf16 v[200:203], a[136:139], a[184:187], v[200:203]
	s_add_u32 s50, s37, 221184
	ds_read_b128 a[164:167], v42 offset:2048
	v_mfma_f32_16x16x32_bf16 v[232:235], a[136:139], a[188:191], v[232:235]
	ds_read_b128 a[168:171], v42 offset:4096
	v_mfma_f32_16x16x32_bf16 v[140:143], a[140:143], a[176:179], v[140:143]
	buffer_load_dwordx4 v28, s[4:7], s50 offen lds
	v_mfma_f32_16x16x32_bf16 v[172:175], a[140:143], a[180:183], v[172:175]
	s_add_u32 s37, s37, 128
	ds_read_b128 a[172:175], v44 offset:0
	v_mfma_f32_16x16x32_bf16 v[204:207], a[140:143], a[184:187], v[204:207]
	s_add_u32 m0, s46, 0
	ds_read_b64_tr_b16 a[128:129], v34 offset:0
	v_mfma_f32_16x16x32_bf16 v[236:239], a[140:143], a[188:191], v[236:239]
	s_add_u32 s50, s36, 0
	ds_read_b64_tr_b16 a[130:131], v34 offset:4096
	v_mfma_f32_16x16x32_bf16 v[144:147], a[144:147], a[176:179], v[144:147]
	buffer_load_dwordx4 v29, s[8:11], s50 offen lds
	v_mfma_f32_16x16x32_bf16 v[176:179], a[144:147], a[180:183], v[176:179]
	s_sub_u32 s39, s37, 1152
	ds_read_b64_tr_b16 a[132:133], v35 offset:0
	v_mfma_f32_16x16x32_bf16 v[208:211], a[144:147], a[184:187], v[208:211]
	s_add_u32 m0, s46, 1024
	ds_read_b64_tr_b16 a[134:135], v35 offset:4096
	v_mfma_f32_16x16x32_bf16 v[148:151], a[148:151], a[176:179], v[148:151]
	s_add_u32 s50, s36, 131072
	ds_read_b64_tr_b16 a[136:137], v34 offset:512
	v_mfma_f32_16x16x32_bf16 v[180:183], a[148:151], a[180:183], v[180:183]
	buffer_load_dwordx4 v29, s[8:11], s50 offen lds
	v_mfma_f32_16x16x32_bf16 v[212:215], a[148:151], a[184:187], v[212:215]
	s_min_u32 s37, s37, s39
	ds_read_b64_tr_b16 a[138:139], v34 offset:4608
	v_mfma_f32_16x16x32_bf16 v[152:155], a[152:155], a[176:179], v[152:155]
	s_add_u32 m0, s46, 8192
	ds_read_b64_tr_b16 a[140:141], v35 offset:512
	v_mfma_f32_16x16x32_bf16 v[184:187], a[152:155], a[180:183], v[184:187]
	s_add_u32 s50, s36, 262144
	ds_read_b64_tr_b16 a[142:143], v35 offset:4608
	v_mfma_f32_16x16x32_bf16 v[216:219], a[152:155], a[184:187], v[216:219]
	buffer_load_dwordx4 v29, s[8:11], s50 offen lds
	v_mfma_f32_16x16x32_bf16 v[156:159], a[156:159], a[176:179], v[156:159]
	s_add_u32 m0, s46, 9216
	ds_read_b64_tr_b16 a[144:145], v36 offset:0
	v_mfma_f32_16x16x32_bf16 v[188:191], a[156:159], a[180:183], v[188:191]
	s_add_u32 s50, s36, 393216
	ds_read_b64_tr_b16 a[146:147], v36 offset:4096
	v_mfma_f32_16x16x32_bf16 v[220:223], a[156:159], a[184:187], v[220:223]
	s_waitcnt lgkmcnt(8)
	ds_read_b64_tr_b16 a[148:149], v37 offset:0
	v_mfma_f32_16x16x32_bf16 v[128:131], a[128:131], a[160:163], v[128:131]
	buffer_load_dwordx4 v29, s[8:11], s50 offen lds
	v_mfma_f32_16x16x32_bf16 v[160:163], a[128:131], a[164:167], v[160:163]
	s_add_u32 m0, s47, 16384
	ds_read_b64_tr_b16 a[150:151], v37 offset:4096
	v_mfma_f32_16x16x32_bf16 v[192:195], a[128:131], a[168:171], v[192:195]
	s_add_u32 s50, s37, 0
	ds_read_b64_tr_b16 a[152:153], v36 offset:512
	v_mfma_f32_16x16x32_bf16 v[224:227], a[128:131], a[172:175], v[224:227]
	s_waitcnt lgkmcnt(9)
	ds_read_b64_tr_b16 a[154:155], v36 offset:4608
	v_mfma_f32_16x16x32_bf16 v[132:135], a[132:135], a[160:163], v[132:135]
	buffer_load_dwordx4 v28, s[4:7], s50 offen lds
	v_mfma_f32_16x16x32_bf16 v[164:167], a[132:135], a[164:167], v[164:167]
	s_add_u32 s36, s36, 524288
	ds_read_b128 a[176:179], v43 offset:0
	v_mfma_f32_16x16x32_bf16 v[196:199], a[132:135], a[168:171], v[196:199]
	s_add_u32 m0, s47, 20480
	ds_read_b64_tr_b16 a[156:157], v37 offset:512
	v_mfma_f32_16x16x32_bf16 v[228:231], a[132:135], a[172:175], v[228:231]
	s_waitcnt lgkmcnt(10)
	ds_read_b64_tr_b16 a[158:159], v37 offset:4608
	v_mfma_f32_16x16x32_bf16 v[136:139], a[136:139], a[160:163], v[136:139]
	s_add_u32 s50, s37, 36864
	buffer_load_dwordx4 v28, s[4:7], s50 offen lds
	v_mfma_f32_16x16x32_bf16 v[168:171], a[136:139], a[164:167], v[168:171]
	s_sub_u32 s39, s36, 4718592
	ds_read_b128 a[180:183], v43 offset:2048
	v_mfma_f32_16x16x32_bf16 v[200:203], a[136:139], a[168:171], v[200:203]
	s_add_u32 m0, s47, 24576
	ds_read_b128 a[184:187], v43 offset:4096
	v_mfma_f32_16x16x32_bf16 v[232:235], a[136:139], a[172:175], v[232:235]
	s_waitcnt lgkmcnt(11)
	ds_read_b128 a[188:191], v45 offset:0
	v_mfma_f32_16x16x32_bf16 v[140:143], a[140:143], a[160:163], v[140:143]
	s_add_u32 s50, s37, 73728
	buffer_load_dwordx4 v28, s[4:7], s50 offen lds
	v_mfma_f32_16x16x32_bf16 v[172:175], a[140:143], a[164:167], v[172:175]
	s_min_u32 s36, s36, s39
	ds_read_b64_tr_b16 a[128:129], v34 offset:8192
	v_mfma_f32_16x16x32_bf16 v[204:207], a[140:143], a[168:171], v[204:207]
	s_add_u32 m0, s47, 28672
	ds_read_b64_tr_b16 a[130:131], v34 offset:12288
	v_mfma_f32_16x16x32_bf16 v[236:239], a[140:143], a[172:175], v[236:239]
	s_waitcnt lgkmcnt(12)
	ds_read_b64_tr_b16 a[132:133], v35 offset:8192
	v_mfma_f32_16x16x32_bf16 v[144:147], a[144:147], a[160:163], v[144:147]
	s_add_u32 s50, s37, 110592
	buffer_load_dwordx4 v28, s[4:7], s50 offen lds
	v_mfma_f32_16x16x32_bf16 v[176:179], a[144:147], a[164:167], v[176:179]
	s_add_u32 m0, s47, 32768
	ds_read_b64_tr_b16 a[134:135], v35 offset:12288
	v_mfma_f32_16x16x32_bf16 v[208:211], a[144:147], a[168:171], v[208:211]
	s_waitcnt lgkmcnt(12)
	ds_read_b64_tr_b16 a[136:137], v34 offset:8704
	v_mfma_f32_16x16x32_bf16 v[148:151], a[148:151], a[160:163], v[148:151]
	s_add_u32 s50, s37, 147456
	ds_read_b64_tr_b16 a[138:139], v34 offset:12800
	v_mfma_f32_16x16x32_bf16 v[180:183], a[148:151], a[164:167], v[180:183]
	buffer_load_dwordx4 v28, s[4:7], s50 offen lds
	v_mfma_f32_16x16x32_bf16 v[212:215], a[148:151], a[168:171], v[212:215]
	s_waitcnt lgkmcnt(12)
	ds_read_b64_tr_b16 a[140:141], v35 offset:8704
	v_mfma_f32_16x16x32_bf16 v[152:155], a[152:155], a[160:163], v[152:155]
	s_add_u32 m0, s47, 36864
	ds_read_b64_tr_b16 a[142:143], v35 offset:12800
	v_mfma_f32_16x16x32_bf16 v[184:187], a[152:155], a[164:167], v[184:187]
	s_add_u32 s50, s37, 184320
	ds_read_b64_tr_b16 a[144:145], v36 offset:8192
	v_mfma_f32_16x16x32_bf16 v[216:219], a[152:155], a[168:171], v[216:219]
	s_waitcnt lgkmcnt(12)
	buffer_load_dwordx4 v28, s[4:7], s50 offen lds
	v_mfma_f32_16x16x32_bf16 v[156:159], a[156:159], a[160:163], v[156:159]
	ds_read_b64_tr_b16 a[146:147], v36 offset:12288
	v_mfma_f32_16x16x32_bf16 v[188:191], a[156:159], a[164:167], v[188:191]
	ds_read_b64_tr_b16 a[148:149], v37 offset:8192
	v_mfma_f32_16x16x32_bf16 v[220:223], a[156:159], a[168:171], v[220:223]
	s_waitcnt lgkmcnt(9)
	ds_read_b64_tr_b16 a[150:151], v37 offset:12288
	v_mfma_f32_16x16x32_bf16 v[128:131], a[128:131], a[176:179], v[128:131]
	s_add_u32 m0, s47, 40960
	ds_read_b64_tr_b16 a[152:153], v36 offset:8704
	v_mfma_f32_16x16x32_bf16 v[160:163], a[128:131], a[180:183], v[160:163]
	s_add_u32 s50, s37, 221184
	ds_read_b64_tr_b16 a[154:155], v36 offset:12800
	ds_read_b64_tr_b16 a[156:157], v37 offset:8704
	ds_read_b64_tr_b16 a[158:159], v37 offset:12800
	v_mfma_f32_16x16x32_bf16 v[192:195], a[128:131], a[184:187], v[192:195]
	buffer_load_dwordx4 v28, s[4:7], s50 offen lds
	v_add_u32 v34, 90112, v30
	v_mfma_f32_16x16x32_bf16 v[224:227], a[128:131], a[188:191], v[224:227]
	s_waitcnt lgkmcnt(12)
	v_add_u32 v35, 90112, v31
	v_add_u32 v36, 90112, v32
	v_mfma_f32_16x16x32_bf16 v[132:135], a[132:135], a[176:179], v[132:135]
	v_add_u32 v37, 90112, v33
	v_add_u32 v42, 90112, v38
	v_mfma_f32_16x16x32_bf16 v[164:167], a[132:135], a[180:183], v[164:167]
	v_add_u32 v43, 90112, v39
	v_add_u32 v44, 90112, v40
	v_mfma_f32_16x16x32_bf16 v[196:199], a[132:135], a[184:187], v[196:199]
	s_add_u32 s37, s37, 128
	v_add_u32 v45, 90112, v41
	v_mfma_f32_16x16x32_bf16 v[228:231], a[132:135], a[188:191], v[228:231]
	s_waitcnt lgkmcnt(10)
	v_mfma_f32_16x16x32_bf16 v[136:139], a[136:139], a[176:179], v[136:139]
	s_waitcnt vmcnt(11) lgkmcnt(0)
	s_barrier
	ds_read_b128 a[160:163], v42 offset:0
	v_mfma_f32_16x16x32_bf16 v[168:171], a[136:139], a[180:183], v[168:171]
	s_add_u32 m0, s46, 45056
	s_add_u32 s50, s36, 0
	buffer_load_dwordx4 v29, s[8:11], s50 offen lds
	v_mfma_f32_16x16x32_bf16 v[200:203], a[136:139], a[184:187], v[200:203]
	s_sub_u32 s39, s37, 1152
	ds_read_b128 a[164:167], v42 offset:2048
	v_mfma_f32_16x16x32_bf16 v[232:235], a[136:139], a[188:191], v[232:235]
	s_add_u32 m0, s46, 46080
	ds_read_b128 a[168:171], v42 offset:4096
	v_mfma_f32_16x16x32_bf16 v[140:143], a[140:143], a[176:179], v[140:143]
	s_add_u32 s50, s36, 131072
	ds_read_b128 a[172:175], v44 offset:0
	v_mfma_f32_16x16x32_bf16 v[172:175], a[140:143], a[180:183], v[172:175]
	buffer_load_dwordx4 v29, s[8:11], s50 offen lds
	v_mfma_f32_16x16x32_bf16 v[204:207], a[140:143], a[184:187], v[204:207]
	s_min_u32 s37, s37, s39
	ds_read_b64_tr_b16 a[128:129], v34 offset:0
	v_mfma_f32_16x16x32_bf16 v[236:239], a[140:143], a[188:191], v[236:239]
	s_add_u32 m0, s46, 53248
	ds_read_b64_tr_b16 a[130:131], v34 offset:4096
	v_mfma_f32_16x16x32_bf16 v[144:147], a[144:147], a[176:179], v[144:147]
	s_add_u32 s50, s36, 262144
	ds_read_b64_tr_b16 a[132:133], v35 offset:0
	v_mfma_f32_16x16x32_bf16 v[176:179], a[144:147], a[180:183], v[176:179]
	buffer_load_dwordx4 v29, s[8:11], s50 offen lds
	v_mfma_f32_16x16x32_bf16 v[208:211], a[144:147], a[184:187], v[208:211]
	s_add_u32 m0, s46, 54272
	ds_read_b64_tr_b16 a[134:135], v35 offset:4096
	v_mfma_f32_16x16x32_bf16 v[148:151], a[148:151], a[176:179], v[148:151]
	s_add_u32 s50, s36, 393216
	ds_read_b64_tr_b16 a[136:137], v34 offset:512
	v_mfma_f32_16x16x32_bf16 v[180:183], a[148:151], a[180:183], v[180:183]
	ds_read_b64_tr_b16 a[138:139], v34 offset:4608
	v_mfma_f32_16x16x32_bf16 v[212:215], a[148:151], a[184:187], v[212:215]
	buffer_load_dwordx4 v29, s[8:11], s50 offen lds
	v_mfma_f32_16x16x32_bf16 v[152:155], a[152:155], a[176:179], v[152:155]
	s_add_u32 m0, s47, 61440
	ds_read_b64_tr_b16 a[140:141], v35 offset:512
	v_mfma_f32_16x16x32_bf16 v[184:187], a[152:155], a[180:183], v[184:187]
	s_add_u32 s50, s37, 0
	ds_read_b64_tr_b16 a[142:143], v35 offset:4608
	v_mfma_f32_16x16x32_bf16 v[216:219], a[152:155], a[184:187], v[216:219]
	ds_read_b64_tr_b16 a[144:145], v36 offset:0
	v_mfma_f32_16x16x32_bf16 v[156:159], a[156:159], a[176:179], v[156:159]
	buffer_load_dwordx4 v28, s[4:7], s50 offen lds
	v_mfma_f32_16x16x32_bf16 v[188:191], a[156:159], a[180:183], v[188:191]
	s_add_u32 s36, s36, 524288
	ds_read_b64_tr_b16 a[146:147], v36 offset:4096
	v_mfma_f32_16x16x32_bf16 v[220:223], a[156:159], a[184:187], v[220:223]
	s_waitcnt lgkmcnt(8)
	ds_read_b64_tr_b16 a[148:149], v37 offset:0
	v_mfma_f32_16x16x32_bf16 v[128:131], a[128:131], a[160:163], v[128:131]
	s_add_u32 m0, s47, 65536
	ds_read_b64_tr_b16 a[150:151], v37 offset:4096
	v_mfma_f32_16x16x32_bf16 v[160:163], a[128:131], a[164:167], v[160:163]
	s_add_u32 s50, s37, 36864
	buffer_load_dwordx4 v28, s[4:7], s50 offen lds
	v_mfma_f32_16x16x32_bf16 v[192:195], a[128:131], a[168:171], v[192:195]
	s_sub_u32 s39, s36, 4718592
	ds_read_b64_tr_b16 a[152:153], v36 offset:512
	v_mfma_f32_16x16x32_bf16 v[224:227], a[128:131], a[172:175], v[224:227]
	s_waitcnt lgkmcnt(9)
	ds_read_b64_tr_b16 a[154:155], v36 offset:4608
	v_mfma_f32_16x16x32_bf16 v[132:135], a[132:135], a[160:163], v[132:135]
	s_add_u32 m0, s47, 69632
	ds_read_b128 a[176:179], v43 offset:0
	v_mfma_f32_16x16x32_bf16 v[164:167], a[132:135], a[164:167], v[164:167]
	s_add_u32 s50, s37, 73728
	buffer_load_dwordx4 v28, s[4:7], s50 offen lds
	v_mfma_f32_16x16x32_bf16 v[196:199], a[132:135], a[168:171], v[196:199]
	s_min_u32 s36, s36, s39
	ds_read_b64_tr_b16 a[156:157], v37 offset:512
	v_mfma_f32_16x16x32_bf16 v[228:231], a[132:135], a[172:175], v[228:231]
	s_waitcnt lgkmcnt(10)
	ds_read_b64_tr_b16 a[158:159], v37 offset:4608
	v_mfma_f32_16x16x32_bf16 v[136:139], a[136:139], a[160:163], v[136:139]
	s_add_u32 m0, s47, 73728
	ds_read_b128 a[180:183], v43 offset:2048
	v_mfma_f32_16x16x32_bf16 v[168:171], a[136:139], a[164:167], v[168:171]
	s_add_u32 s50, s37, 110592
	buffer_load_dwordx4 v28, s[4:7], s50 offen lds
	v_mfma_f32_16x16x32_bf16 v[200:203], a[136:139], a[168:171], v[200:203]
	s_add_u32 m0, s47, 77824
	ds_read_b128 a[184:187], v43 offset:4096
	v_mfma_f32_16x16x32_bf16 v[232:235], a[136:139], a[172:175], v[232:235]
	s_waitcnt lgkmcnt(11)
	ds_read_b128 a[188:191], v45 offset:0
	v_mfma_f32_16x16x32_bf16 v[140:143], a[140:143], a[160:163], v[140:143]
	s_add_u32 s50, s37, 147456
	ds_read_b64_tr_b16 a[128:129], v34 offset:8192
	v_mfma_f32_16x16x32_bf16 v[172:175], a[140:143], a[164:167], v[172:175]
	buffer_load_dwordx4 v28, s[4:7], s50 offen lds
	v_mfma_f32_16x16x32_bf16 v[204:207], a[140:143], a[168:171], v[204:207]
	s_add_u32 m0, s47, 81920
	ds_read_b64_tr_b16 a[130:131], v34 offset:12288
	v_mfma_f32_16x16x32_bf16 v[236:239], a[140:143], a[172:175], v[236:239]
	s_waitcnt lgkmcnt(12)
	ds_read_b64_tr_b16 a[132:133], v35 offset:8192
	v_mfma_f32_16x16x32_bf16 v[144:147], a[144:147], a[160:163], v[144:147]
	s_add_u32 s50, s37, 184320
	ds_read_b64_tr_b16 a[134:135], v35 offset:12288
	v_mfma_f32_16x16x32_bf16 v[176:179], a[144:147], a[164:167], v[176:179]
	buffer_load_dwordx4 v28, s[4:7], s50 offen lds
	v_mfma_f32_16x16x32_bf16 v[208:211], a[144:147], a[168:171], v[208:211]
	s_waitcnt lgkmcnt(12)
	ds_read_b64_tr_b16 a[136:137], v34 offset:8704
	v_mfma_f32_16x16x32_bf16 v[148:151], a[148:151], a[160:163], v[148:151]
	s_add_u32 m0, s47, 86016
	ds_read_b64_tr_b16 a[138:139], v34 offset:12800
	v_mfma_f32_16x16x32_bf16 v[180:183], a[148:151], a[164:167], v[180:183]
	s_add_u32 s50, s37, 221184
	ds_read_b64_tr_b16 a[140:141], v35 offset:8704
	v_mfma_f32_16x16x32_bf16 v[212:215], a[148:151], a[168:171], v[212:215]
	s_waitcnt lgkmcnt(13)
	buffer_load_dwordx4 v28, s[4:7], s50 offen lds
	v_mfma_f32_16x16x32_bf16 v[152:155], a[152:155], a[160:163], v[152:155]
	ds_read_b64_tr_b16 a[142:143], v35 offset:12800
	v_mfma_f32_16x16x32_bf16 v[184:187], a[152:155], a[164:167], v[184:187]
	ds_read_b64_tr_b16 a[144:145], v36 offset:8192
	v_mfma_f32_16x16x32_bf16 v[216:219], a[152:155], a[168:171], v[216:219]
	s_waitcnt lgkmcnt(12)
	ds_read_b64_tr_b16 a[146:147], v36 offset:12288
	v_mfma_f32_16x16x32_bf16 v[156:159], a[156:159], a[160:163], v[156:159]
	ds_read_b64_tr_b16 a[148:149], v37 offset:8192
	v_mfma_f32_16x16x32_bf16 v[188:191], a[156:159], a[164:167], v[188:191]
	ds_read_b64_tr_b16 a[150:151], v37 offset:12288
	v_mfma_f32_16x16x32_bf16 v[220:223], a[156:159], a[168:171], v[220:223]
	s_waitcnt lgkmcnt(10)
	ds_read_b64_tr_b16 a[152:153], v36 offset:8704
	v_mfma_f32_16x16x32_bf16 v[128:131], a[128:131], a[176:179], v[128:131]
	ds_read_b64_tr_b16 a[154:155], v36 offset:12800
	v_mfma_f32_16x16x32_bf16 v[160:163], a[128:131], a[180:183], v[160:163]
	ds_read_b64_tr_b16 a[156:157], v37 offset:8704
	ds_read_b64_tr_b16 a[158:159], v37 offset:12800
	v_mfma_f32_16x16x32_bf16 v[192:195], a[128:131], a[184:187], v[192:195]
	v_add_u32 v34, 0, v30
	v_add_u32 v35, 0, v31
	v_mfma_f32_16x16x32_bf16 v[224:227], a[128:131], a[188:191], v[224:227]
	s_waitcnt lgkmcnt(12)
	v_add_u32 v36, 0, v32
	v_add_u32 v37, 0, v33
	v_mfma_f32_16x16x32_bf16 v[132:135], a[132:135], a[176:179], v[132:135]
	v_add_u32 v42, 0, v38
	v_add_u32 v43, 0, v39
	v_mfma_f32_16x16x32_bf16 v[164:167], a[132:135], a[180:183], v[164:167]
	v_add_u32 v44, 0, v40
	v_add_u32 v45, 0, v41
	v_mfma_f32_16x16x32_bf16 v[196:199], a[132:135], a[184:187], v[196:199]
	s_add_u32 s37, s37, 128
	v_mfma_f32_16x16x32_bf16 v[228:231], a[132:135], a[188:191], v[228:231]
	s_waitcnt lgkmcnt(10)
	v_mfma_f32_16x16x32_bf16 v[136:139], a[136:139], a[176:179], v[136:139]
	s_waitcnt vmcnt(11) lgkmcnt(0)
	s_barrier
	ds_read_b128 a[160:163], v42 offset:0
	v_mfma_f32_16x16x32_bf16 v[168:171], a[136:139], a[180:183], v[168:171]
	s_add_u32 m0, s46, 90112
	s_add_u32 s50, s36, 0
	buffer_load_dwordx4 v29, s[8:11], s50 offen lds
	v_mfma_f32_16x16x32_bf16 v[200:203], a[136:139], a[184:187], v[200:203]
	s_sub_u32 s39, s37, 1152
	ds_read_b128 a[164:167], v42 offset:2048
	v_mfma_f32_16x16x32_bf16 v[232:235], a[136:139], a[188:191], v[232:235]
	s_add_u32 m0, s46, 91136
	ds_read_b128 a[168:171], v42 offset:4096
	v_mfma_f32_16x16x32_bf16 v[140:143], a[140:143], a[176:179], v[140:143]
	s_add_u32 s50, s36, 131072
	ds_read_b128 a[172:175], v44 offset:0
	v_mfma_f32_16x16x32_bf16 v[172:175], a[140:143], a[180:183], v[172:175]
	buffer_load_dwordx4 v29, s[8:11], s50 offen lds
	v_mfma_f32_16x16x32_bf16 v[204:207], a[140:143], a[184:187], v[204:207]
	s_min_u32 s37, s37, s39
	ds_read_b64_tr_b16 a[128:129], v34 offset:0
	v_mfma_f32_16x16x32_bf16 v[236:239], a[140:143], a[188:191], v[236:239]
	s_add_u32 m0, s46, 98304
	ds_read_b64_tr_b16 a[130:131], v34 offset:4096
	v_mfma_f32_16x16x32_bf16 v[144:147], a[144:147], a[176:179], v[144:147]
	s_add_u32 s50, s36, 262144
	ds_read_b64_tr_b16 a[132:133], v35 offset:0
	v_mfma_f32_16x16x32_bf16 v[176:179], a[144:147], a[180:183], v[176:179]
	buffer_load_dwordx4 v29, s[8:11], s50 offen lds
	v_mfma_f32_16x16x32_bf16 v[208:211], a[144:147], a[184:187], v[208:211]
	s_add_u32 m0, s46, 99328
	ds_read_b64_tr_b16 a[134:135], v35 offset:4096
	v_mfma_f32_16x16x32_bf16 v[148:151], a[148:151], a[176:179], v[148:151]
	s_add_u32 s50, s36, 393216
	ds_read_b64_tr_b16 a[136:137], v34 offset:512
	v_mfma_f32_16x16x32_bf16 v[180:183], a[148:151], a[180:183], v[180:183]
	ds_read_b64_tr_b16 a[138:139], v34 offset:4608
	v_mfma_f32_16x16x32_bf16 v[212:215], a[148:151], a[184:187], v[212:215]
	buffer_load_dwordx4 v29, s[8:11], s50 offen lds
	v_mfma_f32_16x16x32_bf16 v[152:155], a[152:155], a[176:179], v[152:155]
	s_add_u32 m0, s47, 106496
	ds_read_b64_tr_b16 a[140:141], v35 offset:512
	v_mfma_f32_16x16x32_bf16 v[184:187], a[152:155], a[180:183], v[184:187]
	s_add_u32 s50, s37, 0
	ds_read_b64_tr_b16 a[142:143], v35 offset:4608
	v_mfma_f32_16x16x32_bf16 v[216:219], a[152:155], a[184:187], v[216:219]
	ds_read_b64_tr_b16 a[144:145], v36 offset:0
	v_mfma_f32_16x16x32_bf16 v[156:159], a[156:159], a[176:179], v[156:159]
	buffer_load_dwordx4 v28, s[4:7], s50 offen lds
	v_mfma_f32_16x16x32_bf16 v[188:191], a[156:159], a[180:183], v[188:191]
	s_add_u32 s36, s36, 524288
	ds_read_b64_tr_b16 a[146:147], v36 offset:4096
	v_mfma_f32_16x16x32_bf16 v[220:223], a[156:159], a[184:187], v[220:223]
	s_waitcnt lgkmcnt(8)
	ds_read_b64_tr_b16 a[148:149], v37 offset:0
	v_mfma_f32_16x16x32_bf16 v[128:131], a[128:131], a[160:163], v[128:131]
	s_add_u32 m0, s47, 110592
	ds_read_b64_tr_b16 a[150:151], v37 offset:4096
	v_mfma_f32_16x16x32_bf16 v[160:163], a[128:131], a[164:167], v[160:163]
	s_add_u32 s50, s37, 36864
	buffer_load_dwordx4 v28, s[4:7], s50 offen lds
	v_mfma_f32_16x16x32_bf16 v[192:195], a[128:131], a[168:171], v[192:195]
	s_sub_u32 s39, s36, 4718592
	ds_read_b64_tr_b16 a[152:153], v36 offset:512
	v_mfma_f32_16x16x32_bf16 v[224:227], a[128:131], a[172:175], v[224:227]
	s_waitcnt lgkmcnt(9)
	ds_read_b64_tr_b16 a[154:155], v36 offset:4608
	v_mfma_f32_16x16x32_bf16 v[132:135], a[132:135], a[160:163], v[132:135]
	s_add_u32 m0, s47, 114688
	ds_read_b128 a[176:179], v43 offset:0
	v_mfma_f32_16x16x32_bf16 v[164:167], a[132:135], a[164:167], v[164:167]
	s_add_u32 s50, s37, 73728
	buffer_load_dwordx4 v28, s[4:7], s50 offen lds
	v_mfma_f32_16x16x32_bf16 v[196:199], a[132:135], a[168:171], v[196:199]
	s_min_u32 s36, s36, s39
	ds_read_b64_tr_b16 a[156:157], v37 offset:512
	v_mfma_f32_16x16x32_bf16 v[228:231], a[132:135], a[172:175], v[228:231]
	s_waitcnt lgkmcnt(10)
	ds_read_b64_tr_b16 a[158:159], v37 offset:4608
	v_mfma_f32_16x16x32_bf16 v[136:139], a[136:139], a[160:163], v[136:139]
	s_add_u32 m0, s47, 118784
	ds_read_b128 a[180:183], v43 offset:2048
	v_mfma_f32_16x16x32_bf16 v[168:171], a[136:139], a[164:167], v[168:171]
	s_add_u32 s50, s37, 110592
	buffer_load_dwordx4 v28, s[4:7], s50 offen lds
	v_mfma_f32_16x16x32_bf16 v[200:203], a[136:139], a[168:171], v[200:203]
	s_add_u32 m0, s47, 122880
	ds_read_b128 a[184:187], v43 offset:4096
	v_mfma_f32_16x16x32_bf16 v[232:235], a[136:139], a[172:175], v[232:235]
	s_waitcnt lgkmcnt(11)
	ds_read_b128 a[188:191], v45 offset:0
	v_mfma_f32_16x16x32_bf16 v[140:143], a[140:143], a[160:163], v[140:143]
	s_add_u32 s50, s37, 147456
	ds_read_b64_tr_b16 a[128:129], v34 offset:8192
	v_mfma_f32_16x16x32_bf16 v[172:175], a[140:143], a[164:167], v[172:175]
	buffer_load_dwordx4 v28, s[4:7], s50 offen lds
	v_mfma_f32_16x16x32_bf16 v[204:207], a[140:143], a[168:171], v[204:207]
	s_add_u32 m0, s47, 126976
	ds_read_b64_tr_b16 a[130:131], v34 offset:12288
	v_mfma_f32_16x16x32_bf16 v[236:239], a[140:143], a[172:175], v[236:239]
	s_waitcnt lgkmcnt(12)
	ds_read_b64_tr_b16 a[132:133], v35 offset:8192
	v_mfma_f32_16x16x32_bf16 v[144:147], a[144:147], a[160:163], v[144:147]
	s_add_u32 s50, s37, 184320
	ds_read_b64_tr_b16 a[134:135], v35 offset:12288
	v_mfma_f32_16x16x32_bf16 v[176:179], a[144:147], a[164:167], v[176:179]
	buffer_load_dwordx4 v28, s[4:7], s50 offen lds
	v_mfma_f32_16x16x32_bf16 v[208:211], a[144:147], a[168:171], v[208:211]
	s_waitcnt lgkmcnt(12)
	ds_read_b64_tr_b16 a[136:137], v34 offset:8704
	v_mfma_f32_16x16x32_bf16 v[148:151], a[148:151], a[160:163], v[148:151]
	s_add_u32 m0, s47, 131072
	ds_read_b64_tr_b16 a[138:139], v34 offset:12800
	v_mfma_f32_16x16x32_bf16 v[180:183], a[148:151], a[164:167], v[180:183]
	s_add_u32 s50, s37, 221184
	ds_read_b64_tr_b16 a[140:141], v35 offset:8704
	v_mfma_f32_16x16x32_bf16 v[212:215], a[148:151], a[168:171], v[212:215]
	s_waitcnt lgkmcnt(13)
	buffer_load_dwordx4 v28, s[4:7], s50 offen lds
	v_mfma_f32_16x16x32_bf16 v[152:155], a[152:155], a[160:163], v[152:155]
	ds_read_b64_tr_b16 a[142:143], v35 offset:12800
	v_mfma_f32_16x16x32_bf16 v[184:187], a[152:155], a[164:167], v[184:187]
	ds_read_b64_tr_b16 a[144:145], v36 offset:8192
	v_mfma_f32_16x16x32_bf16 v[216:219], a[152:155], a[168:171], v[216:219]
	s_waitcnt lgkmcnt(12)
	ds_read_b64_tr_b16 a[146:147], v36 offset:12288
	v_mfma_f32_16x16x32_bf16 v[156:159], a[156:159], a[160:163], v[156:159]
	ds_read_b64_tr_b16 a[148:149], v37 offset:8192
	v_mfma_f32_16x16x32_bf16 v[188:191], a[156:159], a[164:167], v[188:191]
	ds_read_b64_tr_b16 a[150:151], v37 offset:12288
	v_mfma_f32_16x16x32_bf16 v[220:223], a[156:159], a[168:171], v[220:223]
	s_waitcnt lgkmcnt(10)
	ds_read_b64_tr_b16 a[152:153], v36 offset:8704
	v_mfma_f32_16x16x32_bf16 v[128:131], a[128:131], a[176:179], v[128:131]
	ds_read_b64_tr_b16 a[154:155], v36 offset:12800
	v_mfma_f32_16x16x32_bf16 v[160:163], a[128:131], a[180:183], v[160:163]
	ds_read_b64_tr_b16 a[156:157], v37 offset:8704
	ds_read_b64_tr_b16 a[158:159], v37 offset:12800
	v_mfma_f32_16x16x32_bf16 v[192:195], a[128:131], a[184:187], v[192:195]
	v_add_u32 v34, 45056, v30
	v_add_u32 v35, 45056, v31
	v_mfma_f32_16x16x32_bf16 v[224:227], a[128:131], a[188:191], v[224:227]
	s_waitcnt lgkmcnt(12)
	v_add_u32 v36, 45056, v32
	v_add_u32 v37, 45056, v33
	v_mfma_f32_16x16x32_bf16 v[132:135], a[132:135], a[176:179], v[132:135]
	v_add_u32 v42, 45056, v38
	v_add_u32 v43, 45056, v39
	v_mfma_f32_16x16x32_bf16 v[164:167], a[132:135], a[180:183], v[164:167]
	v_add_u32 v44, 45056, v40
	v_add_u32 v45, 45056, v41
	v_mfma_f32_16x16x32_bf16 v[196:199], a[132:135], a[184:187], v[196:199]
	s_add_u32 s37, s37, 128
	v_mfma_f32_16x16x32_bf16 v[228:231], a[132:135], a[188:191], v[228:231]
	s_waitcnt lgkmcnt(10)
	v_mfma_f32_16x16x32_bf16 v[136:139], a[136:139], a[176:179], v[136:139]
	s_waitcnt vmcnt(11) lgkmcnt(0)
	s_barrier
	ds_read_b128 a[160:163], v42 offset:0
	v_mfma_f32_16x16x32_bf16 v[168:171], a[136:139], a[180:183], v[168:171]
	s_add_u32 m0, s46, 0
	s_add_u32 s50, s36, 0
	buffer_load_dwordx4 v29, s[8:11], s50 offen lds
	v_mfma_f32_16x16x32_bf16 v[200:203], a[136:139], a[184:187], v[200:203]
	s_sub_u32 s39, s37, 1152
	ds_read_b128 a[164:167], v42 offset:2048
	v_mfma_f32_16x16x32_bf16 v[232:235], a[136:139], a[188:191], v[232:235]
	s_add_u32 m0, s46, 1024
	ds_read_b128 a[168:171], v42 offset:4096
	v_mfma_f32_16x16x32_bf16 v[140:143], a[140:143], a[176:179], v[140:143]
	s_add_u32 s50, s36, 131072
	ds_read_b128 a[172:175], v44 offset:0
	v_mfma_f32_16x16x32_bf16 v[172:175], a[140:143], a[180:183], v[172:175]
	buffer_load_dwordx4 v29, s[8:11], s50 offen lds
	v_mfma_f32_16x16x32_bf16 v[204:207], a[140:143], a[184:187], v[204:207]
	s_min_u32 s37, s37, s39
	ds_read_b64_tr_b16 a[128:129], v34 offset:0
	v_mfma_f32_16x16x32_bf16 v[236:239], a[140:143], a[188:191], v[236:239]
	s_add_u32 m0, s46, 8192
	ds_read_b64_tr_b16 a[130:131], v34 offset:4096
	v_mfma_f32_16x16x32_bf16 v[144:147], a[144:147], a[176:179], v[144:147]
	s_add_u32 s50, s36, 262144
	ds_read_b64_tr_b16 a[132:133], v35 offset:0
	v_mfma_f32_16x16x32_bf16 v[176:179], a[144:147], a[180:183], v[176:179]
	buffer_load_dwordx4 v29, s[8:11], s50 offen lds
	v_mfma_f32_16x16x32_bf16 v[208:211], a[144:147], a[184:187], v[208:211]
	s_add_u32 m0, s46, 9216
	ds_read_b64_tr_b16 a[134:135], v35 offset:4096
	v_mfma_f32_16x16x32_bf16 v[148:151], a[148:151], a[176:179], v[148:151]
	s_add_u32 s50, s36, 393216
	ds_read_b64_tr_b16 a[136:137], v34 offset:512
	v_mfma_f32_16x16x32_bf16 v[180:183], a[148:151], a[180:183], v[180:183]
	ds_read_b64_tr_b16 a[138:139], v34 offset:4608
	v_mfma_f32_16x16x32_bf16 v[212:215], a[148:151], a[184:187], v[212:215]
	buffer_load_dwordx4 v29, s[8:11], s50 offen lds
	v_mfma_f32_16x16x32_bf16 v[152:155], a[152:155], a[176:179], v[152:155]
	s_add_u32 m0, s47, 16384
	ds_read_b64_tr_b16 a[140:141], v35 offset:512
	v_mfma_f32_16x16x32_bf16 v[184:187], a[152:155], a[180:183], v[184:187]
	s_add_u32 s50, s37, 0
	ds_read_b64_tr_b16 a[142:143], v35 offset:4608
	v_mfma_f32_16x16x32_bf16 v[216:219], a[152:155], a[184:187], v[216:219]
	ds_read_b64_tr_b16 a[144:145], v36 offset:0
	v_mfma_f32_16x16x32_bf16 v[156:159], a[156:159], a[176:179], v[156:159]
	buffer_load_dwordx4 v28, s[4:7], s50 offen lds
	v_mfma_f32_16x16x32_bf16 v[188:191], a[156:159], a[180:183], v[188:191]
	s_add_u32 s36, s36, 524288
	ds_read_b64_tr_b16 a[146:147], v36 offset:4096
	v_mfma_f32_16x16x32_bf16 v[220:223], a[156:159], a[184:187], v[220:223]
	s_waitcnt lgkmcnt(8)
	ds_read_b64_tr_b16 a[148:149], v37 offset:0
	v_mfma_f32_16x16x32_bf16 v[128:131], a[128:131], a[160:163], v[128:131]
	s_add_u32 m0, s47, 20480
	ds_read_b64_tr_b16 a[150:151], v37 offset:4096
	v_mfma_f32_16x16x32_bf16 v[160:163], a[128:131], a[164:167], v[160:163]
	s_add_u32 s50, s37, 36864
	buffer_load_dwordx4 v28, s[4:7], s50 offen lds
	v_mfma_f32_16x16x32_bf16 v[192:195], a[128:131], a[168:171], v[192:195]
	s_sub_u32 s39, s36, 4718592
	ds_read_b64_tr_b16 a[152:153], v36 offset:512
	v_mfma_f32_16x16x32_bf16 v[224:227], a[128:131], a[172:175], v[224:227]
	s_waitcnt lgkmcnt(9)
	ds_read_b64_tr_b16 a[154:155], v36 offset:4608
	v_mfma_f32_16x16x32_bf16 v[132:135], a[132:135], a[160:163], v[132:135]
	s_add_u32 m0, s47, 24576
	ds_read_b128 a[176:179], v43 offset:0
	v_mfma_f32_16x16x32_bf16 v[164:167], a[132:135], a[164:167], v[164:167]
	s_add_u32 s50, s37, 73728
	buffer_load_dwordx4 v28, s[4:7], s50 offen lds
	v_mfma_f32_16x16x32_bf16 v[196:199], a[132:135], a[168:171], v[196:199]
	s_min_u32 s36, s36, s39
	ds_read_b64_tr_b16 a[156:157], v37 offset:512
	v_mfma_f32_16x16x32_bf16 v[228:231], a[132:135], a[172:175], v[228:231]
	s_waitcnt lgkmcnt(10)
	ds_read_b64_tr_b16 a[158:159], v37 offset:4608
	v_mfma_f32_16x16x32_bf16 v[136:139], a[136:139], a[160:163], v[136:139]
	s_add_u32 m0, s47, 28672
	ds_read_b128 a[180:183], v43 offset:2048
	v_mfma_f32_16x16x32_bf16 v[168:171], a[136:139], a[164:167], v[168:171]
	s_add_u32 s50, s37, 110592
	buffer_load_dwordx4 v28, s[4:7], s50 offen lds
	v_mfma_f32_16x16x32_bf16 v[200:203], a[136:139], a[168:171], v[200:203]
	s_add_u32 m0, s47, 32768
	ds_read_b128 a[184:187], v43 offset:4096
	v_mfma_f32_16x16x32_bf16 v[232:235], a[136:139], a[172:175], v[232:235]
	s_waitcnt lgkmcnt(11)
	ds_read_b128 a[188:191], v45 offset:0
	v_mfma_f32_16x16x32_bf16 v[140:143], a[140:143], a[160:163], v[140:143]
	s_add_u32 s50, s37, 147456
	ds_read_b64_tr_b16 a[128:129], v34 offset:8192
	v_mfma_f32_16x16x32_bf16 v[172:175], a[140:143], a[164:167], v[172:175]
	buffer_load_dwordx4 v28, s[4:7], s50 offen lds
	v_mfma_f32_16x16x32_bf16 v[204:207], a[140:143], a[168:171], v[204:207]
	s_add_u32 m0, s47, 36864
	ds_read_b64_tr_b16 a[130:131], v34 offset:12288
	v_mfma_f32_16x16x32_bf16 v[236:239], a[140:143], a[172:175], v[236:239]
	s_waitcnt lgkmcnt(12)
	ds_read_b64_tr_b16 a[132:133], v35 offset:8192
	v_mfma_f32_16x16x32_bf16 v[144:147], a[144:147], a[160:163], v[144:147]
	s_add_u32 s50, s37, 184320
	ds_read_b64_tr_b16 a[134:135], v35 offset:12288
	v_mfma_f32_16x16x32_bf16 v[176:179], a[144:147], a[164:167], v[176:179]
	buffer_load_dwordx4 v28, s[4:7], s50 offen lds
	v_mfma_f32_16x16x32_bf16 v[208:211], a[144:147], a[168:171], v[208:211]
	s_waitcnt lgkmcnt(12)
	ds_read_b64_tr_b16 a[136:137], v34 offset:8704
	v_mfma_f32_16x16x32_bf16 v[148:151], a[148:151], a[160:163], v[148:151]
	s_add_u32 m0, s47, 40960
	ds_read_b64_tr_b16 a[138:139], v34 offset:12800
	v_mfma_f32_16x16x32_bf16 v[180:183], a[148:151], a[164:167], v[180:183]
	s_add_u32 s50, s37, 221184
	ds_read_b64_tr_b16 a[140:141], v35 offset:8704
	v_mfma_f32_16x16x32_bf16 v[212:215], a[148:151], a[168:171], v[212:215]
	s_waitcnt lgkmcnt(13)
	buffer_load_dwordx4 v28, s[4:7], s50 offen lds
	v_mfma_f32_16x16x32_bf16 v[152:155], a[152:155], a[160:163], v[152:155]
	ds_read_b64_tr_b16 a[142:143], v35 offset:12800
	v_mfma_f32_16x16x32_bf16 v[184:187], a[152:155], a[164:167], v[184:187]
	ds_read_b64_tr_b16 a[144:145], v36 offset:8192
	v_mfma_f32_16x16x32_bf16 v[216:219], a[152:155], a[168:171], v[216:219]
	s_waitcnt lgkmcnt(12)
	ds_read_b64_tr_b16 a[146:147], v36 offset:12288
	v_mfma_f32_16x16x32_bf16 v[156:159], a[156:159], a[160:163], v[156:159]
	ds_read_b64_tr_b16 a[148:149], v37 offset:8192
	v_mfma_f32_16x16x32_bf16 v[188:191], a[156:159], a[164:167], v[188:191]
	ds_read_b64_tr_b16 a[150:151], v37 offset:12288
	v_mfma_f32_16x16x32_bf16 v[220:223], a[156:159], a[168:171], v[220:223]
	s_waitcnt lgkmcnt(10)
	ds_read_b64_tr_b16 a[152:153], v36 offset:8704
	v_mfma_f32_16x16x32_bf16 v[128:131], a[128:131], a[176:179], v[128:131]
	ds_read_b64_tr_b16 a[154:155], v36 offset:12800
	v_mfma_f32_16x16x32_bf16 v[160:163], a[128:131], a[180:183], v[160:163]
	ds_read_b64_tr_b16 a[156:157], v37 offset:8704
	ds_read_b64_tr_b16 a[158:159], v37 offset:12800
	v_mfma_f32_16x16x32_bf16 v[192:195], a[128:131], a[184:187], v[192:195]
	v_add_u32 v34, 90112, v30
	v_add_u32 v35, 90112, v31
	v_mfma_f32_16x16x32_bf16 v[224:227], a[128:131], a[188:191], v[224:227]
	s_waitcnt lgkmcnt(12)
	v_add_u32 v36, 90112, v32
	v_add_u32 v37, 90112, v33
	v_mfma_f32_16x16x32_bf16 v[132:135], a[132:135], a[176:179], v[132:135]
	v_add_u32 v42, 90112, v38
	v_add_u32 v43, 90112, v39
	v_mfma_f32_16x16x32_bf16 v[164:167], a[132:135], a[180:183], v[164:167]
	v_add_u32 v44, 90112, v40
	v_add_u32 v45, 90112, v41
	v_mfma_f32_16x16x32_bf16 v[196:199], a[132:135], a[184:187], v[196:199]
	s_add_u32 s37, s37, 128
	v_mfma_f32_16x16x32_bf16 v[228:231], a[132:135], a[188:191], v[228:231]
	s_waitcnt lgkmcnt(10)
	v_mfma_f32_16x16x32_bf16 v[136:139], a[136:139], a[176:179], v[136:139]
	s_waitcnt vmcnt(11) lgkmcnt(0)
	s_barrier
	ds_read_b128 a[160:163], v42 offset:0
	v_mfma_f32_16x16x32_bf16 v[168:171], a[136:139], a[180:183], v[168:171]
	s_add_u32 m0, s46, 45056
	s_add_u32 s50, s36, 0
	buffer_load_dwordx4 v29, s[8:11], s50 offen lds
	v_mfma_f32_16x16x32_bf16 v[200:203], a[136:139], a[184:187], v[200:203]
	s_sub_u32 s39, s37, 1152
	ds_read_b128 a[164:167], v42 offset:2048
	v_mfma_f32_16x16x32_bf16 v[232:235], a[136:139], a[188:191], v[232:235]
	s_add_u32 m0, s46, 46080
	ds_read_b128 a[168:171], v42 offset:4096
	v_mfma_f32_16x16x32_bf16 v[140:143], a[140:143], a[176:179], v[140:143]
	s_add_u32 s50, s36, 131072
	ds_read_b128 a[172:175], v44 offset:0
	v_mfma_f32_16x16x32_bf16 v[172:175], a[140:143], a[180:183], v[172:175]
	buffer_load_dwordx4 v29, s[8:11], s50 offen lds
	v_mfma_f32_16x16x32_bf16 v[204:207], a[140:143], a[184:187], v[204:207]
	s_min_u32 s37, s37, s39
	ds_read_b64_tr_b16 a[128:129], v34 offset:0
	v_mfma_f32_16x16x32_bf16 v[236:239], a[140:143], a[188:191], v[236:239]
	s_add_u32 m0, s46, 53248
	ds_read_b64_tr_b16 a[130:131], v34 offset:4096
	v_mfma_f32_16x16x32_bf16 v[144:147], a[144:147], a[176:179], v[144:147]
	s_add_u32 s50, s36, 262144
	ds_read_b64_tr_b16 a[132:133], v35 offset:0
	v_mfma_f32_16x16x32_bf16 v[176:179], a[144:147], a[180:183], v[176:179]
	buffer_load_dwordx4 v29, s[8:11], s50 offen lds
	v_mfma_f32_16x16x32_bf16 v[208:211], a[144:147], a[184:187], v[208:211]
	s_add_u32 m0, s46, 54272
	ds_read_b64_tr_b16 a[134:135], v35 offset:4096
	v_mfma_f32_16x16x32_bf16 v[148:151], a[148:151], a[176:179], v[148:151]
	s_add_u32 s50, s36, 393216
	ds_read_b64_tr_b16 a[136:137], v34 offset:512
	v_mfma_f32_16x16x32_bf16 v[180:183], a[148:151], a[180:183], v[180:183]
	ds_read_b64_tr_b16 a[138:139], v34 offset:4608
	v_mfma_f32_16x16x32_bf16 v[212:215], a[148:151], a[184:187], v[212:215]
	buffer_load_dwordx4 v29, s[8:11], s50 offen lds
	v_mfma_f32_16x16x32_bf16 v[152:155], a[152:155], a[176:179], v[152:155]
	s_add_u32 m0, s47, 61440
	ds_read_b64_tr_b16 a[140:141], v35 offset:512
	v_mfma_f32_16x16x32_bf16 v[184:187], a[152:155], a[180:183], v[184:187]
	s_add_u32 s50, s37, 0
	ds_read_b64_tr_b16 a[142:143], v35 offset:4608
	v_mfma_f32_16x16x32_bf16 v[216:219], a[152:155], a[184:187], v[216:219]
	ds_read_b64_tr_b16 a[144:145], v36 offset:0
	v_mfma_f32_16x16x32_bf16 v[156:159], a[156:159], a[176:179], v[156:159]
	buffer_load_dwordx4 v28, s[4:7], s50 offen lds
	v_mfma_f32_16x16x32_bf16 v[188:191], a[156:159], a[180:183], v[188:191]
	s_add_u32 s36, s36, 524288
	ds_read_b64_tr_b16 a[146:147], v36 offset:4096
	v_mfma_f32_16x16x32_bf16 v[220:223], a[156:159], a[184:187], v[220:223]
	s_waitcnt lgkmcnt(8)
	ds_read_b64_tr_b16 a[148:149], v37 offset:0
	v_mfma_f32_16x16x32_bf16 v[128:131], a[128:131], a[160:163], v[128:131]
	s_add_u32 m0, s47, 65536
	ds_read_b64_tr_b16 a[150:151], v37 offset:4096
	v_mfma_f32_16x16x32_bf16 v[160:163], a[128:131], a[164:167], v[160:163]
	s_add_u32 s50, s37, 36864
	buffer_load_dwordx4 v28, s[4:7], s50 offen lds
	v_mfma_f32_16x16x32_bf16 v[192:195], a[128:131], a[168:171], v[192:195]
	s_sub_u32 s39, s36, 4718592
	ds_read_b64_tr_b16 a[152:153], v36 offset:512
	v_mfma_f32_16x16x32_bf16 v[224:227], a[128:131], a[172:175], v[224:227]
	s_waitcnt lgkmcnt(9)
	ds_read_b64_tr_b16 a[154:155], v36 offset:4608
	v_mfma_f32_16x16x32_bf16 v[132:135], a[132:135], a[160:163], v[132:135]
	s_add_u32 m0, s47, 69632
	ds_read_b128 a[176:179], v43 offset:0
	v_mfma_f32_16x16x32_bf16 v[164:167], a[132:135], a[164:167], v[164:167]
	s_add_u32 s50, s37, 73728
	buffer_load_dwordx4 v28, s[4:7], s50 offen lds
	v_mfma_f32_16x16x32_bf16 v[196:199], a[132:135], a[168:171], v[196:199]
	s_min_u32 s36, s36, s39
	ds_read_b64_tr_b16 a[156:157], v37 offset:512
	v_mfma_f32_16x16x32_bf16 v[228:231], a[132:135], a[172:175], v[228:231]
	s_waitcnt lgkmcnt(10)
	ds_read_b64_tr_b16 a[158:159], v37 offset:4608
	v_mfma_f32_16x16x32_bf16 v[136:139], a[136:139], a[160:163], v[136:139]
	s_add_u32 m0, s47, 73728
	ds_read_b128 a[180:183], v43 offset:2048
	v_mfma_f32_16x16x32_bf16 v[168:171], a[136:139], a[164:167], v[168:171]
	s_add_u32 s50, s37, 110592
	buffer_load_dwordx4 v28, s[4:7], s50 offen lds
	v_mfma_f32_16x16x32_bf16 v[200:203], a[136:139], a[168:171], v[200:203]
	s_add_u32 m0, s47, 77824
	ds_read_b128 a[184:187], v43 offset:4096
	v_mfma_f32_16x16x32_bf16 v[232:235], a[136:139], a[172:175], v[232:235]
	s_waitcnt lgkmcnt(11)
	ds_read_b128 a[188:191], v45 offset:0
	v_mfma_f32_16x16x32_bf16 v[140:143], a[140:143], a[160:163], v[140:143]
	s_add_u32 s50, s37, 147456
	ds_read_b64_tr_b16 a[128:129], v34 offset:8192
	v_mfma_f32_16x16x32_bf16 v[172:175], a[140:143], a[164:167], v[172:175]
	buffer_load_dwordx4 v28, s[4:7], s50 offen lds
	v_mfma_f32_16x16x32_bf16 v[204:207], a[140:143], a[168:171], v[204:207]
	s_add_u32 m0, s47, 81920
	ds_read_b64_tr_b16 a[130:131], v34 offset:12288
	v_mfma_f32_16x16x32_bf16 v[236:239], a[140:143], a[172:175], v[236:239]
	s_waitcnt lgkmcnt(12)
	ds_read_b64_tr_b16 a[132:133], v35 offset:8192
	v_mfma_f32_16x16x32_bf16 v[144:147], a[144:147], a[160:163], v[144:147]
	s_add_u32 s50, s37, 184320
	ds_read_b64_tr_b16 a[134:135], v35 offset:12288
	v_mfma_f32_16x16x32_bf16 v[176:179], a[144:147], a[164:167], v[176:179]
	buffer_load_dwordx4 v28, s[4:7], s50 offen lds
	v_mfma_f32_16x16x32_bf16 v[208:211], a[144:147], a[168:171], v[208:211]
	s_waitcnt lgkmcnt(12)
	ds_read_b64_tr_b16 a[136:137], v34 offset:8704
	v_mfma_f32_16x16x32_bf16 v[148:151], a[148:151], a[160:163], v[148:151]
	s_add_u32 m0, s47, 86016
	ds_read_b64_tr_b16 a[138:139], v34 offset:12800
	v_mfma_f32_16x16x32_bf16 v[180:183], a[148:151], a[164:167], v[180:183]
	s_add_u32 s50, s37, 221184
	ds_read_b64_tr_b16 a[140:141], v35 offset:8704
	v_mfma_f32_16x16x32_bf16 v[212:215], a[148:151], a[168:171], v[212:215]
	s_waitcnt lgkmcnt(13)
	buffer_load_dwordx4 v28, s[4:7], s50 offen lds
	v_mfma_f32_16x16x32_bf16 v[152:155], a[152:155], a[160:163], v[152:155]
	ds_read_b64_tr_b16 a[142:143], v35 offset:12800
	v_mfma_f32_16x16x32_bf16 v[184:187], a[152:155], a[164:167], v[184:187]
	ds_read_b64_tr_b16 a[144:145], v36 offset:8192
	v_mfma_f32_16x16x32_bf16 v[216:219], a[152:155], a[168:171], v[216:219]
	s_waitcnt lgkmcnt(12)
	ds_read_b64_tr_b16 a[146:147], v36 offset:12288
	v_mfma_f32_16x16x32_bf16 v[156:159], a[156:159], a[160:163], v[156:159]
	ds_read_b64_tr_b16 a[148:149], v37 offset:8192
	v_mfma_f32_16x16x32_bf16 v[188:191], a[156:159], a[164:167], v[188:191]
	ds_read_b64_tr_b16 a[150:151], v37 offset:12288
	v_mfma_f32_16x16x32_bf16 v[220:223], a[156:159], a[168:171], v[220:223]
	s_waitcnt lgkmcnt(10)
	ds_read_b64_tr_b16 a[152:153], v36 offset:8704
	v_mfma_f32_16x16x32_bf16 v[128:131], a[128:131], a[176:179], v[128:131]
	ds_read_b64_tr_b16 a[154:155], v36 offset:12800
	v_mfma_f32_16x16x32_bf16 v[160:163], a[128:131], a[180:183], v[160:163]
	ds_read_b64_tr_b16 a[156:157], v37 offset:8704
	ds_read_b64_tr_b16 a[158:159], v37 offset:12800
	v_mfma_f32_16x16x32_bf16 v[192:195], a[128:131], a[184:187], v[192:195]
	v_add_u32 v34, 0, v30
	v_add_u32 v35, 0, v31
	v_mfma_f32_16x16x32_bf16 v[224:227], a[128:131], a[188:191], v[224:227]
	s_waitcnt lgkmcnt(12)
	v_add_u32 v36, 0, v32
	v_add_u32 v37, 0, v33
	v_mfma_f32_16x16x32_bf16 v[132:135], a[132:135], a[176:179], v[132:135]
	v_add_u32 v42, 0, v38
	v_add_u32 v43, 0, v39
	v_mfma_f32_16x16x32_bf16 v[164:167], a[132:135], a[180:183], v[164:167]
	v_add_u32 v44, 0, v40
	v_add_u32 v45, 0, v41
	v_mfma_f32_16x16x32_bf16 v[196:199], a[132:135], a[184:187], v[196:199]
	s_add_u32 s37, s37, 128
	v_mfma_f32_16x16x32_bf16 v[228:231], a[132:135], a[188:191], v[228:231]
	s_waitcnt lgkmcnt(10)
	v_mfma_f32_16x16x32_bf16 v[136:139], a[136:139], a[176:179], v[136:139]
	s_waitcnt vmcnt(11) lgkmcnt(0)
	s_barrier
	ds_read_b128 a[160:163], v42 offset:0
	v_mfma_f32_16x16x32_bf16 v[168:171], a[136:139], a[180:183], v[168:171]
	s_add_u32 m0, s46, 90112
	s_add_u32 s50, s36, 0
	buffer_load_dwordx4 v29, s[8:11], s50 offen lds
	v_mfma_f32_16x16x32_bf16 v[200:203], a[136:139], a[184:187], v[200:203]
	s_sub_u32 s39, s37, 1152
	ds_read_b128 a[164:167], v42 offset:2048
	v_mfma_f32_16x16x32_bf16 v[232:235], a[136:139], a[188:191], v[232:235]
	s_add_u32 m0, s46, 91136
	ds_read_b128 a[168:171], v42 offset:4096
	v_mfma_f32_16x16x32_bf16 v[140:143], a[140:143], a[176:179], v[140:143]
	s_add_u32 s50, s36, 131072
	ds_read_b128 a[172:175], v44 offset:0
	v_mfma_f32_16x16x32_bf16 v[172:175], a[140:143], a[180:183], v[172:175]
	buffer_load_dwordx4 v29, s[8:11], s50 offen lds
	v_mfma_f32_16x16x32_bf16 v[204:207], a[140:143], a[184:187], v[204:207]
	s_min_u32 s37, s37, s39
	ds_read_b64_tr_b16 a[128:129], v34 offset:0
	v_mfma_f32_16x16x32_bf16 v[236:239], a[140:143], a[188:191], v[236:239]
	s_add_u32 m0, s46, 98304
	ds_read_b64_tr_b16 a[130:131], v34 offset:4096
	v_mfma_f32_16x16x32_bf16 v[144:147], a[144:147], a[176:179], v[144:147]
	s_add_u32 s50, s36, 262144
	ds_read_b64_tr_b16 a[132:133], v35 offset:0
	v_mfma_f32_16x16x32_bf16 v[176:179], a[144:147], a[180:183], v[176:179]
	buffer_load_dwordx4 v29, s[8:11], s50 offen lds
	v_mfma_f32_16x16x32_bf16 v[208:211], a[144:147], a[184:187], v[208:211]
	s_add_u32 m0, s46, 99328
	ds_read_b64_tr_b16 a[134:135], v35 offset:4096
	v_mfma_f32_16x16x32_bf16 v[148:151], a[148:151], a[176:179], v[148:151]
	s_add_u32 s50, s36, 393216
	ds_read_b64_tr_b16 a[136:137], v34 offset:512
	v_mfma_f32_16x16x32_bf16 v[180:183], a[148:151], a[180:183], v[180:183]
	ds_read_b64_tr_b16 a[138:139], v34 offset:4608
	v_mfma_f32_16x16x32_bf16 v[212:215], a[148:151], a[184:187], v[212:215]
	buffer_load_dwordx4 v29, s[8:11], s50 offen lds
	v_mfma_f32_16x16x32_bf16 v[152:155], a[152:155], a[176:179], v[152:155]
	s_add_u32 m0, s47, 106496
	ds_read_b64_tr_b16 a[140:141], v35 offset:512
	v_mfma_f32_16x16x32_bf16 v[184:187], a[152:155], a[180:183], v[184:187]
	s_add_u32 s50, s37, 0
	ds_read_b64_tr_b16 a[142:143], v35 offset:4608
	v_mfma_f32_16x16x32_bf16 v[216:219], a[152:155], a[184:187], v[216:219]
	ds_read_b64_tr_b16 a[144:145], v36 offset:0
	v_mfma_f32_16x16x32_bf16 v[156:159], a[156:159], a[176:179], v[156:159]
	buffer_load_dwordx4 v28, s[4:7], s50 offen lds
	v_mfma_f32_16x16x32_bf16 v[188:191], a[156:159], a[180:183], v[188:191]
	s_add_u32 s36, s36, 524288
	ds_read_b64_tr_b16 a[146:147], v36 offset:4096
	v_mfma_f32_16x16x32_bf16 v[220:223], a[156:159], a[184:187], v[220:223]
	s_waitcnt lgkmcnt(8)
	ds_read_b64_tr_b16 a[148:149], v37 offset:0
	v_mfma_f32_16x16x32_bf16 v[128:131], a[128:131], a[160:163], v[128:131]
	s_add_u32 m0, s47, 110592
	ds_read_b64_tr_b16 a[150:151], v37 offset:4096
	v_mfma_f32_16x16x32_bf16 v[160:163], a[128:131], a[164:167], v[160:163]
	s_add_u32 s50, s37, 36864
	buffer_load_dwordx4 v28, s[4:7], s50 offen lds
	v_mfma_f32_16x16x32_bf16 v[192:195], a[128:131], a[168:171], v[192:195]
	s_sub_u32 s39, s36, 4718592
	ds_read_b64_tr_b16 a[152:153], v36 offset:512
	v_mfma_f32_16x16x32_bf16 v[224:227], a[128:131], a[172:175], v[224:227]
	s_waitcnt lgkmcnt(9)
	ds_read_b64_tr_b16 a[154:155], v36 offset:4608
	v_mfma_f32_16x16x32_bf16 v[132:135], a[132:135], a[160:163], v[132:135]
	s_add_u32 m0, s47, 114688
	ds_read_b128 a[176:179], v43 offset:0
	v_mfma_f32_16x16x32_bf16 v[164:167], a[132:135], a[164:167], v[164:167]
	s_add_u32 s50, s37, 73728
	buffer_load_dwordx4 v28, s[4:7], s50 offen lds
	v_mfma_f32_16x16x32_bf16 v[196:199], a[132:135], a[168:171], v[196:199]
	s_min_u32 s36, s36, s39
	ds_read_b64_tr_b16 a[156:157], v37 offset:512
	v_mfma_f32_16x16x32_bf16 v[228:231], a[132:135], a[172:175], v[228:231]
	s_waitcnt lgkmcnt(10)
	ds_read_b64_tr_b16 a[158:159], v37 offset:4608
	v_mfma_f32_16x16x32_bf16 v[136:139], a[136:139], a[160:163], v[136:139]
	s_add_u32 m0, s47, 118784
	ds_read_b128 a[180:183], v43 offset:2048
	v_mfma_f32_16x16x32_bf16 v[168:171], a[136:139], a[164:167], v[168:171]
	s_add_u32 s50, s37, 110592
	buffer_load_dwordx4 v28, s[4:7], s50 offen lds
	v_mfma_f32_16x16x32_bf16 v[200:203], a[136:139], a[168:171], v[200:203]
	s_add_u32 m0, s47, 122880
	ds_read_b128 a[184:187], v43 offset:4096
	v_mfma_f32_16x16x32_bf16 v[232:235], a[136:139], a[172:175], v[232:235]
	s_waitcnt lgkmcnt(11)
	ds_read_b128 a[188:191], v45 offset:0
	v_mfma_f32_16x16x32_bf16 v[140:143], a[140:143], a[160:163], v[140:143]
	s_add_u32 s50, s37, 147456
	ds_read_b64_tr_b16 a[128:129], v34 offset:8192
	v_mfma_f32_16x16x32_bf16 v[172:175], a[140:143], a[164:167], v[172:175]
	buffer_load_dwordx4 v28, s[4:7], s50 offen lds
	v_mfma_f32_16x16x32_bf16 v[204:207], a[140:143], a[168:171], v[204:207]
	s_add_u32 m0, s47, 126976
	ds_read_b64_tr_b16 a[130:131], v34 offset:12288
	v_mfma_f32_16x16x32_bf16 v[236:239], a[140:143], a[172:175], v[236:239]
	s_waitcnt lgkmcnt(12)
	ds_read_b64_tr_b16 a[132:133], v35 offset:8192
	v_mfma_f32_16x16x32_bf16 v[144:147], a[144:147], a[160:163], v[144:147]
	s_add_u32 s50, s37, 184320
	ds_read_b64_tr_b16 a[134:135], v35 offset:12288
	v_mfma_f32_16x16x32_bf16 v[176:179], a[144:147], a[164:167], v[176:179]
	buffer_load_dwordx4 v28, s[4:7], s50 offen lds
	v_mfma_f32_16x16x32_bf16 v[208:211], a[144:147], a[168:171], v[208:211]
	s_waitcnt lgkmcnt(12)
	ds_read_b64_tr_b16 a[136:137], v34 offset:8704
	v_mfma_f32_16x16x32_bf16 v[148:151], a[148:151], a[160:163], v[148:151]
	s_add_u32 m0, s47, 131072
	ds_read_b64_tr_b16 a[138:139], v34 offset:12800
	v_mfma_f32_16x16x32_bf16 v[180:183], a[148:151], a[164:167], v[180:183]
	s_add_u32 s50, s37, 221184
	ds_read_b64_tr_b16 a[140:141], v35 offset:8704
	v_mfma_f32_16x16x32_bf16 v[212:215], a[148:151], a[168:171], v[212:215]
	s_waitcnt lgkmcnt(13)
	buffer_load_dwordx4 v28, s[4:7], s50 offen lds
	v_mfma_f32_16x16x32_bf16 v[152:155], a[152:155], a[160:163], v[152:155]
	s_mul_i32 s70, s2, 18432
	ds_read_b64_tr_b16 a[142:143], v35 offset:12800
	v_mfma_f32_16x16x32_bf16 v[184:187], a[152:155], a[164:167], v[184:187]
	ds_read_b64_tr_b16 a[144:145], v36 offset:8192
	v_mfma_f32_16x16x32_bf16 v[216:219], a[152:155], a[168:171], v[216:219]
	s_waitcnt lgkmcnt(12)
	ds_read_b64_tr_b16 a[146:147], v36 offset:12288
	v_mfma_f32_16x16x32_bf16 v[156:159], a[156:159], a[160:163], v[156:159]
	buffer_load_dword v61, v60, s[24:27], s70 offen
	v_mfma_f32_16x16x32_bf16 v[188:191], a[156:159], a[164:167], v[188:191]
	ds_read_b64_tr_b16 a[148:149], v37 offset:8192
	v_mfma_f32_16x16x32_bf16 v[220:223], a[156:159], a[168:171], v[220:223]
	s_waitcnt lgkmcnt(9)
	ds_read_b64_tr_b16 a[150:151], v37 offset:12288
	v_mfma_f32_16x16x32_bf16 v[128:131], a[128:131], a[176:179], v[128:131]
	ds_read_b64_tr_b16 a[152:153], v36 offset:8704
	v_mfma_f32_16x16x32_bf16 v[160:163], a[128:131], a[180:183], v[160:163]
	ds_read_b64_tr_b16 a[154:155], v36 offset:12800
	ds_read_b64_tr_b16 a[156:157], v37 offset:8704
	ds_read_b64_tr_b16 a[158:159], v37 offset:12800
	v_mfma_f32_16x16x32_bf16 v[192:195], a[128:131], a[184:187], v[192:195]
	v_add_u32 v34, 45056, v30
	v_add_u32 v35, 45056, v31
	v_mfma_f32_16x16x32_bf16 v[224:227], a[128:131], a[188:191], v[224:227]
	s_waitcnt lgkmcnt(12)
	v_add_u32 v36, 45056, v32
	v_add_u32 v37, 45056, v33
	v_mfma_f32_16x16x32_bf16 v[132:135], a[132:135], a[176:179], v[132:135]
	v_add_u32 v42, 45056, v38
	v_add_u32 v43, 45056, v39
	v_mfma_f32_16x16x32_bf16 v[164:167], a[132:135], a[180:183], v[164:167]
	v_add_u32 v44, 45056, v40
	v_add_u32 v45, 45056, v41
	v_mfma_f32_16x16x32_bf16 v[196:199], a[132:135], a[184:187], v[196:199]
	s_add_u32 m0, s48, 0
	v_mfma_f32_16x16x32_bf16 v[228:231], a[132:135], a[188:191], v[228:231]
	s_waitcnt lgkmcnt(10)
	v_mfma_f32_16x16x32_bf16 v[136:139], a[136:139], a[176:179], v[136:139]
	s_waitcnt vmcnt(12) lgkmcnt(0)
	s_barrier
	ds_read_b128 a[160:163], v42 offset:0
	v_mfma_f32_16x16x32_bf16 v[168:171], a[136:139], a[180:183], v[168:171]
	s_add_u32 s49, s63, 0
	s_and_b32 s49, s49, 0x1ffff
	buffer_load_dwordx4 v3, s[12:15], s49 offen nt lds
	v_mfma_f32_16x16x32_bf16 v[200:203], a[136:139], a[184:187], v[200:203]
	ds_read_b128 a[164:167], v42 offset:2048
	v_mfma_f32_16x16x32_bf16 v[232:235], a[136:139], a[188:191], v[232:235]
	ds_read_b128 a[168:171], v42 offset:4096
	v_mfma_f32_16x16x32_bf16 v[140:143], a[140:143], a[176:179], v[140:143]
	ds_read_b128 a[172:175], v44 offset:0
	v_mfma_f32_16x16x32_bf16 v[172:175], a[140:143], a[180:183], v[172:175]
	ds_read_b64_tr_b16 a[128:129], v34 offset:0
	v_mfma_f32_16x16x32_bf16 v[204:207], a[140:143], a[184:187], v[204:207]
	buffer_load_dwordx4 v3, s[12:15], s49 offen offset:2048 nt lds
	v_mfma_f32_16x16x32_bf16 v[236:239], a[140:143], a[188:191], v[236:239]
	ds_read_b64_tr_b16 a[130:131], v34 offset:4096
	v_mfma_f32_16x16x32_bf16 v[144:147], a[144:147], a[176:179], v[144:147]
	s_add_u32 m0, s48, 8192
	ds_read_b64_tr_b16 a[132:133], v35 offset:0
	v_mfma_f32_16x16x32_bf16 v[176:179], a[144:147], a[180:183], v[176:179]
	ds_read_b64_tr_b16 a[134:135], v35 offset:4096
	v_mfma_f32_16x16x32_bf16 v[208:211], a[144:147], a[184:187], v[208:211]
	ds_read_b64_tr_b16 a[136:137], v34 offset:512
	v_mfma_f32_16x16x32_bf16 v[148:151], a[148:151], a[176:179], v[148:151]
	buffer_load_dwordx4 v4, s[16:19], s49 offen nt lds
	v_mfma_f32_16x16x32_bf16 v[180:183], a[148:151], a[180:183], v[180:183]
	ds_read_b64_tr_b16 a[138:139], v34 offset:4608
	v_mfma_f32_16x16x32_bf16 v[212:215], a[148:151], a[184:187], v[212:215]
	ds_read_b64_tr_b16 a[140:141], v35 offset:512
	v_mfma_f32_16x16x32_bf16 v[152:155], a[152:155], a[176:179], v[152:155]
	ds_read_b64_tr_b16 a[142:143], v35 offset:4608
	v_mfma_f32_16x16x32_bf16 v[184:187], a[152:155], a[180:183], v[184:187]
	ds_read_b64_tr_b16 a[144:145], v36 offset:0
	v_mfma_f32_16x16x32_bf16 v[216:219], a[152:155], a[184:187], v[216:219]
	buffer_load_dwordx4 v4, s[16:19], s49 offen offset:2048 nt lds
	v_mfma_f32_16x16x32_bf16 v[156:159], a[156:159], a[176:179], v[156:159]
	ds_read_b64_tr_b16 a[146:147], v36 offset:4096
	v_mfma_f32_16x16x32_bf16 v[188:191], a[156:159], a[180:183], v[188:191]
	s_add_u32 m0, s48, 16384
	ds_read_b64_tr_b16 a[148:149], v37 offset:0
	v_mfma_f32_16x16x32_bf16 v[220:223], a[156:159], a[184:187], v[220:223]
	s_waitcnt lgkmcnt(9)
	ds_read_b64_tr_b16 a[150:151], v37 offset:4096
	v_mfma_f32_16x16x32_bf16 v[128:131], a[128:131], a[160:163], v[128:131]
	s_add_u32 s49, s63, 8192
	ds_read_b64_tr_b16 a[152:153], v36 offset:512
	v_mfma_f32_16x16x32_bf16 v[160:163], a[128:131], a[164:167], v[160:163]
	s_and_b32 s49, s49, 0x1ffff
	buffer_load_dwordx4 v3, s[12:15], s49 offen nt lds
	v_mfma_f32_16x16x32_bf16 v[192:195], a[128:131], a[168:171], v[192:195]
	ds_read_b64_tr_b16 a[154:155], v36 offset:4608
	v_mfma_f32_16x16x32_bf16 v[224:227], a[128:131], a[172:175], v[224:227]
	s_waitcnt lgkmcnt(10)
	ds_read_b128 a[176:179], v43 offset:0
	v_mfma_f32_16x16x32_bf16 v[132:135], a[132:135], a[160:163], v[132:135]
	ds_read_b64_tr_b16 a[156:157], v37 offset:512
	v_mfma_f32_16x16x32_bf16 v[164:167], a[132:135], a[164:167], v[164:167]
	ds_read_b64_tr_b16 a[158:159], v37 offset:4608
	v_mfma_f32_16x16x32_bf16 v[196:199], a[132:135], a[168:171], v[196:199]
	buffer_load_dwordx4 v3, s[12:15], s49 offen offset:2048 nt lds
	v_mfma_f32_16x16x32_bf16 v[228:231], a[132:135], a[172:175], v[228:231]
	s_waitcnt lgkmcnt(11)
	ds_read_b128 a[180:183], v43 offset:2048
	v_mfma_f32_16x16x32_bf16 v[136:139], a[136:139], a[160:163], v[136:139]
	s_add_u32 m0, s48, 24576
	ds_read_b128 a[184:187], v43 offset:4096
	v_mfma_f32_16x16x32_bf16 v[168:171], a[136:139], a[164:167], v[168:171]
	ds_read_b128 a[188:191], v45 offset:0
	v_mfma_f32_16x16x32_bf16 v[200:203], a[136:139], a[168:171], v[200:203]
	ds_read_b64_tr_b16 a[128:129], v34 offset:8192
	v_mfma_f32_16x16x32_bf16 v[232:235], a[136:139], a[172:175], v[232:235]
	s_waitcnt lgkmcnt(13)
	buffer_load_dwordx4 v4, s[16:19], s49 offen nt lds
	v_mfma_f32_16x16x32_bf16 v[140:143], a[140:143], a[160:163], v[140:143]
	ds_read_b64_tr_b16 a[130:131], v34 offset:12288
	v_mfma_f32_16x16x32_bf16 v[172:175], a[140:143], a[164:167], v[172:175]
	ds_read_b64_tr_b16 a[132:133], v35 offset:8192
	v_mfma_f32_16x16x32_bf16 v[204:207], a[140:143], a[168:171], v[204:207]
	ds_read_b64_tr_b16 a[134:135], v35 offset:12288
	v_mfma_f32_16x16x32_bf16 v[236:239], a[140:143], a[172:175], v[236:239]
	s_waitcnt lgkmcnt(14)
	ds_read_b64_tr_b16 a[136:137], v34 offset:8704
	v_mfma_f32_16x16x32_bf16 v[144:147], a[144:147], a[160:163], v[144:147]
	buffer_load_dwordx4 v4, s[16:19], s49 offen offset:2048 nt lds
	v_mfma_f32_16x16x32_bf16 v[176:179], a[144:147], a[164:167], v[176:179]
	ds_read_b64_tr_b16 a[138:139], v34 offset:12800
	v_mfma_f32_16x16x32_bf16 v[208:211], a[144:147], a[168:171], v[208:211]
	s_waitcnt lgkmcnt(14)
	ds_read_b64_tr_b16 a[140:141], v35 offset:8704
	v_mfma_f32_16x16x32_bf16 v[148:151], a[148:151], a[160:163], v[148:151]
	ds_read_b64_tr_b16 a[142:143], v35 offset:12800
	v_mfma_f32_16x16x32_bf16 v[180:183], a[148:151], a[164:167], v[180:183]
	ds_read_b64_tr_b16 a[144:145], v36 offset:8192
	v_mfma_f32_16x16x32_bf16 v[212:215], a[148:151], a[168:171], v[212:215]
	s_waitcnt lgkmcnt(15)
	ds_read_b64_tr_b16 a[146:147], v36 offset:12288
	v_mfma_f32_16x16x32_bf16 v[152:155], a[152:155], a[160:163], v[152:155]
	ds_read_b64_tr_b16 a[148:149], v37 offset:8192
	v_mfma_f32_16x16x32_bf16 v[184:187], a[152:155], a[164:167], v[184:187]
	ds_read_b64_tr_b16 a[150:151], v37 offset:12288
	v_mfma_f32_16x16x32_bf16 v[216:219], a[152:155], a[168:171], v[216:219]
	s_waitcnt lgkmcnt(15)
	ds_read_b64_tr_b16 a[152:153], v36 offset:8704
	v_mfma_f32_16x16x32_bf16 v[156:159], a[156:159], a[160:163], v[156:159]
	ds_read_b64_tr_b16 a[154:155], v36 offset:12800
	v_mfma_f32_16x16x32_bf16 v[188:191], a[156:159], a[164:167], v[188:191]
	v_mfma_f32_16x16x32_bf16 v[220:223], a[156:159], a[168:171], v[220:223]
	s_waitcnt lgkmcnt(12)
	ds_read_b64_tr_b16 a[156:157], v37 offset:8704
	v_mfma_f32_16x16x32_bf16 v[128:131], a[128:131], a[176:179], v[128:131]
	ds_read_b64_tr_b16 a[158:159], v37 offset:12800
	v_mfma_f32_16x16x32_bf16 v[160:163], a[128:131], a[180:183], v[160:163]
	v_mfma_f32_16x16x32_bf16 v[192:195], a[128:131], a[184:187], v[192:195]
	v_add_u32 v34, 90112, v30
	v_add_u32 v35, 90112, v31
	v_mfma_f32_16x16x32_bf16 v[224:227], a[128:131], a[188:191], v[224:227]
	s_waitcnt lgkmcnt(12)
	v_add_u32 v36, 90112, v32
	v_add_u32 v37, 90112, v33
	v_mfma_f32_16x16x32_bf16 v[132:135], a[132:135], a[176:179], v[132:135]
	v_add_u32 v42, 90112, v38
	v_add_u32 v43, 90112, v39
	v_mfma_f32_16x16x32_bf16 v[164:167], a[132:135], a[180:183], v[164:167]
	v_add_u32 v44, 90112, v40
	v_add_u32 v45, 90112, v41
	v_mfma_f32_16x16x32_bf16 v[196:199], a[132:135], a[184:187], v[196:199]
	s_add_u32 m0, s48, 32768
	v_mfma_f32_16x16x32_bf16 v[228:231], a[132:135], a[188:191], v[228:231]
	s_waitcnt lgkmcnt(10)
	v_mfma_f32_16x16x32_bf16 v[136:139], a[136:139], a[176:179], v[136:139]
	s_waitcnt vmcnt(9) lgkmcnt(0)
	s_barrier
	ds_read_b64_tr_b16 a[192:193], v34 offset:0
	v_mfma_f32_16x16x32_bf16 v[168:171], a[136:139], a[180:183], v[168:171]
	s_add_u32 s49, s63, 16384
	s_and_b32 s49, s49, 0x1ffff
	buffer_load_dwordx4 v3, s[12:15], s49 offen nt lds
	v_mfma_f32_16x16x32_bf16 v[200:203], a[136:139], a[184:187], v[200:203]
	ds_read_b64_tr_b16 a[194:195], v34 offset:4096
	v_mfma_f32_16x16x32_bf16 v[232:235], a[136:139], a[188:191], v[232:235]
	ds_read_b128 a[172:175], v44 offset:0
	v_mfma_f32_16x16x32_bf16 v[140:143], a[140:143], a[176:179], v[140:143]
	ds_read_b64_tr_b16 a[196:197], v35 offset:0
	v_mfma_f32_16x16x32_bf16 v[172:175], a[140:143], a[180:183], v[172:175]
	ds_read_b64_tr_b16 a[198:199], v35 offset:4096
	v_mfma_f32_16x16x32_bf16 v[204:207], a[140:143], a[184:187], v[204:207]
	ds_read_b64_tr_b16 a[200:201], v34 offset:512
	v_mfma_f32_16x16x32_bf16 v[236:239], a[140:143], a[188:191], v[236:239]
	ds_read_b64_tr_b16 a[202:203], v34 offset:4608
	v_mfma_f32_16x16x32_bf16 v[144:147], a[144:147], a[176:179], v[144:147]
	ds_read_b64_tr_b16 a[204:205], v35 offset:512
	v_mfma_f32_16x16x32_bf16 v[176:179], a[144:147], a[180:183], v[176:179]
	buffer_load_dwordx4 v3, s[12:15], s49 offen offset:2048 nt lds
	v_mfma_f32_16x16x32_bf16 v[208:211], a[144:147], a[184:187], v[208:211]
	ds_read_b64_tr_b16 a[206:207], v35 offset:4608
	v_mfma_f32_16x16x32_bf16 v[148:151], a[148:151], a[176:179], v[148:151]
	ds_read_b64_tr_b16 a[128:129], v34 offset:8192
	v_mfma_f32_16x16x32_bf16 v[180:183], a[148:151], a[180:183], v[180:183]
	ds_read_b64_tr_b16 a[130:131], v34 offset:12288
	v_mfma_f32_16x16x32_bf16 v[212:215], a[148:151], a[184:187], v[212:215]
	ds_read_b128 a[236:239], v45 offset:0
	v_mfma_f32_16x16x32_bf16 v[152:155], a[152:155], a[176:179], v[152:155]
	ds_read_b64_tr_b16 a[132:133], v35 offset:8192
	v_mfma_f32_16x16x32_bf16 v[184:187], a[152:155], a[180:183], v[184:187]
	ds_read_b64_tr_b16 a[134:135], v35 offset:12288
	v_mfma_f32_16x16x32_bf16 v[216:219], a[152:155], a[184:187], v[216:219]
	s_add_u32 m0, s48, 40960
	ds_read_b64_tr_b16 a[136:137], v34 offset:8704
	ds_read_b64_tr_b16 a[138:139], v34 offset:12800
	v_mfma_f32_16x16x32_bf16 v[156:159], a[156:159], a[176:179], v[156:159]
	ds_read_b64_tr_b16 a[140:141], v35 offset:8704
	ds_read_b64_tr_b16 a[142:143], v35 offset:12800
	v_mfma_f32_16x16x32_bf16 v[188:191], a[156:159], a[180:183], v[188:191]
	ds_read_b128 a[160:163], v42 offset:0
	v_mfma_f32_16x16x32_bf16 v[220:223], a[156:159], a[184:187], v[220:223]
	s_waitcnt lgkmcnt(15)
	buffer_load_dwordx4 v4, s[16:19], s49 offen nt lds
	v_mfma_f32_16x16x32_bf16 v[224:227], a[192:195], a[172:175], v[224:227]
	s_waitcnt lgkmcnt(14)
	ds_read_b64_tr_b16 a[208:209], v36 offset:0
	v_mfma_f32_16x16x32_bf16 v[228:231], a[196:199], a[172:175], v[228:231]
	s_waitcnt lgkmcnt(13)
	ds_read_b64_tr_b16 a[210:211], v36 offset:4096
	v_mfma_f32_16x16x32_bf16 v[232:235], a[200:203], a[172:175], v[232:235]
	s_waitcnt lgkmcnt(12)
	ds_read_b64_tr_b16 a[212:213], v37 offset:0
	v_mfma_f32_16x16x32_bf16 v[236:239], a[204:207], a[172:175], v[236:239]
	s_waitcnt lgkmcnt(10)
	ds_read_b64_tr_b16 a[214:215], v37 offset:4096
	v_mfma_f32_16x16x32_bf16 v[224:227], a[128:131], a[236:239], v[224:227]
	s_waitcnt lgkmcnt(9)
	ds_read_b64_tr_b16 a[216:217], v36 offset:512
	ds_read_b64_tr_b16 a[218:219], v36 offset:4608
	v_mfma_f32_16x16x32_bf16 v[228:231], a[132:135], a[236:239], v[228:231]
	s_waitcnt lgkmcnt(9)
	ds_read_b64_tr_b16 a[220:221], v37 offset:512
	ds_read_b64_tr_b16 a[222:223], v37 offset:4608
	v_mfma_f32_16x16x32_bf16 v[232:235], a[136:139], a[236:239], v[232:235]
	s_waitcnt lgkmcnt(9)
	ds_read_b128 a[224:227], v43 offset:0
	v_mfma_f32_16x16x32_bf16 v[236:239], a[140:143], a[236:239], v[236:239]
	s_waitcnt lgkmcnt(9)
	buffer_load_dwordx4 v4, s[16:19], s49 offen offset:2048 nt lds
	v_mfma_f32_16x16x32_bf16 v[128:131], a[192:195], a[160:163], v[128:131]
	ds_read_b64_tr_b16 a[144:145], v36 offset:8192
	v_mul_f32 v224, s56, v224
	v_mul_f32 v225, s56, v225
	v_mfma_f32_16x16x32_bf16 v[132:135], a[196:199], a[160:163], v[132:135]
	ds_read_b64_tr_b16 a[146:147], v36 offset:12288
	v_mul_f32 v226, s56, v226
	v_mul_f32 v227, s56, v227
	v_mfma_f32_16x16x32_bf16 v[136:139], a[200:203], a[160:163], v[136:139]
	ds_read_b64_tr_b16 a[148:149], v37 offset:8192
	v_mul_f32 v228, s56, v228
	v_mul_f32 v229, s56, v229
	v_mfma_f32_16x16x32_bf16 v[140:143], a[204:207], a[160:163], v[140:143]
	s_waitcnt lgkmcnt(10)
	ds_read_b64_tr_b16 a[150:151], v37 offset:12288
	v_mul_f32 v230, s56, v230
	v_mul_f32 v231, s56, v231
	v_mfma_f32_16x16x32_bf16 v[144:147], a[208:211], a[160:163], v[144:147]
	s_waitcnt lgkmcnt(9)
	ds_read_b64_tr_b16 a[152:153], v36 offset:8704
	ds_read_b64_tr_b16 a[154:155], v36 offset:12800
	v_mul_f32 v232, s56, v232
	v_mfma_f32_16x16x32_bf16 v[148:151], a[212:215], a[160:163], v[148:151]
	s_waitcnt lgkmcnt(9)
	ds_read_b64_tr_b16 a[156:157], v37 offset:8704
	ds_read_b64_tr_b16 a[158:159], v37 offset:12800
	v_mul_f32 v233, s56, v233
	v_mfma_f32_16x16x32_bf16 v[152:155], a[216:219], a[160:163], v[152:155]
	s_waitcnt lgkmcnt(9)
	ds_read_b128 a[164:167], v42 offset:2048
	v_mul_f32 v234, s56, v234
	v_mul_f32 v235, s56, v235
	v_mfma_f32_16x16x32_bf16 v[156:159], a[220:223], a[160:163], v[156:159]
	s_waitcnt lgkmcnt(9)
	ds_read_b128 a[228:231], v43 offset:2048
	v_mul_f32 v236, s56, v236
	v_mul_f32 v237, s56, v237
	v_mfma_f32_16x16x32_bf16 v[128:131], a[128:131], a[224:227], v[128:131]
	ds_read_b128 a[168:171], v42 offset:4096
	v_mul_f32 v238, s56, v238
	v_mul_f32 v239, s56, v239
	v_mfma_f32_16x16x32_bf16 v[132:135], a[132:135], a[224:227], v[132:135]
	v_cvt_pk_bf16_f32 v112, v224, v225
	v_cvt_pk_bf16_f32 v113, v226, v227
	v_cvt_pk_bf16_f32 v114, v228, v229
	v_mfma_f32_16x16x32_bf16 v[136:139], a[136:139], a[224:227], v[136:139]
	v_cvt_pk_bf16_f32 v115, v230, v231
	v_cvt_pk_bf16_f32 v116, v232, v233
	v_cvt_pk_bf16_f32 v117, v234, v235
	v_mfma_f32_16x16x32_bf16 v[140:143], a[140:143], a[224:227], v[140:143]
	s_waitcnt lgkmcnt(9)
	ds_read_b128 a[232:235], v43 offset:4096
	v_cvt_pk_bf16_f32 v118, v236, v237
	v_cvt_pk_bf16_f32 v119, v238, v239
	v_mfma_f32_16x16x32_bf16 v[144:147], a[144:147], a[224:227], v[144:147]
	s_waitcnt lgkmcnt(8)
	v_permlane16_swap_b32 v112, v114
	v_permlane16_swap_b32 v113, v115
	v_permlane16_swap_b32 v116, v118
	v_mfma_f32_16x16x32_bf16 v[148:151], a[148:151], a[224:227], v[148:151]
	s_waitcnt lgkmcnt(6)
	ds_write_b128 v62, v[112:115] offset:0
	v_permlane16_swap_b32 v117, v119
	v_mul_f32 v128, s56, v128
	v_mfma_f32_16x16x32_bf16 v[152:155], a[152:155], a[224:227], v[152:155]
	s_waitcnt lgkmcnt(5)
	ds_write_b128 v62, v[116:119] offset:1024
	v_mul_f32 v129, s56, v129
	v_mul_f32 v130, s56, v130
	v_mfma_f32_16x16x32_bf16 v[156:159], a[156:159], a[224:227], v[156:159]
	s_waitcnt lgkmcnt(5)
	v_mul_f32 v131, s56, v131
	v_mul_f32 v132, s56, v132
	v_mul_f32 v133, s56, v133
	v_mfma_f32_16x16x32_bf16 v[160:163], a[192:195], a[164:167], v[160:163]
	v_cvt_pk_bf16_f32 v64, v128, v129
	v_mul_f32 v134, s56, v134
	v_mul_f32 v135, s56, v135
	v_mfma_f32_16x16x32_bf16 v[164:167], a[196:199], a[164:167], v[164:167]
	v_cvt_pk_bf16_f32 v65, v130, v131
	v_cvt_pk_bf16_f32 v66, v132, v133
	v_cvt_pk_bf16_f32 v67, v134, v135
	v_mfma_f32_16x16x32_bf16 v[168:171], a[200:203], a[164:167], v[168:171]
	v_mul_f32 v136, s56, v136
	v_mul_f32 v137, s56, v137
	v_mul_f32 v138, s56, v138
	v_mfma_f32_16x16x32_bf16 v[172:175], a[204:207], a[164:167], v[172:175]
	v_mul_f32 v139, s56, v139
	v_mul_f32 v140, s56, v140
	v_mul_f32 v141, s56, v141
	v_mfma_f32_16x16x32_bf16 v[176:179], a[208:211], a[164:167], v[176:179]
	v_cvt_pk_bf16_f32 v68, v136, v137
	v_mul_f32 v142, s56, v142
	v_mul_f32 v143, s56, v143
	v_mfma_f32_16x16x32_bf16 v[180:183], a[212:215], a[164:167], v[180:183]
	v_cvt_pk_bf16_f32 v69, v138, v139
	v_cvt_pk_bf16_f32 v70, v140, v141
	v_cvt_pk_bf16_f32 v71, v142, v143
	v_mfma_f32_16x16x32_bf16 v[184:187], a[216:219], a[164:167], v[184:187]
	v_mul_f32 v144, s56, v144
	v_mul_f32 v145, s56, v145
	v_mul_f32 v146, s56, v146
	v_mfma_f32_16x16x32_bf16 v[188:191], a[220:223], a[164:167], v[188:191]
	s_waitcnt lgkmcnt(4)
	v_mul_f32 v147, s56, v147
	v_mul_f32 v148, s56, v148
	v_mul_f32 v149, s56, v149
	v_mfma_f32_16x16x32_bf16 v[160:163], a[128:131], a[228:231], v[160:163]
	v_permlane16_swap_b32 v64, v66
	v_mul_f32 v150, s56, v150
	v_mul_f32 v151, s56, v151
	v_mfma_f32_16x16x32_bf16 v[164:167], a[132:135], a[228:231], v[164:167]
	v_permlane16_swap_b32 v65, v67
	v_cvt_pk_bf16_f32 v72, v144, v145
	v_cvt_pk_bf16_f32 v73, v146, v147
	v_mfma_f32_16x16x32_bf16 v[168:171], a[136:139], a[228:231], v[168:171]
	v_cvt_pk_bf16_f32 v74, v148, v149
	v_cvt_pk_bf16_f32 v75, v150, v151
	v_mul_f32 v152, s56, v152
	v_mfma_f32_16x16x32_bf16 v[172:175], a[140:143], a[228:231], v[172:175]
	v_mul_f32 v153, s56, v153
	v_mul_f32 v154, s56, v154
	v_mul_f32 v155, s56, v155
	v_mfma_f32_16x16x32_bf16 v[176:179], a[144:147], a[228:231], v[176:179]
	v_mul_f32 v156, s56, v156
	v_mul_f32 v157, s56, v157
	v_mul_f32 v158, s56, v158
	v_mfma_f32_16x16x32_bf16 v[180:183], a[148:151], a[228:231], v[180:183]
	v_permlane16_swap_b32 v68, v70
	v_permlane16_swap_b32 v69, v71
	v_mul_f32 v159, s56, v159
	v_mfma_f32_16x16x32_bf16 v[184:187], a[152:155], a[228:231], v[184:187]
	v_cvt_pk_bf16_f32 v76, v152, v153
	v_cvt_pk_bf16_f32 v77, v154, v155
	v_cvt_pk_bf16_f32 v78, v156, v157
	v_mfma_f32_16x16x32_bf16 v[188:191], a[156:159], a[228:231], v[188:191]
	s_waitcnt lgkmcnt(3)
	v_permlane16_swap_b32 v72, v74
	v_permlane16_swap_b32 v73, v75
	v_cvt_pk_bf16_f32 v79, v158, v159
	v_mfma_f32_16x16x32_bf16 v[192:195], a[192:195], a[168:171], v[192:195]
	v_permlane16_swap_b32 v76, v78
	v_permlane16_swap_b32 v77, v79
	v_mul_f32 v160, s56, v160
	v_mfma_f32_16x16x32_bf16 v[196:199], a[196:199], a[168:171], v[196:199]
	v_mul_f32 v161, s56, v161
	v_mul_f32 v162, s56, v162
	v_mul_f32 v163, s56, v163
	v_mfma_f32_16x16x32_bf16 v[200:203], a[200:203], a[168:171], v[200:203]
	v_mul_f32 v164, s56, v164
	v_mul_f32 v165, s56, v165
	v_mul_f32 v166, s56, v166
	v_mfma_f32_16x16x32_bf16 v[204:207], a[204:207], a[168:171], v[204:207]
	s_add_u32 m0, s48, 49152
	v_cvt_pk_bf16_f32 v80, v160, v161
	v_cvt_pk_bf16_f32 v81, v162, v163
	v_mul_f32 v167, s56, v167
	v_mfma_f32_16x16x32_bf16 v[208:211], a[208:211], a[168:171], v[208:211]
	s_waitcnt vmcnt(4) lgkmcnt(0)
	s_barrier
	s_add_u32 s4, s61, 0
	s_add_u32 s5, s61, 147456
	s_add_u32 s6, s61, 294912
	s_add_u32 s7, s61, 442368
	s_add_u32 s8, s61, 589824
	s_add_u32 s9, s61, 737280
	s_add_u32 s10, s61, 884736
	s_add_u32 s11, s61, 1032192
	ds_read_b128 a[0:3], v8 offset:0
	v_cvt_pk_bf16_f32 v82, v164, v165
	v_cvt_pk_bf16_f32 v83, v166, v167
	v_mfma_f32_16x16x32_bf16 v[212:215], a[212:215], a[168:171], v[212:215]
	s_add_u32 s49, s63, 24576
	ds_read_b128 a[4:7], v8 offset:256
	v_mul_f32 v168, s56, v168
	v_mul_f32 v169, s56, v169
	v_mfma_f32_16x16x32_bf16 v[216:219], a[216:219], a[168:171], v[216:219]
	s_and_b32 s49, s49, 0x1ffff
	buffer_load_dwordx4 v3, s[12:15], s49 offen nt lds
	v_mul_f32 v170, s56, v170
	v_mul_f32 v171, s56, v171
	v_mfma_f32_16x16x32_bf16 v[220:223], a[220:223], a[168:171], v[220:223]
	ds_read_b128 a[8:11], v12 offset:0
	v_mul_f32 v172, s56, v172
	v_mul_f32 v173, s56, v173
	v_mfma_f32_16x16x32_bf16 v[192:195], a[128:131], a[232:235], v[192:195]
	ds_read_b128 a[12:15], v12 offset:256
	v_mul_f32 v174, s56, v174
	v_mul_f32 v175, s56, v175
	v_mfma_f32_16x16x32_bf16 v[196:199], a[132:135], a[232:235], v[196:199]
	ds_read_b128 a[16:19], v8 offset:4096
	v_cvt_pk_bf16_f32 v84, v168, v169
	v_cvt_pk_bf16_f32 v85, v170, v171
	v_mfma_f32_16x16x32_bf16 v[200:203], a[136:139], a[232:235], v[200:203]
	ds_read_b128 a[20:23], v8 offset:4352
	v_cvt_pk_bf16_f32 v86, v172, v173
	v_cvt_pk_bf16_f32 v87, v174, v175
	v_mfma_f32_16x16x32_bf16 v[204:207], a[140:143], a[232:235], v[204:207]
	ds_read_b128 a[24:27], v12 offset:4096
	v_mul_f32 v176, s56, v176
	v_mul_f32 v177, s56, v177
	v_mfma_f32_16x16x32_bf16 v[208:211], a[144:147], a[232:235], v[208:211]
	ds_read_b128 a[28:31], v12 offset:4352
	v_mul_f32 v178, s56, v178
	v_mul_f32 v179, s56, v179
	v_mfma_f32_16x16x32_bf16 v[212:215], a[148:151], a[232:235], v[212:215]
	ds_read_b128 v[120:123], v63 offset:0
	v_mul_f32 v180, s56, v180
	v_mul_f32 v181, s56, v181
	v_mfma_f32_16x16x32_bf16 v[216:219], a[152:155], a[232:235], v[216:219]
	ds_read_b128 v[124:127], v63 offset:1024
	v_mul_f32 v182, s56, v182
	v_mul_f32 v183, s56, v183
	v_mfma_f32_16x16x32_bf16 v[220:223], a[156:159], a[232:235], v[220:223]
	s_waitcnt lgkmcnt(9)
	buffer_load_dwordx4 v3, s[12:15], s49 offen offset:2048 nt lds
	v_permlane16_swap_b32 v80, v82
	v_permlane16_swap_b32 v81, v83
	v_mfma_f32_16x16x32_bf16 v[40:43], a[0:3], v[64:67], 0
	s_waitcnt lgkmcnt(8)
	v_cvt_pk_bf16_f32 v88, v176, v177
	v_cvt_pk_bf16_f32 v89, v178, v179
	v_cvt_pk_bf16_f32 v90, v180, v181
	v_mfma_f32_16x16x32_bf16 v[40:43], a[4:7], v[68:71], v[40:43]
	s_waitcnt lgkmcnt(7)
	v_cvt_pk_bf16_f32 v91, v182, v183
	v_mul_f32 v184, s56, v184
	v_mul_f32 v185, s56, v185
	v_mfma_f32_16x16x32_bf16 v[40:43], a[8:11], v[72:75], v[40:43]
	s_waitcnt lgkmcnt(6)
	v_mul_f32 v186, s56, v186
	v_mul_f32 v187, s56, v187
	v_mul_f32 v188, s56, v188
	v_mfma_f32_16x16x32_bf16 v[40:43], a[12:15], v[76:79], v[40:43]
	s_waitcnt lgkmcnt(5)
	v_mul_f32 v189, s56, v189
	v_mul_f32 v190, s56, v190
	v_mul_f32 v191, s56, v191
	v_mfma_f32_16x16x32_bf16 v[44:47], a[16:19], v[64:67], 0
	s_waitcnt lgkmcnt(4)
	v_permlane16_swap_b32 v84, v86
	v_permlane16_swap_b32 v85, v87
	v_cvt_pk_bf16_f32 v92, v184, v185
	v_mfma_f32_16x16x32_bf16 v[44:47], a[20:23], v[68:71], v[44:47]
	s_waitcnt lgkmcnt(3)
	v_cvt_pk_bf16_f32 v93, v186, v187
	v_cvt_pk_bf16_f32 v94, v188, v189
	v_cvt_pk_bf16_f32 v95, v190, v191
	v_mfma_f32_16x16x32_bf16 v[44:47], a[24:27], v[72:75], v[44:47]
	s_waitcnt lgkmcnt(2)
	v_permlane16_swap_b32 v88, v90
	v_permlane16_swap_b32 v89, v91
	v_permlane16_swap_b32 v92, v94
	v_mfma_f32_16x16x32_bf16 v[44:47], a[28:31], v[76:79], v[44:47]
	s_add_u32 m0, s48, 57344
	s_nop 0
	buffer_load_dwordx4 v4, s[16:19], s49 offen nt lds
	v_permlane16_swap_b32 v93, v95
	v_mul_f32 v192, s56, v192
	v_mfma_f32_16x16x32_bf16 v[48:51], a[0:3], v[80:83], 0
	ds_read_b64_tr_b16 a[32:33], v16 offset:8192
	v_exp_f32 v40, v40
	v_mfma_f32_16x16x32_bf16 v[48:51], a[4:7], v[84:87], v[48:51]
	ds_read_b64_tr_b16 a[34:35], v16 offset:12288
	v_exp_f32 v41, v41
	v_mfma_f32_16x16x32_bf16 v[48:51], a[8:11], v[88:91], v[48:51]
	ds_read_b64_tr_b16 a[36:37], v20 offset:8192
	v_exp_f32 v44, v44
	v_mfma_f32_16x16x32_bf16 v[48:51], a[12:15], v[92:95], v[48:51]
	ds_read_b64_tr_b16 a[38:39], v20 offset:12288
	v_exp_f32 v45, v45
	v_mfma_f32_16x16x32_bf16 v[52:55], a[16:19], v[80:83], 0
	ds_read_b64_tr_b16 a[40:41], v16 offset:8448
	v_exp_f32 v42, v42
	v_mfma_f32_16x16x32_bf16 v[52:55], a[20:23], v[84:87], v[52:55]
	buffer_load_dwordx4 v4, s[16:19], s49 offen offset:2048 nt lds
	v_exp_f32 v43, v43
	v_mfma_f32_16x16x32_bf16 v[52:55], a[24:27], v[88:91], v[52:55]
	ds_read_b64_tr_b16 a[42:43], v16 offset:12544
	v_exp_f32 v46, v46
	v_mfma_f32_16x16x32_bf16 v[52:55], a[28:31], v[92:95], v[52:55]
	ds_read_b64_tr_b16 a[44:45], v20 offset:8448
	v_exp_f32 v47, v47
	v_mfma_f32_16x16x32_bf16 v[56:59], a[0:3], v[112:115], 0
	ds_read_b64_tr_b16 a[46:47], v20 offset:12544
	v_cvt_pk_bf16_f32 v28, v40, v41
	v_cvt_pk_bf16_f32 v29, v42, v43
	v_mfma_f32_16x16x32_bf16 v[56:59], a[4:7], v[116:119], v[56:59]
	s_waitcnt lgkmcnt(9)
	ds_read_b64_tr_b16 a[48:49], v16 offset:8704
	v_cvt_pk_bf16_f32 v30, v44, v45
	v_cvt_pk_bf16_f32 v31, v46, v47
	v_mfma_f32_16x16x32_bf16 v[56:59], a[8:11], v[120:123], v[56:59]
	s_waitcnt lgkmcnt(9)
	ds_read_b64_tr_b16 a[50:51], v16 offset:12800
	v_mul_f32 v193, s56, v193
	v_mul_f32 v194, s56, v194
	v_mfma_f32_16x16x32_bf16 v[56:59], a[12:15], v[124:127], v[56:59]
	ds_read_b64_tr_b16 a[52:53], v20 offset:8704
	v_mul_f32 v195, s56, v195
	v_mul_f32 v196, s56, v196
	v_mfma_f32_16x16x32_bf16 v[60:63], a[16:19], v[112:115], 0
	s_add_u32 m0, s48, 65536
	ds_read_b64_tr_b16 a[54:55], v20 offset:12800
	v_mul_f32 v197, s56, v197
	v_mul_f32 v198, s56, v198
	v_mfma_f32_16x16x32_bf16 v[60:63], a[20:23], v[116:119], v[60:63]
	s_add_u32 s49, s63, 32768
	ds_read_b64_tr_b16 a[56:57], v16 offset:8960
	ds_read_b64_tr_b16 a[58:59], v16 offset:13056
	v_mul_f32 v199, s56, v199
	v_mfma_f32_16x16x32_bf16 v[60:63], a[24:27], v[120:123], v[60:63]
	s_and_b32 s49, s49, 0x1ffff
	ds_read_b64_tr_b16 a[60:61], v20 offset:8960
	ds_read_b64_tr_b16 a[62:63], v20 offset:13056
	v_cvt_pk_bf16_f32 v96, v192, v193
	v_mfma_f32_16x16x32_bf16 v[60:63], a[28:31], v[124:127], v[60:63]
	s_waitcnt lgkmcnt(14)
	buffer_load_dwordx4 v3, s[12:15], s49 offen nt lds
	v_cvt_pk_bf16_f32 v97, v194, v195
	v_cvt_pk_bf16_f32 v98, v196, v197
	v_mfma_f32_16x16x32_bf16 v[128:131], a[32:35], v[28:31], 0
	s_waitcnt lgkmcnt(12)
	v_cvt_pk_bf16_f32 v99, v198, v199
	v_mul_f32 v200, s56, v200
	v_mul_f32 v201, s56, v201
	v_mfma_f32_16x16x32_bf16 v[132:135], a[36:39], v[28:31], 0
	s_waitcnt lgkmcnt(10)
	v_mul_f32 v202, s56, v202
	v_mul_f32 v203, s56, v203
	v_mul_f32 v204, s56, v204
	v_mfma_f32_16x16x32_bf16 v[136:139], a[40:43], v[28:31], 0
	s_waitcnt lgkmcnt(8)
	v_mul_f32 v205, s56, v205
	v_mul_f32 v206, s56, v206
	v_mul_f32 v207, s56, v207
	v_mfma_f32_16x16x32_bf16 v[140:143], a[44:47], v[28:31], 0
	s_waitcnt lgkmcnt(6)
	v_cvt_pk_bf16_f32 v100, v200, v201
	v_cvt_pk_bf16_f32 v101, v202, v203
	v_cvt_pk_bf16_f32 v102, v204, v205
	v_mfma_f32_16x16x32_bf16 v[144:147], a[48:51], v[28:31], 0
	s_waitcnt lgkmcnt(4)
	v_cvt_pk_bf16_f32 v103, v206, v207
	v_mul_f32 v208, s56, v208
	v_mul_f32 v209, s56, v209
	v_mul_f32 v210, s56, v210
	v_mul_f32 v211, s56, v211
	v_mul_f32 v212, s56, v212
	v_mul_f32 v213, s56, v213
	v_mul_f32 v214, s56, v214
	v_mul_f32 v215, s56, v215
	v_mfma_f32_16x16x32_bf16 v[148:151], a[52:55], v[28:31], 0
	s_waitcnt lgkmcnt(2)
	v_permlane16_swap_b32 v96, v98
	v_permlane16_swap_b32 v97, v99
	v_cvt_pk_bf16_f32 v104, v208, v209
	v_cvt_pk_bf16_f32 v105, v210, v211
	v_cvt_pk_bf16_f32 v106, v212, v213
	v_cvt_pk_bf16_f32 v107, v214, v215
	v_mul_f32 v216, s56, v216
	v_mul_f32 v217, s56, v217
	v_mul_f32 v218, s56, v218
	v_mul_f32 v219, s56, v219
	v_mul_f32 v220, s56, v220
	v_mul_f32 v221, s56, v221
	v_mul_f32 v222, s56, v222
	v_mul_f32 v223, s56, v223
	v_mfma_f32_16x16x32_bf16 v[152:155], a[56:59], v[28:31], 0
	s_waitcnt lgkmcnt(0)
	v_permlane16_swap_b32 v100, v102
	v_permlane16_swap_b32 v101, v103
	v_cvt_pk_bf16_f32 v108, v216, v217
	v_cvt_pk_bf16_f32 v109, v218, v219
	v_cvt_pk_bf16_f32 v110, v220, v221
	v_cvt_pk_bf16_f32 v111, v222, v223
	v_mfma_f32_16x16x32_bf16 v[156:159], a[60:63], v[28:31], 0
	v_permlane16_swap_b32 v104, v106
	v_permlane16_swap_b32 v105, v107
	v_add_f32 v24, v24, v40
	v_add_f32 v24, v24, v41
	v_add_f32 v24, v24, v42
	v_add_f32 v24, v24, v43
	v_mfma_f32_16x16x32_bf16 v[40:43], a[0:3], v[96:99], 0
	buffer_load_dwordx4 v3, s[12:15], s49 offen offset:2048 nt lds
	v_permlane16_swap_b32 v108, v110
	v_permlane16_swap_b32 v109, v111
	v_mfma_f32_16x16x32_bf16 v[40:43], a[4:7], v[100:103], v[40:43]
	v_add_f32 v24, v24, v44
	v_add_f32 v24, v24, v45
	v_add_f32 v24, v24, v46
	v_mfma_f32_16x16x32_bf16 v[40:43], a[8:11], v[104:107], v[40:43]
	v_add_f32 v24, v24, v47
	v_exp_f32 v48, v48
	v_mfma_f32_16x16x32_bf16 v[40:43], a[12:15], v[108:111], v[40:43]
	v_exp_f32 v49, v49
	v_exp_f32 v52, v52
	v_exp_f32 v53, v53
	v_mfma_f32_16x16x32_bf16 v[44:47], a[16:19], v[96:99], 0
	v_exp_f32 v50, v50
	v_exp_f32 v51, v51
	v_exp_f32 v54, v54
	v_exp_f32 v55, v55
	v_mfma_f32_16x16x32_bf16 v[44:47], a[20:23], v[100:103], v[44:47]
	s_add_u32 m0, s48, 73728
	v_cvt_pk_bf16_f32 v32, v48, v49
	v_cvt_pk_bf16_f32 v33, v50, v51
	v_cvt_pk_bf16_f32 v34, v52, v53
	v_mfma_f32_16x16x32_bf16 v[44:47], a[24:27], v[104:107], v[44:47]
	ds_read_b128 a[64:67], v10 offset:0
	v_add_f32 v25, v25, v48
	v_cvt_pk_bf16_f32 v35, v54, v55
	v_mfma_f32_16x16x32_bf16 v[44:47], a[28:31], v[108:111], v[44:47]
	ds_read_b128 a[68:71], v10 offset:256
	v_add_f32 v25, v25, v49
	v_add_f32 v25, v25, v50
	v_mfma_f32_16x16x32_bf16 v[160:163], a[32:35], v[32:35], 0
	buffer_load_dwordx4 v4, s[16:19], s49 offen nt lds
	v_add_f32 v25, v25, v51
	v_add_f32 v25, v25, v52
	v_mfma_f32_16x16x32_bf16 v[164:167], a[36:39], v[32:35], 0
	ds_read_b128 a[72:75], v14 offset:0
	v_add_f32 v25, v25, v53
	v_add_f32 v25, v25, v54
	v_mfma_f32_16x16x32_bf16 v[168:171], a[40:43], v[32:35], 0
	ds_read_b128 a[76:79], v14 offset:256
	v_add_f32 v25, v25, v55
	v_mfma_f32_16x16x32_bf16 v[172:175], a[44:47], v[32:35], 0
	ds_read_b128 a[80:83], v10 offset:4096
	v_exp_f32 v56, v56
	v_mfma_f32_16x16x32_bf16 v[176:179], a[48:51], v[32:35], 0
	ds_read_b128 a[84:87], v10 offset:4352
	v_exp_f32 v57, v57
	v_mfma_f32_16x16x32_bf16 v[180:183], a[52:55], v[32:35], 0
	ds_read_b128 a[88:91], v14 offset:4096
	v_exp_f32 v60, v60
	v_mfma_f32_16x16x32_bf16 v[184:187], a[56:59], v[32:35], 0
	ds_read_b128 a[92:95], v14 offset:4352
	v_exp_f32 v61, v61
	v_mfma_f32_16x16x32_bf16 v[188:191], a[60:63], v[32:35], 0
	s_waitcnt lgkmcnt(7)
	buffer_load_dwordx4 v4, s[16:19], s49 offen offset:2048 nt lds
	v_exp_f32 v58, v58
	v_mfma_f32_16x16x32_bf16 v[48:51], a[64:67], v[64:67], 0
	s_waitcnt lgkmcnt(6)
	v_exp_f32 v59, v59
	v_cvt_pk_bf16_f32 v36, v56, v57
	v_mfma_f32_16x16x32_bf16 v[48:51], a[68:71], v[68:71], v[48:51]
	s_waitcnt lgkmcnt(5)
	v_cvt_pk_bf16_f32 v37, v58, v59
	v_exp_f32 v62, v62
	v_mfma_f32_16x16x32_bf16 v[48:51], a[72:75], v[72:75], v[48:51]
	s_waitcnt lgkmcnt(4)
	v_exp_f32 v63, v63
	v_cvt_pk_bf16_f32 v38, v60, v61
	v_mfma_f32_16x16x32_bf16 v[48:51], a[76:79], v[76:79], v[48:51]
	s_waitcnt lgkmcnt(3)
	v_add_f32 v27, v27, v56
	v_add_f32 v27, v27, v57
	v_cvt_pk_bf16_f32 v39, v62, v63
	v_mfma_f32_16x16x32_bf16 v[52:55], a[80:83], v[64:67], 0
	s_waitcnt lgkmcnt(2)
	v_add_f32 v27, v27, v58
	v_add_f32 v27, v27, v59
	v_add_f32 v27, v27, v60
	v_mfma_f32_16x16x32_bf16 v[52:55], a[84:87], v[68:71], v[52:55]
	s_waitcnt lgkmcnt(1)
	s_add_u32 m0, s48, 81920
	s_add_u32 s49, s63, 40960
	s_and_b32 s49, s49, 0x1ffff
	buffer_load_dwordx4 v3, s[12:15], s49 offen nt lds
	v_add_f32 v27, v27, v61
	v_add_f32 v27, v27, v62
	v_mfma_f32_16x16x32_bf16 v[52:55], a[88:91], v[72:75], v[52:55]
	s_waitcnt lgkmcnt(0)
	v_add_f32 v27, v27, v63
	v_exp_f32 v40, v40
	v_mfma_f32_16x16x32_bf16 v[52:55], a[92:95], v[76:79], v[52:55]
	ds_read_b64_tr_b16 a[96:97], v18 offset:8192
	v_exp_f32 v41, v41
	v_mfma_f32_16x16x32_bf16 v[224:227], a[32:35], v[36:39], 0
	v_cvt_pk_bf16_f32 v28, v40, v41
	v_exp_f32 v44, v44
	v_mfma_f32_16x16x32_bf16 v[228:231], a[36:39], v[36:39], 0
	ds_read_b64_tr_b16 a[98:99], v18 offset:12288
	v_exp_f32 v45, v45
	v_mfma_f32_16x16x32_bf16 v[232:235], a[40:43], v[36:39], 0
	v_exp_f32 v42, v42
	v_cvt_pk_bf16_f32 v30, v44, v45
	v_mfma_f32_16x16x32_bf16 v[236:239], a[44:47], v[36:39], 0
	ds_read_b64_tr_b16 a[100:101], v22 offset:8192
	v_exp_f32 v43, v43
	v_mfma_f32_16x16x32_bf16 v[240:243], a[48:51], v[36:39], 0
	v_cvt_pk_bf16_f32 v29, v42, v43
	v_exp_f32 v46, v46
	v_mfma_f32_16x16x32_bf16 v[244:247], a[52:55], v[36:39], 0
	buffer_load_dwordx4 v3, s[12:15], s49 offen offset:2048 nt lds
	v_exp_f32 v47, v47
	v_mfma_f32_16x16x32_bf16 v[248:251], a[56:59], v[36:39], 0
	ds_read_b64_tr_b16 a[102:103], v22 offset:12288
	v_add_f32 v26, v26, v40
	v_cvt_pk_bf16_f32 v31, v46, v47
	v_mfma_f32_16x16x32_bf16 v[252:255], a[60:63], v[36:39], 0
	ds_read_b64_tr_b16 a[104:105], v18 offset:8448
	v_add_f32 v26, v26, v41
	v_add_f32 v26, v26, v42
	v_mfma_f32_16x16x32_bf16 v[56:59], a[64:67], v[80:83], 0
	ds_read_b64_tr_b16 a[106:107], v18 offset:12544
	v_add_f32 v26, v26, v43
	v_add_f32 v26, v26, v44
	v_mfma_f32_16x16x32_bf16 v[56:59], a[68:71], v[84:87], v[56:59]
	ds_read_b64_tr_b16 a[108:109], v22 offset:8448
	v_add_f32 v26, v26, v45
	v_add_f32 v26, v26, v46
	v_mfma_f32_16x16x32_bf16 v[56:59], a[72:75], v[88:91], v[56:59]
	ds_read_b64_tr_b16 a[110:111], v22 offset:12544
	v_add_f32 v26, v26, v47
	v_mfma_f32_16x16x32_bf16 v[56:59], a[76:79], v[92:95], v[56:59]
	ds_read_b64_tr_b16 a[112:113], v18 offset:8704
	v_exp_f32 v48, v48
	v_mfma_f32_16x16x32_bf16 v[60:63], a[80:83], v[80:83], 0
	ds_read_b64_tr_b16 a[114:115], v18 offset:12800
	v_exp_f32 v49, v49
	v_mfma_f32_16x16x32_bf16 v[60:63], a[84:87], v[84:87], v[60:63]
	s_add_u32 m0, s48, 90112
	ds_read_b64_tr_b16 a[116:117], v22 offset:8704
	v_exp_f32 v52, v52
	v_mfma_f32_16x16x32_bf16 v[60:63], a[88:91], v[88:91], v[60:63]
	ds_read_b64_tr_b16 a[118:119], v22 offset:12800
	v_exp_f32 v53, v53
	v_mfma_f32_16x16x32_bf16 v[60:63], a[92:95], v[92:95], v[60:63]
	ds_read_b64_tr_b16 a[120:121], v18 offset:8960
	v_exp_f32 v50, v50
	v_mfma_f32_16x16x32_bf16 v[192:195], a[32:35], v[28:31], 0
	ds_read_b64_tr_b16 a[122:123], v18 offset:13056
	ds_read_b64_tr_b16 a[124:125], v22 offset:8960
	ds_read_b64_tr_b16 a[126:127], v22 offset:13056
	buffer_load_dwordx4 v4, s[16:19], s49 offen nt lds
	v_mfma_f32_16x16x32_bf16 v[196:199], a[36:39], v[28:31], 0
	v_exp_f32 v51, v51
	v_cvt_pk_bf16_f32 v32, v48, v49
	v_mfma_f32_16x16x32_bf16 v[200:203], a[40:43], v[28:31], 0
	v_cvt_pk_bf16_f32 v33, v50, v51
	v_exp_f32 v54, v54
	v_mfma_f32_16x16x32_bf16 v[204:207], a[44:47], v[28:31], 0
	v_exp_f32 v55, v55
	v_cvt_pk_bf16_f32 v34, v52, v53
	v_mfma_f32_16x16x32_bf16 v[208:211], a[48:51], v[28:31], 0
	s_waitcnt vmcnt(7) lgkmcnt(0)
	s_barrier
	ds_read_b128 a[0:3], v8 offset:32768
	v_cvt_pk_bf16_f32 v35, v54, v55
	v_mfma_f32_16x16x32_bf16 v[212:215], a[52:55], v[28:31], 0
	buffer_load_dwordx4 v4, s[16:19], s49 offen offset:2048 nt lds
	v_add_f32 v24, v24, v48
	v_mfma_f32_16x16x32_bf16 v[216:219], a[56:59], v[28:31], 0
	ds_read_b128 a[4:7], v8 offset:33024
	v_add_f32 v24, v24, v49
	v_add_f32 v24, v24, v50
	v_mfma_f32_16x16x32_bf16 v[220:223], a[60:63], v[28:31], 0
	ds_read_b128 a[8:11], v12 offset:32768
	v_add_f32 v24, v24, v51
	v_mfma_f32_16x16x32_bf16 v[40:43], a[64:67], v[96:99], 0
	ds_read_b128 a[12:15], v12 offset:33024
	v_add_f32 v24, v24, v52
	v_add_f32 v24, v24, v53
	v_mfma_f32_16x16x32_bf16 v[40:43], a[68:71], v[100:103], v[40:43]
	ds_read_b128 a[16:19], v8 offset:36864
	v_add_f32 v24, v24, v54
	v_mfma_f32_16x16x32_bf16 v[40:43], a[72:75], v[104:107], v[40:43]
	s_add_u32 m0, s48, 0
	ds_read_b128 a[20:23], v8 offset:37120
	v_add_f32 v24, v24, v55
	v_mfma_f32_16x16x32_bf16 v[40:43], a[76:79], v[108:111], v[40:43]
	s_add_u32 s49, s63, 49152
	ds_read_b128 a[24:27], v12 offset:36864
	v_mfma_f32_16x16x32_bf16 v[44:47], a[80:83], v[96:99], 0
	s_and_b32 s49, s49, 0x1ffff
	ds_read_b128 a[28:31], v12 offset:37120
	v_exp_f32 v56, v56
	v_mfma_f32_16x16x32_bf16 v[44:47], a[84:87], v[100:103], v[44:47]
	buffer_load_dwordx4 v3, s[12:15], s49 offen nt lds
	v_add_f32 v25, v25, v56
	v_mfma_f32_16x16x32_bf16 v[44:47], a[88:91], v[104:107], v[44:47]
	v_exp_f32 v57, v57
	v_mfma_f32_16x16x32_bf16 v[44:47], a[92:95], v[108:111], v[44:47]
	v_cvt_pk_bf16_f32 v36, v56, v57
	v_exp_f32 v60, v60
	v_mfma_f32_16x16x32_bf16 v[128:131], a[96:99], v[32:35], v[128:131]
	v_exp_f32 v61, v61
	v_mfma_f32_16x16x32_bf16 v[132:135], a[100:103], v[32:35], v[132:135]
	v_exp_f32 v58, v58
	v_cvt_pk_bf16_f32 v38, v60, v61
	v_mfma_f32_16x16x32_bf16 v[136:139], a[104:107], v[32:35], v[136:139]
	v_exp_f32 v59, v59
	v_mfma_f32_16x16x32_bf16 v[140:143], a[108:111], v[32:35], v[140:143]
	v_cvt_pk_bf16_f32 v37, v58, v59
	v_exp_f32 v62, v62
	v_mfma_f32_16x16x32_bf16 v[144:147], a[112:115], v[32:35], v[144:147]
	v_exp_f32 v63, v63
	v_mfma_f32_16x16x32_bf16 v[148:151], a[116:119], v[32:35], v[148:151]
	v_add_f32 v25, v25, v57
	v_add_f32 v25, v25, v58
	v_cvt_pk_bf16_f32 v39, v62, v63
	v_mfma_f32_16x16x32_bf16 v[152:155], a[120:123], v[32:35], v[152:155]
	v_add_f32 v25, v25, v59
	v_add_f32 v25, v25, v60
	v_mfma_f32_16x16x32_bf16 v[156:159], a[124:127], v[32:35], v[156:159]
	s_waitcnt lgkmcnt(7)
	v_add_f32 v25, v25, v61
	v_add_f32 v25, v25, v62
	v_mfma_f32_16x16x32_bf16 v[48:51], a[0:3], v[64:67], 0
	s_waitcnt lgkmcnt(6)
	buffer_load_dwordx4 v3, s[12:15], s49 offen offset:2048 nt lds
	v_add_f32 v25, v25, v63
	v_mfma_f32_16x16x32_bf16 v[48:51], a[4:7], v[68:71], v[48:51]
	s_waitcnt lgkmcnt(5)
	v_exp_f32 v40, v40
	v_mfma_f32_16x16x32_bf16 v[48:51], a[8:11], v[72:75], v[48:51]
	s_waitcnt lgkmcnt(4)
	ds_read_b64_tr_b16 a[32:33], v16 offset:40960
	v_exp_f32 v41, v41
	v_mfma_f32_16x16x32_bf16 v[48:51], a[12:15], v[76:79], v[48:51]
	s_waitcnt lgkmcnt(4)
	v_exp_f32 v44, v44
	v_mfma_f32_16x16x32_bf16 v[52:55], a[16:19], v[64:67], 0
	s_waitcnt lgkmcnt(3)
	v_cvt_pk_bf16_f32 v28, v40, v41
	v_exp_f32 v45, v45
	v_mfma_f32_16x16x32_bf16 v[52:55], a[20:23], v[68:71], v[52:55]
	s_waitcnt lgkmcnt(2)
	v_exp_f32 v42, v42
	v_mfma_f32_16x16x32_bf16 v[52:55], a[24:27], v[72:75], v[52:55]
	s_waitcnt lgkmcnt(1)
	v_exp_f32 v43, v43
	v_cvt_pk_bf16_f32 v30, v44, v45
	v_mfma_f32_16x16x32_bf16 v[52:55], a[28:31], v[76:79], v[52:55]
	v_exp_f32 v46, v46
	v_mfma_f32_16x16x32_bf16 v[160:163], a[96:99], v[36:39], v[160:163]
	s_add_u32 m0, s48, 8192
	v_exp_f32 v47, v47
	v_mfma_f32_16x16x32_bf16 v[164:167], a[100:103], v[36:39], v[164:167]
	ds_read_b64_tr_b16 a[34:35], v16 offset:45056
	v_cvt_pk_bf16_f32 v29, v42, v43
	v_cvt_pk_bf16_f32 v31, v46, v47
	v_mfma_f32_16x16x32_bf16 v[168:171], a[104:107], v[36:39], v[168:171]
	v_add_f32 v26, v26, v40
	v_add_f32 v26, v26, v41
	v_mfma_f32_16x16x32_bf16 v[172:175], a[108:111], v[36:39], v[172:175]
	buffer_load_dwordx4 v4, s[16:19], s49 offen nt lds
	v_add_f32 v26, v26, v42
	v_add_f32 v26, v26, v43
	v_mfma_f32_16x16x32_bf16 v[176:179], a[112:115], v[36:39], v[176:179]
	ds_read_b64_tr_b16 a[36:37], v20 offset:40960
	v_add_f32 v26, v26, v44
	v_mfma_f32_16x16x32_bf16 v[180:183], a[116:119], v[36:39], v[180:183]
	ds_read_b64_tr_b16 a[38:39], v20 offset:45056
	v_add_f32 v26, v26, v45
	v_add_f32 v26, v26, v46
	v_mfma_f32_16x16x32_bf16 v[184:187], a[120:123], v[36:39], v[184:187]
	ds_read_b64_tr_b16 a[40:41], v16 offset:41216
	v_add_f32 v26, v26, v47
	v_mfma_f32_16x16x32_bf16 v[188:191], a[124:127], v[36:39], v[188:191]
	ds_read_b64_tr_b16 a[42:43], v16 offset:45312
	v_exp_f32 v48, v48
	v_mfma_f32_16x16x32_bf16 v[56:59], a[0:3], v[80:83], 0
	ds_read_b64_tr_b16 a[44:45], v20 offset:41216
	v_add_f32 v24, v24, v48
	v_mfma_f32_16x16x32_bf16 v[56:59], a[4:7], v[84:87], v[56:59]
	ds_read_b64_tr_b16 a[46:47], v20 offset:45312
	v_mfma_f32_16x16x32_bf16 v[56:59], a[8:11], v[88:91], v[56:59]
	ds_read_b64_tr_b16 a[48:49], v16 offset:41472
	v_exp_f32 v49, v49
	v_mfma_f32_16x16x32_bf16 v[56:59], a[12:15], v[92:95], v[56:59]
	ds_read_b64_tr_b16 a[50:51], v16 offset:45568
	v_cvt_pk_bf16_f32 v32, v48, v49
	v_mfma_f32_16x16x32_bf16 v[60:63], a[16:19], v[80:83], 0
	ds_read_b64_tr_b16 a[52:53], v20 offset:41472
	v_exp_f32 v52, v52
	v_mfma_f32_16x16x32_bf16 v[60:63], a[20:23], v[84:87], v[60:63]
	v_exp_f32 v53, v53
	v_mfma_f32_16x16x32_bf16 v[60:63], a[24:27], v[88:91], v[60:63]
	buffer_load_dwordx4 v4, s[16:19], s49 offen offset:2048 nt lds
	v_exp_f32 v50, v50
	v_mfma_f32_16x16x32_bf16 v[60:63], a[28:31], v[92:95], v[60:63]
	ds_read_b64_tr_b16 a[54:55], v20 offset:45568
	v_cvt_pk_bf16_f32 v34, v52, v53
	v_mfma_f32_16x16x32_bf16 v[192:195], a[96:99], v[28:31], v[192:195]
	ds_read_b64_tr_b16 a[56:57], v16 offset:41728
	v_exp_f32 v51, v51
	v_mfma_f32_16x16x32_bf16 v[196:199], a[100:103], v[28:31], v[196:199]
	v_exp_f32 v54, v54
	v_mfma_f32_16x16x32_bf16 v[200:203], a[104:107], v[28:31], v[200:203]
	v_exp_f32 v55, v55
	v_mfma_f32_16x16x32_bf16 v[204:207], a[108:111], v[28:31], v[204:207]
	ds_read_b64_tr_b16 a[58:59], v16 offset:45824
	v_cvt_pk_bf16_f32 v33, v50, v51
	v_cvt_pk_bf16_f32 v35, v54, v55
	v_mfma_f32_16x16x32_bf16 v[208:211], a[112:115], v[28:31], v[208:211]
	ds_read_b64_tr_b16 a[60:61], v20 offset:41728
	v_add_f32 v24, v24, v49
	v_mfma_f32_16x16x32_bf16 v[212:215], a[116:119], v[28:31], v[212:215]
	ds_read_b64_tr_b16 a[62:63], v20 offset:45824
	v_add_f32 v24, v24, v50
	v_add_f32 v24, v24, v51
	v_mfma_f32_16x16x32_bf16 v[216:219], a[120:123], v[28:31], v[216:219]
	s_add_u32 m0, s48, 16384
	v_add_f32 v24, v24, v52
	v_add_f32 v24, v24, v53
	v_mfma_f32_16x16x32_bf16 v[220:223], a[124:127], v[28:31], v[220:223]
	s_add_u32 s49, s63, 57344
	ds_read_b128 a[64:67], v10 offset:32768
	v_add_f32 v24, v24, v54
	v_add_f32 v24, v24, v55
	v_mfma_f32_16x16x32_bf16 v[40:43], a[0:3], v[112:115], 0
	s_and_b32 s49, s49, 0x1ffff
	v_exp_f32 v56, v56
	v_mfma_f32_16x16x32_bf16 v[40:43], a[4:7], v[116:119], v[40:43]
	buffer_load_dwordx4 v3, s[12:15], s49 offen nt lds
	v_exp_f32 v57, v57
	v_mfma_f32_16x16x32_bf16 v[40:43], a[8:11], v[120:123], v[40:43]
	v_exp_f32 v60, v60
	v_mfma_f32_16x16x32_bf16 v[40:43], a[12:15], v[124:127], v[40:43]
	v_cvt_pk_bf16_f32 v36, v56, v57
	v_exp_f32 v61, v61
	v_mfma_f32_16x16x32_bf16 v[44:47], a[16:19], v[112:115], 0
	v_exp_f32 v58, v58
	v_mfma_f32_16x16x32_bf16 v[44:47], a[20:23], v[116:119], v[44:47]
	v_exp_f32 v59, v59
	v_mfma_f32_16x16x32_bf16 v[44:47], a[24:27], v[120:123], v[44:47]
	v_cvt_pk_bf16_f32 v37, v58, v59
	v_exp_f32 v62, v62
	v_mfma_f32_16x16x32_bf16 v[44:47], a[28:31], v[124:127], v[44:47]
	s_waitcnt lgkmcnt(15)
	v_exp_f32 v63, v63
	v_mfma_f32_16x16x32_bf16 v[128:131], a[32:35], v[32:35], v[128:131]
	s_waitcnt lgkmcnt(13)
	ds_read_b128 a[68:71], v10 offset:33024
	v_cvt_pk_bf16_f32 v38, v60, v61
	v_cvt_pk_bf16_f32 v39, v62, v63
	v_mfma_f32_16x16x32_bf16 v[132:135], a[36:39], v[32:35], v[132:135]
	s_waitcnt lgkmcnt(12)
	ds_read_b128 a[72:75], v14 offset:32768
	v_add_f32 v25, v25, v56
	v_mfma_f32_16x16x32_bf16 v[136:139], a[40:43], v[32:35], v[136:139]
	s_waitcnt lgkmcnt(11)
	ds_read_b128 a[76:79], v14 offset:33024
	v_add_f32 v25, v25, v57
	v_add_f32 v25, v25, v58
	v_mfma_f32_16x16x32_bf16 v[140:143], a[44:47], v[32:35], v[140:143]
	s_waitcnt lgkmcnt(10)
	ds_read_b128 a[80:83], v10 offset:36864
	v_add_f32 v25, v25, v59
	v_mfma_f32_16x16x32_bf16 v[144:147], a[48:51], v[32:35], v[144:147]
	s_waitcnt lgkmcnt(9)
	buffer_load_dwordx4 v3, s[12:15], s49 offen offset:2048 nt lds
	v_add_f32 v25, v25, v60
	v_add_f32 v25, v25, v61
	v_mfma_f32_16x16x32_bf16 v[148:151], a[52:55], v[32:35], v[148:151]
	s_waitcnt lgkmcnt(7)
	ds_read_b128 a[84:87], v10 offset:37120
	v_add_f32 v25, v25, v62
	v_mfma_f32_16x16x32_bf16 v[152:155], a[56:59], v[32:35], v[152:155]
	s_waitcnt lgkmcnt(6)
	ds_read_b128 a[88:91], v14 offset:36864
	v_add_f32 v25, v25, v63
	v_mfma_f32_16x16x32_bf16 v[156:159], a[60:63], v[32:35], v[156:159]
	ds_read_b128 a[92:95], v14 offset:37120
	v_exp_f32 v40, v40
	v_mfma_f32_16x16x32_bf16 v[48:51], a[0:3], v[96:99], 0
	v_exp_f32 v41, v41
	v_mfma_f32_16x16x32_bf16 v[48:51], a[4:7], v[100:103], v[48:51]
	v_cvt_pk_bf16_f32 v28, v40, v41
	v_exp_f32 v44, v44
	v_mfma_f32_16x16x32_bf16 v[48:51], a[8:11], v[104:107], v[48:51]
	v_exp_f32 v45, v45
	v_mfma_f32_16x16x32_bf16 v[48:51], a[12:15], v[108:111], v[48:51]
	v_exp_f32 v42, v42
	v_cvt_pk_bf16_f32 v30, v44, v45
	v_mfma_f32_16x16x32_bf16 v[52:55], a[16:19], v[96:99], 0
	s_add_u32 m0, s48, 24576
	v_exp_f32 v43, v43
	v_mfma_f32_16x16x32_bf16 v[52:55], a[20:23], v[100:103], v[52:55]
	v_cvt_pk_bf16_f32 v29, v42, v43
	v_exp_f32 v46, v46
	v_mfma_f32_16x16x32_bf16 v[52:55], a[24:27], v[104:107], v[52:55]
	v_exp_f32 v47, v47
	v_mfma_f32_16x16x32_bf16 v[52:55], a[28:31], v[108:111], v[52:55]
	buffer_load_dwordx4 v4, s[16:19], s49 offen nt lds
	v_cvt_pk_bf16_f32 v31, v46, v47
	v_mfma_f32_16x16x32_bf16 v[160:163], a[32:35], v[36:39], v[160:163]
	v_add_f32 v27, v27, v40
	v_add_f32 v27, v27, v41
	v_add_f32 v27, v27, v42
	v_mfma_f32_16x16x32_bf16 v[164:167], a[36:39], v[36:39], v[164:167]
	v_add_f32 v27, v27, v43
	v_add_f32 v27, v27, v44
	v_mfma_f32_16x16x32_bf16 v[168:171], a[40:43], v[36:39], v[168:171]
	v_add_f32 v27, v27, v45
	v_add_f32 v27, v27, v46
	v_add_f32 v27, v27, v47
	v_mfma_f32_16x16x32_bf16 v[172:175], a[44:47], v[36:39], v[172:175]
	v_exp_f32 v48, v48
	v_mfma_f32_16x16x32_bf16 v[176:179], a[48:51], v[36:39], v[176:179]
	ds_read_b64_tr_b16 a[96:97], v18 offset:40960
	v_exp_f32 v49, v49
	v_mfma_f32_16x16x32_bf16 v[180:183], a[52:55], v[36:39], v[180:183]
	v_exp_f32 v52, v52
	v_mfma_f32_16x16x32_bf16 v[184:187], a[56:59], v[36:39], v[184:187]
	v_cvt_pk_bf16_f32 v32, v48, v49
	v_exp_f32 v53, v53
	v_mfma_f32_16x16x32_bf16 v[188:191], a[60:63], v[36:39], v[188:191]
	s_waitcnt lgkmcnt(8)
	v_exp_f32 v50, v50
	v_mfma_f32_16x16x32_bf16 v[56:59], a[64:67], v[64:67], 0
	s_waitcnt lgkmcnt(7)
	v_exp_f32 v51, v51
	v_mfma_f32_16x16x32_bf16 v[56:59], a[68:71], v[68:71], v[56:59]
	s_waitcnt lgkmcnt(6)
	v_cvt_pk_bf16_f32 v33, v50, v51
	v_exp_f32 v54, v54
	v_mfma_f32_16x16x32_bf16 v[56:59], a[72:75], v[72:75], v[56:59]
	s_waitcnt lgkmcnt(5)
	buffer_load_dwordx4 v4, s[16:19], s49 offen offset:2048 nt lds
	v_cvt_pk_bf16_f32 v34, v52, v53
	v_mfma_f32_16x16x32_bf16 v[56:59], a[76:79], v[76:79], v[56:59]
	s_waitcnt lgkmcnt(4)
	ds_read_b64_tr_b16 a[98:99], v18 offset:45056
	v_exp_f32 v55, v55
	v_mfma_f32_16x16x32_bf16 v[60:63], a[80:83], v[64:67], 0
	s_waitcnt lgkmcnt(4)
	ds_read_b64_tr_b16 a[100:101], v22 offset:40960
	v_cvt_pk_bf16_f32 v35, v54, v55
	v_mfma_f32_16x16x32_bf16 v[60:63], a[84:87], v[68:71], v[60:63]
	s_waitcnt lgkmcnt(4)
	ds_read_b64_tr_b16 a[102:103], v22 offset:45056
	v_add_f32 v26, v26, v48
	v_add_f32 v26, v26, v49
	v_mfma_f32_16x16x32_bf16 v[60:63], a[88:91], v[72:75], v[60:63]
	s_waitcnt lgkmcnt(4)
	ds_read_b64_tr_b16 a[104:105], v18 offset:41216
	v_add_f32 v26, v26, v50
	v_mfma_f32_16x16x32_bf16 v[60:63], a[92:95], v[76:79], v[60:63]
	ds_read_b64_tr_b16 a[106:107], v18 offset:45312
	v_add_f32 v26, v26, v51
	v_add_f32 v26, v26, v52
	v_mfma_f32_16x16x32_bf16 v[224:227], a[32:35], v[28:31], v[224:227]
	ds_read_b64_tr_b16 a[108:109], v22 offset:41216
	v_add_f32 v26, v26, v53
	v_mfma_f32_16x16x32_bf16 v[228:231], a[36:39], v[28:31], v[228:231]
	ds_read_b64_tr_b16 a[110:111], v22 offset:45312
	v_add_f32 v26, v26, v54
	v_mfma_f32_16x16x32_bf16 v[232:235], a[40:43], v[28:31], v[232:235]
	s_add_u32 m0, s62, 98304
	ds_read_b64_tr_b16 a[112:113], v18 offset:41472
	v_add_f32 v26, v26, v55
	v_mfma_f32_16x16x32_bf16 v[236:239], a[44:47], v[28:31], v[236:239]
	s_add_u32 s50, s4, 0
	ds_read_b64_tr_b16 a[114:115], v18 offset:45568
	v_mfma_f32_16x16x32_bf16 v[240:243], a[48:51], v[28:31], v[240:243]
	ds_read_b64_tr_b16 a[116:117], v22 offset:41472
	v_exp_f32 v56, v56
	v_mfma_f32_16x16x32_bf16 v[244:247], a[52:55], v[28:31], v[244:247]
	buffer_load_dwordx4 v5, s[24:27], s50 offen lds
	v_add_f32 v24, v24, v56
	v_mfma_f32_16x16x32_bf16 v[248:251], a[56:59], v[28:31], v[248:251]
	s_add_u32 m0, s62, 99328
	ds_read_b64_tr_b16 a[118:119], v22 offset:45568
	v_exp_f32 v57, v57
	v_mfma_f32_16x16x32_bf16 v[252:255], a[60:63], v[28:31], v[252:255]
	s_add_u32 s50, s4, 9216
	ds_read_b64_tr_b16 a[120:121], v18 offset:41728
	v_cvt_pk_bf16_f32 v36, v56, v57
	v_mfma_f32_16x16x32_bf16 v[40:43], a[64:67], v[80:83], 0
	buffer_load_dwordx4 v5, s[24:27], s50 offen lds
	v_exp_f32 v60, v60
	v_mfma_f32_16x16x32_bf16 v[40:43], a[68:71], v[84:87], v[40:43]
	s_add_u32 m0, s62, 100352
	ds_read_b64_tr_b16 a[122:123], v18 offset:45824
	v_add_f32 v24, v24, v57
	v_mfma_f32_16x16x32_bf16 v[40:43], a[72:75], v[88:91], v[40:43]
	s_add_u32 s50, s4, 18432
	ds_read_b64_tr_b16 a[124:125], v22 offset:41728
	v_mfma_f32_16x16x32_bf16 v[40:43], a[76:79], v[92:95], v[40:43]
	buffer_load_dwordx4 v5, s[24:27], s50 offen lds
	v_exp_f32 v61, v61
	v_mfma_f32_16x16x32_bf16 v[44:47], a[80:83], v[80:83], 0
	s_add_u32 m0, s62, 101376
	ds_read_b64_tr_b16 a[126:127], v22 offset:45824
	v_cvt_pk_bf16_f32 v38, v60, v61
	v_mfma_f32_16x16x32_bf16 v[44:47], a[84:87], v[84:87], v[44:47]
	s_add_u32 s50, s4, 27648
	v_exp_f32 v58, v58
	v_mfma_f32_16x16x32_bf16 v[44:47], a[88:91], v[88:91], v[44:47]
	buffer_load_dwordx4 v5, s[24:27], s50 offen lds
	v_add_f32 v24, v24, v58
	v_mfma_f32_16x16x32_bf16 v[44:47], a[92:95], v[92:95], v[44:47]
	s_add_u32 m0, s62, 102400
	v_exp_f32 v59, v59
	v_mfma_f32_16x16x32_bf16 v[192:195], a[32:35], v[32:35], v[192:195]
	s_add_u32 s50, s4, 36864
	v_exp_f32 v62, v62
	v_mfma_f32_16x16x32_bf16 v[196:199], a[36:39], v[32:35], v[196:199]
	buffer_load_dwordx4 v5, s[24:27], s50 offen lds
	v_exp_f32 v63, v63
	v_mfma_f32_16x16x32_bf16 v[200:203], a[40:43], v[32:35], v[200:203]
	s_add_u32 m0, s62, 103424
	v_cvt_pk_bf16_f32 v37, v58, v59
	v_cvt_pk_bf16_f32 v39, v62, v63
	v_mfma_f32_16x16x32_bf16 v[204:207], a[44:47], v[32:35], v[204:207]
	s_add_u32 s50, s4, 46080
	v_add_f32 v24, v24, v59
	v_add_f32 v24, v24, v60
	v_add_f32 v24, v24, v61
	v_mfma_f32_16x16x32_bf16 v[208:211], a[48:51], v[32:35], v[208:211]
	s_waitcnt vmcnt(13) lgkmcnt(0)
	s_barrier
	buffer_load_dwordx4 v5, s[24:27], s50 offen lds
	v_add_f32 v24, v24, v62
	v_mfma_f32_16x16x32_bf16 v[212:215], a[52:55], v[32:35], v[212:215]
	s_add_u32 m0, s62, 104448
	ds_read_b128 a[0:3], v9 offset:0
	v_add_f32 v24, v24, v63
	v_mfma_f32_16x16x32_bf16 v[216:219], a[56:59], v[32:35], v[216:219]
	s_add_u32 s50, s4, 55296
	ds_read_b128 a[4:7], v9 offset:256
	v_exp_f32 v40, v40
	v_mfma_f32_16x16x32_bf16 v[220:223], a[60:63], v[32:35], v[220:223]
	buffer_load_dwordx4 v5, s[24:27], s50 offen lds
	v_add_f32 v25, v25, v40
	v_mfma_f32_16x16x32_bf16 v[48:51], a[64:67], v[96:99], 0
	s_add_u32 m0, s62, 105472
	ds_read_b128 a[8:11], v13 offset:0
	v_exp_f32 v41, v41
	v_mfma_f32_16x16x32_bf16 v[48:51], a[68:71], v[100:103], v[48:51]
	s_add_u32 s50, s4, 64512
	ds_read_b128 a[12:15], v13 offset:256
	v_cvt_pk_bf16_f32 v28, v40, v41
	v_mfma_f32_16x16x32_bf16 v[48:51], a[72:75], v[104:107], v[48:51]
	buffer_load_dwordx4 v5, s[24:27], s50 offen lds
	v_exp_f32 v44, v44
	v_mfma_f32_16x16x32_bf16 v[48:51], a[76:79], v[108:111], v[48:51]
	s_add_u32 m0, s48, 32768
	ds_read_b128 a[16:19], v9 offset:4096
	v_add_f32 v25, v25, v41
	v_mfma_f32_16x16x32_bf16 v[52:55], a[80:83], v[96:99], 0
	s_add_u32 s49, s63, 65536
	ds_read_b128 a[20:23], v9 offset:4352
	v_exp_f32 v45, v45
	v_mfma_f32_16x16x32_bf16 v[52:55], a[84:87], v[100:103], v[52:55]
	s_and_b32 s49, s49, 0x1ffff
	buffer_load_dwordx4 v3, s[12:15], s49 offen nt lds
	v_cvt_pk_bf16_f32 v30, v44, v45
	v_mfma_f32_16x16x32_bf16 v[52:55], a[88:91], v[104:107], v[52:55]
	ds_read_b128 a[24:27], v13 offset:4096
	v_mfma_f32_16x16x32_bf16 v[52:55], a[92:95], v[108:111], v[52:55]
	ds_read_b128 a[28:31], v13 offset:4352
	v_exp_f32 v42, v42
	v_mfma_f32_16x16x32_bf16 v[128:131], a[96:99], v[36:39], v[128:131]
	v_exp_f32 v43, v43
	v_mfma_f32_16x16x32_bf16 v[132:135], a[100:103], v[36:39], v[132:135]
	v_cvt_pk_bf16_f32 v29, v42, v43
	v_exp_f32 v46, v46
	v_mfma_f32_16x16x32_bf16 v[136:139], a[104:107], v[36:39], v[136:139]
	v_exp_f32 v47, v47
	v_mfma_f32_16x16x32_bf16 v[140:143], a[108:111], v[36:39], v[140:143]
	v_add_f32 v25, v25, v42
	v_add_f32 v25, v25, v43
	v_cvt_pk_bf16_f32 v31, v46, v47
	v_mfma_f32_16x16x32_bf16 v[144:147], a[112:115], v[36:39], v[144:147]
	v_add_f32 v25, v25, v44
	v_add_f32 v25, v25, v45
	v_mfma_f32_16x16x32_bf16 v[148:151], a[116:119], v[36:39], v[148:151]
	ds_read_b64_tr_b16 a[32:33], v17 offset:8192
	v_add_f32 v25, v25, v46
	v_add_f32 v25, v25, v47
	v_mfma_f32_16x16x32_bf16 v[152:155], a[120:123], v[36:39], v[152:155]
	v_exp_f32 v48, v48
	v_mfma_f32_16x16x32_bf16 v[156:159], a[124:127], v[36:39], v[156:159]
	s_waitcnt lgkmcnt(8)
	v_exp_f32 v49, v49
	v_mfma_f32_16x16x32_bf16 v[56:59], a[0:3], v[64:67], 0
	s_waitcnt lgkmcnt(7)
	buffer_load_dwordx4 v3, s[12:15], s49 offen offset:2048 nt lds
	v_exp_f32 v52, v52
	v_mfma_f32_16x16x32_bf16 v[56:59], a[4:7], v[68:71], v[56:59]
	s_waitcnt lgkmcnt(6)
	v_exp_f32 v53, v53
	v_mfma_f32_16x16x32_bf16 v[56:59], a[8:11], v[72:75], v[56:59]
	s_waitcnt lgkmcnt(5)
	v_exp_f32 v50, v50
	v_cvt_pk_bf16_f32 v32, v48, v49
	v_mfma_f32_16x16x32_bf16 v[56:59], a[12:15], v[76:79], v[56:59]
	s_waitcnt lgkmcnt(4)
	v_exp_f32 v51, v51
	v_mfma_f32_16x16x32_bf16 v[60:63], a[16:19], v[64:67], 0
	s_waitcnt lgkmcnt(3)
	v_cvt_pk_bf16_f32 v33, v50, v51
	v_exp_f32 v54, v54
	v_mfma_f32_16x16x32_bf16 v[60:63], a[20:23], v[68:71], v[60:63]
	s_waitcnt lgkmcnt(2)
	v_exp_f32 v55, v55
	v_mfma_f32_16x16x32_bf16 v[60:63], a[24:27], v[72:75], v[60:63]
	s_waitcnt lgkmcnt(1)
	ds_read_b64_tr_b16 a[34:35], v17 offset:12288
	v_cvt_pk_bf16_f32 v34, v52, v53
	v_cvt_pk_bf16_f32 v35, v54, v55
	v_mfma_f32_16x16x32_bf16 v[60:63], a[28:31], v[76:79], v[60:63]
	v_add_f32 v26, v26, v48
	v_add_f32 v26, v26, v49
	v_mfma_f32_16x16x32_bf16 v[160:163], a[96:99], v[28:31], v[160:163]
	s_add_u32 m0, s48, 40960
	v_add_f32 v26, v26, v50
	v_add_f32 v26, v26, v51
	v_mfma_f32_16x16x32_bf16 v[164:167], a[100:103], v[28:31], v[164:167]
	ds_read_b64_tr_b16 a[36:37], v21 offset:8192
	v_add_f32 v26, v26, v52
	v_add_f32 v26, v26, v53
	v_mfma_f32_16x16x32_bf16 v[168:171], a[104:107], v[28:31], v[168:171]
	ds_read_b64_tr_b16 a[38:39], v21 offset:12288
	v_add_f32 v26, v26, v54
	v_mfma_f32_16x16x32_bf16 v[172:175], a[108:111], v[28:31], v[172:175]
	buffer_load_dwordx4 v4, s[16:19], s49 offen nt lds
	v_add_f32 v26, v26, v55
	v_mfma_f32_16x16x32_bf16 v[176:179], a[112:115], v[28:31], v[176:179]
	ds_read_b64_tr_b16 a[40:41], v17 offset:8448
	v_mfma_f32_16x16x32_bf16 v[180:183], a[116:119], v[28:31], v[180:183]
	ds_read_b64_tr_b16 a[42:43], v17 offset:12544
	v_exp_f32 v56, v56
	v_mfma_f32_16x16x32_bf16 v[184:187], a[120:123], v[28:31], v[184:187]
	ds_read_b64_tr_b16 a[44:45], v21 offset:8448
	v_add_f32 v24, v24, v56
	v_mfma_f32_16x16x32_bf16 v[188:191], a[124:127], v[28:31], v[188:191]
	ds_read_b64_tr_b16 a[46:47], v21 offset:12544
	v_exp_f32 v57, v57
	v_mfma_f32_16x16x32_bf16 v[40:43], a[0:3], v[80:83], 0
	ds_read_b64_tr_b16 a[48:49], v17 offset:8704
	v_cvt_pk_bf16_f32 v36, v56, v57
	v_mfma_f32_16x16x32_bf16 v[40:43], a[4:7], v[84:87], v[40:43]
	ds_read_b64_tr_b16 a[50:51], v17 offset:12800
	v_add_f32 v24, v24, v57
	v_mfma_f32_16x16x32_bf16 v[40:43], a[8:11], v[88:91], v[40:43]
	ds_read_b64_tr_b16 a[52:53], v21 offset:8704
	v_exp_f32 v60, v60
	v_mfma_f32_16x16x32_bf16 v[40:43], a[12:15], v[92:95], v[40:43]
	v_exp_f32 v61, v61
	v_mfma_f32_16x16x32_bf16 v[44:47], a[16:19], v[80:83], 0
	ds_read_b64_tr_b16 a[54:55], v21 offset:12800
	v_exp_f32 v58, v58
	v_mfma_f32_16x16x32_bf16 v[44:47], a[20:23], v[84:87], v[44:47]
	v_exp_f32 v59, v59
	v_mfma_f32_16x16x32_bf16 v[44:47], a[24:27], v[88:91], v[44:47]
	buffer_load_dwordx4 v4, s[16:19], s49 offen offset:2048 nt lds
	v_exp_f32 v62, v62
	v_mfma_f32_16x16x32_bf16 v[44:47], a[28:31], v[92:95], v[44:47]
	v_exp_f32 v63, v63
	v_mfma_f32_16x16x32_bf16 v[192:195], a[96:99], v[32:35], v[192:195]
	ds_read_b64_tr_b16 a[56:57], v17 offset:8960
	v_cvt_pk_bf16_f32 v37, v58, v59
	v_cvt_pk_bf16_f32 v38, v60, v61
	v_mfma_f32_16x16x32_bf16 v[196:199], a[100:103], v[32:35], v[196:199]
	ds_read_b64_tr_b16 a[58:59], v17 offset:13056
	v_cvt_pk_bf16_f32 v39, v62, v63
	v_mfma_f32_16x16x32_bf16 v[200:203], a[104:107], v[32:35], v[200:203]
	ds_read_b64_tr_b16 a[60:61], v21 offset:8960
	v_add_f32 v24, v24, v58
	v_mfma_f32_16x16x32_bf16 v[204:207], a[108:111], v[32:35], v[204:207]
	ds_read_b64_tr_b16 a[62:63], v21 offset:13056
	v_add_f32 v24, v24, v59
	v_add_f32 v24, v24, v60
	v_mfma_f32_16x16x32_bf16 v[208:211], a[112:115], v[32:35], v[208:211]
	v_add_f32 v24, v24, v61
	v_add_f32 v24, v24, v62
	v_mfma_f32_16x16x32_bf16 v[212:215], a[116:119], v[32:35], v[212:215]
	v_add_f32 v24, v24, v63
	v_exp_f32 v40, v40
	v_mfma_f32_16x16x32_bf16 v[216:219], a[120:123], v[32:35], v[216:219]
	s_add_u32 m0, s48, 49152
	v_exp_f32 v41, v41
	v_mfma_f32_16x16x32_bf16 v[220:223], a[124:127], v[32:35], v[220:223]
	s_add_u32 s49, s63, 73728
	v_cvt_pk_bf16_f32 v28, v40, v41
	v_exp_f32 v44, v44
	v_mfma_f32_16x16x32_bf16 v[48:51], a[0:3], v[112:115], 0
	s_and_b32 s49, s49, 0x1ffff
	v_exp_f32 v45, v45
	v_mfma_f32_16x16x32_bf16 v[48:51], a[4:7], v[116:119], v[48:51]
	buffer_load_dwordx4 v3, s[12:15], s49 offen nt lds
	v_exp_f32 v42, v42
	v_mfma_f32_16x16x32_bf16 v[48:51], a[8:11], v[120:123], v[48:51]
	v_exp_f32 v43, v43
	v_mfma_f32_16x16x32_bf16 v[48:51], a[12:15], v[124:127], v[48:51]
	v_cvt_pk_bf16_f32 v29, v42, v43
	v_exp_f32 v46, v46
	v_mfma_f32_16x16x32_bf16 v[52:55], a[16:19], v[112:115], 0
	v_exp_f32 v47, v47
	v_mfma_f32_16x16x32_bf16 v[52:55], a[20:23], v[116:119], v[52:55]
	v_cvt_pk_bf16_f32 v30, v44, v45
	v_cvt_pk_bf16_f32 v31, v46, v47
	v_mfma_f32_16x16x32_bf16 v[52:55], a[24:27], v[120:123], v[52:55]
	ds_read_b128 a[64:67], v11 offset:0
	v_add_f32 v25, v25, v40
	v_add_f32 v25, v25, v41
	v_mfma_f32_16x16x32_bf16 v[52:55], a[28:31], v[124:127], v[52:55]
	s_waitcnt lgkmcnt(15)
	ds_read_b128 a[68:71], v11 offset:256
	v_add_f32 v25, v25, v42
	v_mfma_f32_16x16x32_bf16 v[128:131], a[32:35], v[36:39], v[128:131]
	s_waitcnt lgkmcnt(14)
	ds_read_b128 a[72:75], v15 offset:0
	v_add_f32 v25, v25, v43
	v_add_f32 v25, v25, v44
	v_mfma_f32_16x16x32_bf16 v[132:135], a[36:39], v[36:39], v[132:135]
	s_waitcnt lgkmcnt(13)
	ds_read_b128 a[76:79], v15 offset:256
	v_add_f32 v25, v25, v45
	v_mfma_f32_16x16x32_bf16 v[136:139], a[40:43], v[36:39], v[136:139]
	s_waitcnt lgkmcnt(12)
	ds_read_b128 a[80:83], v11 offset:4096
	v_add_f32 v25, v25, v46
	v_add_f32 v25, v25, v47
	v_mfma_f32_16x16x32_bf16 v[140:143], a[44:47], v[36:39], v[140:143]
	s_waitcnt lgkmcnt(11)
	ds_read_b128 a[84:87], v11 offset:4352
	v_mfma_f32_16x16x32_bf16 v[144:147], a[48:51], v[36:39], v[144:147]
	s_waitcnt lgkmcnt(10)
	buffer_load_dwordx4 v3, s[12:15], s49 offen offset:2048 nt lds
	v_exp_f32 v48, v48
	v_mfma_f32_16x16x32_bf16 v[148:151], a[52:55], v[36:39], v[148:151]
	s_waitcnt lgkmcnt(8)
	ds_read_b128 a[88:91], v15 offset:4096
	v_add_f32 v27, v27, v48
	v_mfma_f32_16x16x32_bf16 v[152:155], a[56:59], v[36:39], v[152:155]
	s_waitcnt lgkmcnt(7)
	ds_read_b128 a[92:95], v15 offset:4352
	v_mfma_f32_16x16x32_bf16 v[156:159], a[60:63], v[36:39], v[156:159]
	v_exp_f32 v49, v49
	v_mfma_f32_16x16x32_bf16 v[56:59], a[0:3], v[96:99], 0
	v_exp_f32 v52, v52
	v_mfma_f32_16x16x32_bf16 v[56:59], a[4:7], v[100:103], v[56:59]
	v_cvt_pk_bf16_f32 v32, v48, v49
	v_exp_f32 v53, v53
	v_mfma_f32_16x16x32_bf16 v[56:59], a[8:11], v[104:107], v[56:59]
	v_exp_f32 v50, v50
	v_mfma_f32_16x16x32_bf16 v[56:59], a[12:15], v[108:111], v[56:59]
	v_exp_f32 v51, v51
	v_cvt_pk_bf16_f32 v34, v52, v53
	v_mfma_f32_16x16x32_bf16 v[60:63], a[16:19], v[96:99], 0
	s_add_u32 m0, s48, 57344
	v_exp_f32 v54, v54
	v_mfma_f32_16x16x32_bf16 v[60:63], a[20:23], v[100:103], v[60:63]
	v_cvt_pk_bf16_f32 v33, v50, v51
	v_exp_f32 v55, v55
	v_mfma_f32_16x16x32_bf16 v[60:63], a[24:27], v[104:107], v[60:63]
	v_add_f32 v27, v27, v49
	v_cvt_pk_bf16_f32 v35, v54, v55
	v_mfma_f32_16x16x32_bf16 v[60:63], a[28:31], v[108:111], v[60:63]
	buffer_load_dwordx4 v4, s[16:19], s49 offen nt lds
	v_add_f32 v27, v27, v50
	v_mfma_f32_16x16x32_bf16 v[160:163], a[32:35], v[28:31], v[160:163]
	v_add_f32 v27, v27, v51
	v_add_f32 v27, v27, v52
	v_add_f32 v27, v27, v53
	v_mfma_f32_16x16x32_bf16 v[164:167], a[36:39], v[28:31], v[164:167]
	v_add_f32 v27, v27, v54
	v_add_f32 v27, v27, v55
	v_mfma_f32_16x16x32_bf16 v[168:171], a[40:43], v[28:31], v[168:171]
	ds_read_b64_tr_b16 a[96:97], v19 offset:8192
	v_exp_f32 v56, v56
	v_mfma_f32_16x16x32_bf16 v[172:175], a[44:47], v[28:31], v[172:175]
	v_exp_f32 v57, v57
	v_mfma_f32_16x16x32_bf16 v[176:179], a[48:51], v[28:31], v[176:179]
	v_cvt_pk_bf16_f32 v36, v56, v57
	v_exp_f32 v60, v60
	v_mfma_f32_16x16x32_bf16 v[180:183], a[52:55], v[28:31], v[180:183]
	v_exp_f32 v61, v61
	v_mfma_f32_16x16x32_bf16 v[184:187], a[56:59], v[28:31], v[184:187]
	v_exp_f32 v58, v58
	v_cvt_pk_bf16_f32 v38, v60, v61
	v_mfma_f32_16x16x32_bf16 v[188:191], a[60:63], v[28:31], v[188:191]
	s_waitcnt lgkmcnt(8)
	v_exp_f32 v59, v59
	v_mfma_f32_16x16x32_bf16 v[40:43], a[64:67], v[64:67], 0
	s_waitcnt lgkmcnt(7)
	v_exp_f32 v62, v62
	v_mfma_f32_16x16x32_bf16 v[40:43], a[68:71], v[68:71], v[40:43]
	s_waitcnt lgkmcnt(6)
	v_cvt_pk_bf16_f32 v37, v58, v59
	v_exp_f32 v63, v63
	v_mfma_f32_16x16x32_bf16 v[40:43], a[72:75], v[72:75], v[40:43]
	s_waitcnt lgkmcnt(5)
	buffer_load_dwordx4 v4, s[16:19], s49 offen offset:2048 nt lds
	v_cvt_pk_bf16_f32 v39, v62, v63
	v_mfma_f32_16x16x32_bf16 v[40:43], a[76:79], v[76:79], v[40:43]
	s_waitcnt lgkmcnt(4)
	ds_read_b64_tr_b16 a[98:99], v19 offset:12288
	v_add_f32 v26, v26, v56
	v_add_f32 v26, v26, v57
	v_mfma_f32_16x16x32_bf16 v[44:47], a[80:83], v[64:67], 0
	s_waitcnt lgkmcnt(4)
	ds_read_b64_tr_b16 a[100:101], v23 offset:8192
	v_add_f32 v26, v26, v58
	v_mfma_f32_16x16x32_bf16 v[44:47], a[84:87], v[68:71], v[44:47]
	s_waitcnt lgkmcnt(4)
	ds_read_b64_tr_b16 a[102:103], v23 offset:12288
	v_add_f32 v26, v26, v59
	v_add_f32 v26, v26, v60
	v_mfma_f32_16x16x32_bf16 v[44:47], a[88:91], v[72:75], v[44:47]
	s_waitcnt lgkmcnt(4)
	ds_read_b64_tr_b16 a[104:105], v19 offset:8448
	v_add_f32 v26, v26, v61
	v_mfma_f32_16x16x32_bf16 v[44:47], a[92:95], v[76:79], v[44:47]
	ds_read_b64_tr_b16 a[106:107], v19 offset:12544
	v_add_f32 v26, v26, v62
	v_add_f32 v26, v26, v63
	v_mfma_f32_16x16x32_bf16 v[224:227], a[32:35], v[32:35], v[224:227]
	ds_read_b64_tr_b16 a[108:109], v23 offset:8448
	v_mfma_f32_16x16x32_bf16 v[228:231], a[36:39], v[32:35], v[228:231]
	ds_read_b64_tr_b16 a[110:111], v23 offset:12544
	v_mfma_f32_16x16x32_bf16 v[232:235], a[40:43], v[32:35], v[232:235]
	s_add_u32 m0, s62, 131072
	ds_read_b64_tr_b16 a[112:113], v19 offset:8704
	v_exp_f32 v40, v40
	v_mfma_f32_16x16x32_bf16 v[236:239], a[44:47], v[32:35], v[236:239]
	s_add_u32 s50, s4, 73728
	ds_read_b64_tr_b16 a[114:115], v19 offset:12800
	v_add_f32 v24, v24, v40
	v_mfma_f32_16x16x32_bf16 v[240:243], a[48:51], v[32:35], v[240:243]
	ds_read_b64_tr_b16 a[116:117], v23 offset:8704
	v_exp_f32 v41, v41
	v_mfma_f32_16x16x32_bf16 v[244:247], a[52:55], v[32:35], v[244:247]
	buffer_load_dwordx4 v5, s[24:27], s50 offen lds
	v_cvt_pk_bf16_f32 v28, v40, v41
	v_mfma_f32_16x16x32_bf16 v[248:251], a[56:59], v[32:35], v[248:251]
	s_add_u32 m0, s62, 132096
	ds_read_b64_tr_b16 a[118:119], v23 offset:12800
	v_exp_f32 v44, v44
	v_mfma_f32_16x16x32_bf16 v[252:255], a[60:63], v[32:35], v[252:255]
	s_add_u32 s50, s4, 82944
	ds_read_b64_tr_b16 a[120:121], v19 offset:8960
	v_add_f32 v24, v24, v41
	v_mfma_f32_16x16x32_bf16 v[48:51], a[64:67], v[80:83], 0
	buffer_load_dwordx4 v5, s[24:27], s50 offen lds
	v_exp_f32 v45, v45
	v_mfma_f32_16x16x32_bf16 v[48:51], a[68:71], v[84:87], v[48:51]
	s_add_u32 m0, s62, 133120
	ds_read_b64_tr_b16 a[122:123], v19 offset:13056
	v_cvt_pk_bf16_f32 v30, v44, v45
	v_mfma_f32_16x16x32_bf16 v[48:51], a[72:75], v[88:91], v[48:51]
	s_add_u32 s50, s4, 92160
	ds_read_b64_tr_b16 a[124:125], v23 offset:8960
	v_exp_f32 v42, v42
	v_mfma_f32_16x16x32_bf16 v[48:51], a[76:79], v[92:95], v[48:51]
	buffer_load_dwordx4 v5, s[24:27], s50 offen lds
	v_add_f32 v24, v24, v42
	v_mfma_f32_16x16x32_bf16 v[52:55], a[80:83], v[80:83], 0
	s_add_u32 m0, s62, 134144
	ds_read_b64_tr_b16 a[126:127], v23 offset:13056
	v_mfma_f32_16x16x32_bf16 v[52:55], a[84:87], v[84:87], v[52:55]
	s_add_u32 s50, s4, 101376
	v_exp_f32 v43, v43
	v_mfma_f32_16x16x32_bf16 v[52:55], a[88:91], v[88:91], v[52:55]
	buffer_load_dwordx4 v5, s[24:27], s50 offen lds
	v_cvt_pk_bf16_f32 v29, v42, v43
	v_mfma_f32_16x16x32_bf16 v[52:55], a[92:95], v[92:95], v[52:55]
	s_add_u32 m0, s62, 135168
	v_add_f32 v24, v24, v43
	v_exp_f32 v46, v46
	v_mfma_f32_16x16x32_bf16 v[192:195], a[32:35], v[36:39], v[192:195]
	s_add_u32 s50, s4, 110592
	v_exp_f32 v47, v47
	v_mfma_f32_16x16x32_bf16 v[196:199], a[36:39], v[36:39], v[196:199]
	buffer_load_dwordx4 v5, s[24:27], s50 offen lds
	v_add_f32 v24, v24, v44
	v_cvt_pk_bf16_f32 v31, v46, v47
	v_mfma_f32_16x16x32_bf16 v[200:203], a[40:43], v[36:39], v[200:203]
	s_add_u32 m0, s62, 136192
	v_add_f32 v24, v24, v45
	v_add_f32 v24, v24, v46
	v_mfma_f32_16x16x32_bf16 v[204:207], a[44:47], v[36:39], v[204:207]
	s_add_u32 s50, s4, 119808
	v_add_f32 v24, v24, v47
	v_exp_f32 v48, v48
	v_mfma_f32_16x16x32_bf16 v[208:211], a[48:51], v[36:39], v[208:211]
	s_waitcnt vmcnt(21) lgkmcnt(0)
	s_barrier
	buffer_load_dwordx4 v5, s[24:27], s50 offen lds
	v_add_f32 v25, v25, v48
	v_mfma_f32_16x16x32_bf16 v[212:215], a[52:55], v[36:39], v[212:215]
	s_add_u32 m0, s62, 137216
	ds_read_b128 a[0:3], v8 offset:0
	v_mfma_f32_16x16x32_bf16 v[216:219], a[56:59], v[36:39], v[216:219]
	s_add_u32 s50, s4, 129024
	ds_read_b128 a[4:7], v8 offset:256
	v_exp_f32 v49, v49
	v_mfma_f32_16x16x32_bf16 v[220:223], a[60:63], v[36:39], v[220:223]
	buffer_load_dwordx4 v5, s[24:27], s50 offen lds
	v_cvt_pk_bf16_f32 v32, v48, v49
	v_mfma_f32_16x16x32_bf16 v[56:59], a[64:67], v[96:99], 0
	s_add_u32 m0, s62, 138240
	ds_read_b128 a[8:11], v12 offset:0
	v_exp_f32 v52, v52
	v_mfma_f32_16x16x32_bf16 v[56:59], a[68:71], v[100:103], v[56:59]
	s_add_u32 s50, s4, 138240
	ds_read_b128 a[12:15], v12 offset:256
	v_add_f32 v25, v25, v49
	v_mfma_f32_16x16x32_bf16 v[56:59], a[72:75], v[104:107], v[56:59]
	buffer_load_dwordx4 v5, s[24:27], s50 offen lds
	v_exp_f32 v53, v53
	v_mfma_f32_16x16x32_bf16 v[56:59], a[76:79], v[108:111], v[56:59]
	s_add_u32 m0, s48, 65536
	ds_read_b128 a[16:19], v8 offset:4096
	v_cvt_pk_bf16_f32 v34, v52, v53
	v_mfma_f32_16x16x32_bf16 v[60:63], a[80:83], v[96:99], 0
	s_add_u32 s49, s63, 81920
	ds_read_b128 a[20:23], v8 offset:4352
	v_exp_f32 v50, v50
	v_mfma_f32_16x16x32_bf16 v[60:63], a[84:87], v[100:103], v[60:63]
	s_and_b32 s49, s49, 0x1ffff
	buffer_load_dwordx4 v3, s[12:15], s49 offen nt lds
	v_add_f32 v25, v25, v50
	v_mfma_f32_16x16x32_bf16 v[60:63], a[88:91], v[104:107], v[60:63]
	ds_read_b128 a[24:27], v12 offset:4096
	v_mfma_f32_16x16x32_bf16 v[60:63], a[92:95], v[108:111], v[60:63]
	ds_read_b128 a[28:31], v12 offset:4352
	v_exp_f32 v51, v51
	v_mfma_f32_16x16x32_bf16 v[128:131], a[96:99], v[28:31], v[128:131]
	v_exp_f32 v54, v54
	v_mfma_f32_16x16x32_bf16 v[132:135], a[100:103], v[28:31], v[132:135]
	v_cvt_pk_bf16_f32 v33, v50, v51
	v_exp_f32 v55, v55
	v_mfma_f32_16x16x32_bf16 v[136:139], a[104:107], v[28:31], v[136:139]
	v_add_f32 v25, v25, v51
	v_cvt_pk_bf16_f32 v35, v54, v55
	v_mfma_f32_16x16x32_bf16 v[140:143], a[108:111], v[28:31], v[140:143]
	v_add_f32 v25, v25, v52
	v_add_f32 v25, v25, v53
	v_add_f32 v25, v25, v54
	v_mfma_f32_16x16x32_bf16 v[144:147], a[112:115], v[28:31], v[144:147]
	s_waitcnt vmcnt(21)
	ds_read_b64_tr_b16 a[128:129], v0 offset:32768
	v_add_f32 v25, v25, v55
	v_mfma_f32_16x16x32_bf16 v[148:151], a[116:119], v[28:31], v[148:151]
	ds_read_b64_tr_b16 a[130:131], v0 offset:34816
	v_exp_f32 v56, v56
	v_mfma_f32_16x16x32_bf16 v[152:155], a[120:123], v[28:31], v[152:155]
	v_exp_f32 v57, v57
	v_mfma_f32_16x16x32_bf16 v[156:159], a[124:127], v[28:31], v[156:159]
	s_waitcnt lgkmcnt(9)
	v_exp_f32 v60, v60
	v_mfma_f32_16x16x32_bf16 v[40:43], a[0:3], v[64:67], 0
	s_waitcnt lgkmcnt(8)
	buffer_load_dwordx4 v3, s[12:15], s49 offen offset:2048 nt lds
	v_exp_f32 v61, v61
	v_mfma_f32_16x16x32_bf16 v[40:43], a[4:7], v[68:71], v[40:43]
	s_waitcnt lgkmcnt(7)
	ds_read_b64_tr_b16 a[132:133], v1 offset:32768
	v_cvt_pk_bf16_f32 v36, v56, v57
	v_mfma_f32_16x16x32_bf16 v[40:43], a[8:11], v[72:75], v[40:43]
	s_waitcnt lgkmcnt(7)
	ds_read_b64_tr_b16 a[134:135], v1 offset:34816
	v_exp_f32 v58, v58
	v_mfma_f32_16x16x32_bf16 v[40:43], a[12:15], v[76:79], v[40:43]
	s_waitcnt lgkmcnt(7)
	ds_read_b64_tr_b16 a[136:137], v0 offset:33280
	v_cvt_pk_bf16_f32 v38, v60, v61
	v_mfma_f32_16x16x32_bf16 v[44:47], a[16:19], v[64:67], 0
	s_waitcnt lgkmcnt(7)
	ds_read_b64_tr_b16 a[138:139], v0 offset:35328
	v_exp_f32 v59, v59
	v_mfma_f32_16x16x32_bf16 v[44:47], a[20:23], v[68:71], v[44:47]
	s_waitcnt lgkmcnt(7)
	ds_read_b64_tr_b16 a[140:141], v1 offset:33280
	v_cvt_pk_bf16_f32 v37, v58, v59
	v_mfma_f32_16x16x32_bf16 v[44:47], a[24:27], v[72:75], v[44:47]
	s_waitcnt lgkmcnt(7)
	ds_read_b64_tr_b16 a[142:143], v1 offset:35328
	v_exp_f32 v62, v62
	v_mfma_f32_16x16x32_bf16 v[44:47], a[28:31], v[76:79], v[44:47]
	s_waitcnt vmcnt(18)
	ds_read_b64_tr_b16 a[144:145], v0 offset:36864
	v_add_f32 v26, v26, v56
	v_mfma_f32_16x16x32_bf16 v[160:163], a[96:99], v[32:35], v[160:163]
	s_add_u32 m0, s48, 73728
	ds_read_b64_tr_b16 a[146:147], v0 offset:38912
	v_add_f32 v26, v26, v57
	v_mfma_f32_16x16x32_bf16 v[164:167], a[100:103], v[32:35], v[164:167]
	ds_read_b64_tr_b16 a[148:149], v1 offset:36864
	v_exp_f32 v63, v63
	v_mfma_f32_16x16x32_bf16 v[168:171], a[104:107], v[32:35], v[168:171]
	ds_read_b64_tr_b16 a[150:151], v1 offset:38912
	v_cvt_pk_bf16_f32 v39, v62, v63
	v_mfma_f32_16x16x32_bf16 v[172:175], a[108:111], v[32:35], v[172:175]
	buffer_load_dwordx4 v4, s[16:19], s49 offen nt lds
	v_add_f32 v26, v26, v58
	v_add_f32 v26, v26, v59
	v_mfma_f32_16x16x32_bf16 v[176:179], a[112:115], v[32:35], v[176:179]
	ds_read_b64_tr_b16 a[152:153], v0 offset:37376
	v_add_f32 v26, v26, v60
	v_mfma_f32_16x16x32_bf16 v[180:183], a[116:119], v[32:35], v[180:183]
	ds_read_b64_tr_b16 a[154:155], v0 offset:39424
	v_add_f32 v26, v26, v61
	v_add_f32 v26, v26, v62
	v_mfma_f32_16x16x32_bf16 v[184:187], a[120:123], v[32:35], v[184:187]
	ds_read_b64_tr_b16 a[156:157], v1 offset:37376
	v_add_f32 v26, v26, v63
	v_mfma_f32_16x16x32_bf16 v[188:191], a[124:127], v[32:35], v[188:191]
	ds_read_b64_tr_b16 a[158:159], v1 offset:39424
	v_exp_f32 v40, v40
	v_mfma_f32_16x16x32_bf16 v[48:51], a[0:3], v[80:83], 0
	ds_read_b64_tr_b16 a[32:33], v16 offset:8192
	v_add_f32 v24, v24, v40
	v_mfma_f32_16x16x32_bf16 v[48:51], a[4:7], v[84:87], v[48:51]
	ds_read_b64_tr_b16 a[34:35], v16 offset:12288
	v_mfma_f32_16x16x32_bf16 v[48:51], a[8:11], v[88:91], v[48:51]
	ds_read_b64_tr_b16 a[36:37], v20 offset:8192
	v_exp_f32 v41, v41
	v_mfma_f32_16x16x32_bf16 v[48:51], a[12:15], v[92:95], v[48:51]
	ds_read_b64_tr_b16 a[38:39], v20 offset:12288
	v_cvt_pk_bf16_f32 v28, v40, v41
	v_mfma_f32_16x16x32_bf16 v[52:55], a[16:19], v[80:83], 0
	ds_read_b64_tr_b16 a[40:41], v16 offset:8448
	v_exp_f32 v44, v44
	v_mfma_f32_16x16x32_bf16 v[52:55], a[20:23], v[84:87], v[52:55]
	ds_read_b64_tr_b16 a[42:43], v16 offset:12544
	v_add_f32 v24, v24, v41
	v_mfma_f32_16x16x32_bf16 v[52:55], a[24:27], v[88:91], v[52:55]
	buffer_load_dwordx4 v4, s[16:19], s49 offen offset:2048 nt lds
	v_exp_f32 v45, v45
	v_mfma_f32_16x16x32_bf16 v[52:55], a[28:31], v[92:95], v[52:55]
	ds_read_b64_tr_b16 a[44:45], v20 offset:8448
	v_cvt_pk_bf16_f32 v30, v44, v45
	v_mfma_f32_16x16x32_bf16 v[192:195], a[96:99], v[36:39], v[192:195]
	ds_read_b64_tr_b16 a[46:47], v20 offset:12544
	v_exp_f32 v42, v42
	v_mfma_f32_16x16x32_bf16 v[196:199], a[100:103], v[36:39], v[196:199]
	ds_read_b64_tr_b16 a[48:49], v16 offset:8704
	v_add_f32 v24, v24, v42
	v_mfma_f32_16x16x32_bf16 v[200:203], a[104:107], v[36:39], v[200:203]
	ds_read_b64_tr_b16 a[50:51], v16 offset:12800
	v_exp_f32 v43, v43
	v_mfma_f32_16x16x32_bf16 v[204:207], a[108:111], v[36:39], v[204:207]
	ds_read_b64_tr_b16 a[52:53], v20 offset:8704
	v_cvt_pk_bf16_f32 v29, v42, v43
	v_mfma_f32_16x16x32_bf16 v[208:211], a[112:115], v[36:39], v[208:211]
	ds_read_b64_tr_b16 a[54:55], v20 offset:12800
	v_add_f32 v24, v24, v43
	v_mfma_f32_16x16x32_bf16 v[212:215], a[116:119], v[36:39], v[212:215]
	ds_read_b64_tr_b16 a[56:57], v16 offset:8960
	v_exp_f32 v46, v46
	v_mfma_f32_16x16x32_bf16 v[216:219], a[120:123], v[36:39], v[216:219]
	s_add_u32 m0, s48, 81920
	v_exp_f32 v47, v47
	v_mfma_f32_16x16x32_bf16 v[220:223], a[124:127], v[36:39], v[220:223]
	s_add_u32 s49, s63, 90112
	ds_read_b64_tr_b16 a[58:59], v16 offset:13056
	v_add_f32 v24, v24, v44
	v_cvt_pk_bf16_f32 v31, v46, v47
	v_mfma_f32_16x16x32_bf16 v[56:59], a[0:3], v[112:115], 0
	s_and_b32 s49, s49, 0x1ffff
	ds_read_b64_tr_b16 a[60:61], v20 offset:8960
	v_add_f32 v24, v24, v45
	v_mfma_f32_16x16x32_bf16 v[56:59], a[4:7], v[116:119], v[56:59]
	buffer_load_dwordx4 v3, s[12:15], s49 offen nt lds
	v_add_f32 v24, v24, v46
	v_add_f32 v24, v24, v47
	v_mfma_f32_16x16x32_bf16 v[56:59], a[8:11], v[120:123], v[56:59]
	ds_read_b64_tr_b16 a[62:63], v20 offset:13056
	v_mfma_f32_16x16x32_bf16 v[56:59], a[12:15], v[124:127], v[56:59]
	ds_read_b128 a[64:67], v10 offset:0
	v_exp_f32 v48, v48
	v_mfma_f32_16x16x32_bf16 v[60:63], a[16:19], v[112:115], 0
	v_exp_f32 v49, v49
	v_mfma_f32_16x16x32_bf16 v[60:63], a[20:23], v[116:119], v[60:63]
	v_exp_f32 v52, v52
	v_mfma_f32_16x16x32_bf16 v[60:63], a[24:27], v[120:123], v[60:63]
	v_cvt_pk_bf16_f32 v32, v48, v49
	v_exp_f32 v53, v53
	v_mfma_f32_16x16x32_bf16 v[60:63], a[28:31], v[124:127], v[60:63]
	s_waitcnt lgkmcnt(15)
	v_exp_f32 v50, v50
	v_mfma_f32_16x16x32_bf16 v[128:131], a[32:35], v[28:31], v[128:131]
	s_waitcnt lgkmcnt(13)
	v_exp_f32 v51, v51
	v_cvt_pk_bf16_f32 v34, v52, v53
	v_mfma_f32_16x16x32_bf16 v[132:135], a[36:39], v[28:31], v[132:135]
	s_waitcnt lgkmcnt(11)
	v_exp_f32 v54, v54
	v_mfma_f32_16x16x32_bf16 v[136:139], a[40:43], v[28:31], v[136:139]
	s_waitcnt lgkmcnt(9)
	v_cvt_pk_bf16_f32 v33, v50, v51
	v_exp_f32 v55, v55
	v_mfma_f32_16x16x32_bf16 v[140:143], a[44:47], v[28:31], v[140:143]
	s_waitcnt lgkmcnt(7)
	ds_read_b128 a[68:71], v10 offset:256
	v_cvt_pk_bf16_f32 v35, v54, v55
	v_mfma_f32_16x16x32_bf16 v[144:147], a[48:51], v[28:31], v[144:147]
	s_waitcnt lgkmcnt(6)
	buffer_load_dwordx4 v3, s[12:15], s49 offen offset:2048 nt lds
	v_add_f32 v25, v25, v48
	v_add_f32 v25, v25, v49
	v_mfma_f32_16x16x32_bf16 v[148:151], a[52:55], v[28:31], v[148:151]
	s_waitcnt lgkmcnt(4)
	ds_read_b128 a[72:75], v14 offset:0
	v_add_f32 v25, v25, v50
	v_mfma_f32_16x16x32_bf16 v[152:155], a[56:59], v[28:31], v[152:155]
	s_waitcnt lgkmcnt(3)
	ds_read_b128 a[76:79], v14 offset:256
	v_add_f32 v25, v25, v51
	v_mfma_f32_16x16x32_bf16 v[156:159], a[60:63], v[28:31], v[156:159]
	ds_read_b128 a[80:83], v10 offset:4096
	v_add_f32 v25, v25, v52
	v_add_f32 v25, v25, v53
	v_mfma_f32_16x16x32_bf16 v[40:43], a[0:3], v[96:99], 0
	ds_read_b128 a[84:87], v10 offset:4352
	v_add_f32 v25, v25, v54
	v_mfma_f32_16x16x32_bf16 v[40:43], a[4:7], v[100:103], v[40:43]
	ds_read_b128 a[88:91], v14 offset:4096
	v_add_f32 v25, v25, v55
	v_mfma_f32_16x16x32_bf16 v[40:43], a[8:11], v[104:107], v[40:43]
	ds_read_b128 a[92:95], v14 offset:4352
	v_mfma_f32_16x16x32_bf16 v[40:43], a[12:15], v[108:111], v[40:43]
	ds_read_b64_tr_b16 a[96:97], v18 offset:8192
	v_exp_f32 v56, v56
	v_mfma_f32_16x16x32_bf16 v[44:47], a[16:19], v[96:99], 0
	s_add_u32 m0, s48, 90112
	v_exp_f32 v57, v57
	v_mfma_f32_16x16x32_bf16 v[44:47], a[20:23], v[100:103], v[44:47]
	v_cvt_pk_bf16_f32 v36, v56, v57
	v_exp_f32 v60, v60
	v_mfma_f32_16x16x32_bf16 v[44:47], a[24:27], v[104:107], v[44:47]
	v_exp_f32 v61, v61
	v_mfma_f32_16x16x32_bf16 v[44:47], a[28:31], v[108:111], v[44:47]
	buffer_load_dwordx4 v4, s[16:19], s49 offen nt lds
	v_cvt_pk_bf16_f32 v38, v60, v61
	v_mfma_f32_16x16x32_bf16 v[160:163], a[32:35], v[32:35], v[160:163]
	v_exp_f32 v58, v58
	v_add_f32 v27, v27, v56
	v_mfma_f32_16x16x32_bf16 v[164:167], a[36:39], v[32:35], v[164:167]
	v_exp_f32 v59, v59
	v_mfma_f32_16x16x32_bf16 v[168:171], a[40:43], v[32:35], v[168:171]
	v_cvt_pk_bf16_f32 v37, v58, v59
	v_exp_f32 v62, v62
	v_mfma_f32_16x16x32_bf16 v[172:175], a[44:47], v[32:35], v[172:175]
	v_exp_f32 v63, v63
	v_mfma_f32_16x16x32_bf16 v[176:179], a[48:51], v[32:35], v[176:179]
	v_add_f32 v27, v27, v57
	v_add_f32 v27, v27, v58
	v_cvt_pk_bf16_f32 v39, v62, v63
	v_mfma_f32_16x16x32_bf16 v[180:183], a[52:55], v[32:35], v[180:183]
	v_add_f32 v27, v27, v59
	v_add_f32 v27, v27, v60
	v_mfma_f32_16x16x32_bf16 v[184:187], a[56:59], v[32:35], v[184:187]
	v_add_f32 v27, v27, v61
	v_add_f32 v27, v27, v62
	v_add_f32 v27, v27, v63
	v_mfma_f32_16x16x32_bf16 v[188:191], a[60:63], v[32:35], v[188:191]
	s_waitcnt lgkmcnt(8)
	v_exp_f32 v40, v40
	v_mfma_f32_16x16x32_bf16 v[48:51], a[64:67], v[64:67], 0
	s_waitcnt lgkmcnt(7)
	v_exp_f32 v41, v41
	v_mfma_f32_16x16x32_bf16 v[48:51], a[68:71], v[68:71], v[48:51]
	s_waitcnt lgkmcnt(6)
	v_cvt_pk_bf16_f32 v28, v40, v41
	v_exp_f32 v44, v44
	v_mfma_f32_16x16x32_bf16 v[48:51], a[72:75], v[72:75], v[48:51]
	s_waitcnt lgkmcnt(5)
	buffer_load_dwordx4 v4, s[16:19], s49 offen offset:2048 nt lds
	v_add_f32 v26, v26, v40
	v_mfma_f32_16x16x32_bf16 v[48:51], a[76:79], v[76:79], v[48:51]
	s_waitcnt lgkmcnt(4)
	ds_read_b64_tr_b16 a[98:99], v18 offset:12288
	v_exp_f32 v45, v45
	v_mfma_f32_16x16x32_bf16 v[52:55], a[80:83], v[64:67], 0
	s_waitcnt lgkmcnt(4)
	v_exp_f32 v42, v42
	v_mfma_f32_16x16x32_bf16 v[52:55], a[84:87], v[68:71], v[52:55]
	s_waitcnt lgkmcnt(3)
	v_exp_f32 v43, v43
	v_cvt_pk_bf16_f32 v30, v44, v45
	v_mfma_f32_16x16x32_bf16 v[52:55], a[88:91], v[72:75], v[52:55]
	s_waitcnt lgkmcnt(2)
	v_exp_f32 v46, v46
	v_mfma_f32_16x16x32_bf16 v[52:55], a[92:95], v[76:79], v[52:55]
	v_cvt_pk_bf16_f32 v29, v42, v43
	v_exp_f32 v47, v47
	v_mfma_f32_16x16x32_bf16 v[224:227], a[32:35], v[36:39], v[224:227]
	ds_read_b64_tr_b16 a[100:101], v22 offset:8192
	v_cvt_pk_bf16_f32 v31, v46, v47
	v_mfma_f32_16x16x32_bf16 v[228:231], a[36:39], v[36:39], v[228:231]
	ds_read_b64_tr_b16 a[102:103], v22 offset:12288
	v_add_f32 v26, v26, v41
	v_mfma_f32_16x16x32_bf16 v[232:235], a[40:43], v[36:39], v[232:235]
	s_add_u32 m0, s62, 98304
	ds_read_b64_tr_b16 a[104:105], v18 offset:8448
	v_add_f32 v26, v26, v42
	v_add_f32 v26, v26, v43
	v_mfma_f32_16x16x32_bf16 v[236:239], a[44:47], v[36:39], v[236:239]
	s_add_u32 s50, s5, 0
	ds_read_b64_tr_b16 a[106:107], v18 offset:12544
	v_add_f32 v26, v26, v44
	v_mfma_f32_16x16x32_bf16 v[240:243], a[48:51], v[36:39], v[240:243]
	ds_read_b64_tr_b16 a[108:109], v22 offset:8448
	v_add_f32 v26, v26, v45
	v_add_f32 v26, v26, v46
	v_mfma_f32_16x16x32_bf16 v[244:247], a[52:55], v[36:39], v[244:247]
	buffer_load_dwordx4 v5, s[24:27], s50 offen lds
	v_add_f32 v26, v26, v47
	v_mfma_f32_16x16x32_bf16 v[248:251], a[56:59], v[36:39], v[248:251]
	s_add_u32 m0, s62, 99328
	ds_read_b64_tr_b16 a[110:111], v22 offset:12544
	v_exp_f32 v48, v48
	v_mfma_f32_16x16x32_bf16 v[252:255], a[60:63], v[36:39], v[252:255]
	s_add_u32 s50, s5, 9216
	ds_read_b64_tr_b16 a[112:113], v18 offset:8704
	v_add_f32 v24, v24, v48
	v_mfma_f32_16x16x32_bf16 v[56:59], a[64:67], v[80:83], 0
	buffer_load_dwordx4 v5, s[24:27], s50 offen lds
	v_exp_f32 v49, v49
	v_mfma_f32_16x16x32_bf16 v[56:59], a[68:71], v[84:87], v[56:59]
	s_add_u32 m0, s62, 100352
	ds_read_b64_tr_b16 a[114:115], v18 offset:12800
	v_cvt_pk_bf16_f32 v32, v48, v49
	v_mfma_f32_16x16x32_bf16 v[56:59], a[72:75], v[88:91], v[56:59]
	s_add_u32 s50, s5, 18432
	ds_read_b64_tr_b16 a[116:117], v22 offset:8704
	v_exp_f32 v52, v52
	v_mfma_f32_16x16x32_bf16 v[56:59], a[76:79], v[92:95], v[56:59]
	buffer_load_dwordx4 v5, s[24:27], s50 offen lds
	v_add_f32 v24, v24, v49
	v_mfma_f32_16x16x32_bf16 v[60:63], a[80:83], v[80:83], 0
	ds_read_b64_tr_b16 a[118:119], v22 offset:12800
	v_mfma_f32_16x16x32_bf16 v[60:63], a[84:87], v[84:87], v[60:63]
	ds_read_b64_tr_b16 a[120:121], v18 offset:8960
	v_exp_f32 v53, v53
	v_mfma_f32_16x16x32_bf16 v[60:63], a[88:91], v[88:91], v[60:63]
	s_add_u32 m0, s62, 101376
	ds_read_b64_tr_b16 a[122:123], v18 offset:13056
	v_cvt_pk_bf16_f32 v34, v52, v53
	v_mfma_f32_16x16x32_bf16 v[60:63], a[92:95], v[92:95], v[60:63]
	s_add_u32 s50, s5, 27648
	ds_read_b64_tr_b16 a[124:125], v22 offset:8960
	v_exp_f32 v50, v50
	v_mfma_f32_16x16x32_bf16 v[192:195], a[32:35], v[28:31], v[192:195]
	ds_read_b64_tr_b16 a[126:127], v22 offset:13056
	v_add_f32 v24, v24, v50
	v_mfma_f32_16x16x32_bf16 v[196:199], a[36:39], v[28:31], v[196:199]
	buffer_load_dwordx4 v5, s[24:27], s50 offen lds
	v_exp_f32 v51, v51
	v_mfma_f32_16x16x32_bf16 v[200:203], a[40:43], v[28:31], v[200:203]
	s_add_u32 m0, s62, 102400
	s_add_u32 s50, s5, 36864
	buffer_load_dwordx4 v5, s[24:27], s50 offen lds
	v_cvt_pk_bf16_f32 v33, v50, v51
	v_mfma_f32_16x16x32_bf16 v[204:207], a[44:47], v[28:31], v[204:207]
	s_add_u32 m0, s62, 103424
	v_add_f32 v24, v24, v51
	v_exp_f32 v54, v54
	v_mfma_f32_16x16x32_bf16 v[208:211], a[48:51], v[28:31], v[208:211]
	s_waitcnt vmcnt(21) lgkmcnt(0)
	s_barrier
	s_add_u32 s50, s5, 46080
	buffer_load_dwordx4 v5, s[24:27], s50 offen lds
	v_add_f32 v24, v24, v52
	v_mfma_f32_16x16x32_bf16 v[212:215], a[52:55], v[28:31], v[212:215]
	s_add_u32 m0, s62, 104448
	v_exp_f32 v55, v55
	v_mfma_f32_16x16x32_bf16 v[216:219], a[56:59], v[28:31], v[216:219]
	s_add_u32 s50, s5, 55296
	ds_read_b128 a[0:3], v8 offset:32768
	v_add_f32 v24, v24, v53
	v_cvt_pk_bf16_f32 v35, v54, v55
	v_mfma_f32_16x16x32_bf16 v[220:223], a[60:63], v[28:31], v[220:223]
	buffer_load_dwordx4 v5, s[24:27], s50 offen lds
	v_add_f32 v24, v24, v54
	v_mfma_f32_16x16x32_bf16 v[40:43], a[64:67], v[96:99], 0
	s_add_u32 m0, s62, 105472
	ds_read_b128 a[4:7], v8 offset:33024
	v_add_f32 v24, v24, v55
	v_mfma_f32_16x16x32_bf16 v[40:43], a[68:71], v[100:103], v[40:43]
	s_add_u32 s50, s5, 64512
	ds_read_b128 a[8:11], v12 offset:32768
	v_mfma_f32_16x16x32_bf16 v[40:43], a[72:75], v[104:107], v[40:43]
	buffer_load_dwordx4 v5, s[24:27], s50 offen lds
	v_exp_f32 v56, v56
	v_mfma_f32_16x16x32_bf16 v[40:43], a[76:79], v[108:111], v[40:43]
	s_add_u32 m0, s48, 0
	ds_read_b128 a[12:15], v12 offset:33024
	v_add_f32 v25, v25, v56
	v_mfma_f32_16x16x32_bf16 v[44:47], a[80:83], v[96:99], 0
	s_add_u32 s49, s63, 98304
	ds_read_b128 a[16:19], v8 offset:36864
	v_exp_f32 v57, v57
	v_mfma_f32_16x16x32_bf16 v[44:47], a[84:87], v[100:103], v[44:47]
	s_and_b32 s49, s49, 0x1ffff
	buffer_load_dwordx4 v3, s[12:15], s49 offen nt lds
	v_cvt_pk_bf16_f32 v36, v56, v57
	v_mfma_f32_16x16x32_bf16 v[44:47], a[88:91], v[104:107], v[44:47]
	ds_read_b128 a[20:23], v8 offset:37120
	v_add_f32 v25, v25, v57
	v_mfma_f32_16x16x32_bf16 v[44:47], a[92:95], v[108:111], v[44:47]
	ds_read_b128 a[24:27], v12 offset:36864
	v_exp_f32 v60, v60
	v_mfma_f32_16x16x32_bf16 v[128:131], a[96:99], v[32:35], v[128:131]
	ds_read_b128 a[28:31], v12 offset:37120
	v_mfma_f32_16x16x32_bf16 v[132:135], a[100:103], v[32:35], v[132:135]
	s_waitcnt vmcnt(21)
	ds_read_b64_tr_b16 a[160:161], v6 offset:0
	v_exp_f32 v61, v61
	v_mfma_f32_16x16x32_bf16 v[136:139], a[104:107], v[32:35], v[136:139]
	v_exp_f32 v58, v58
	v_mfma_f32_16x16x32_bf16 v[140:143], a[108:111], v[32:35], v[140:143]
	v_exp_f32 v59, v59
	v_cvt_pk_bf16_f32 v38, v60, v61
	v_mfma_f32_16x16x32_bf16 v[144:147], a[112:115], v[32:35], v[144:147]
	v_exp_f32 v62, v62
	v_mfma_f32_16x16x32_bf16 v[148:151], a[116:119], v[32:35], v[148:151]
	v_cvt_pk_bf16_f32 v37, v58, v59
	v_exp_f32 v63, v63
	v_mfma_f32_16x16x32_bf16 v[152:155], a[120:123], v[32:35], v[152:155]
	v_add_f32 v25, v25, v58
	v_cvt_pk_bf16_f32 v39, v62, v63
	v_mfma_f32_16x16x32_bf16 v[156:159], a[124:127], v[32:35], v[156:159]
	s_waitcnt lgkmcnt(8)
	v_add_f32 v25, v25, v59
	v_add_f32 v25, v25, v60
	v_mfma_f32_16x16x32_bf16 v[48:51], a[0:3], v[64:67], 0
	s_waitcnt lgkmcnt(7)
	buffer_load_dwordx4 v3, s[12:15], s49 offen offset:2048 nt lds
	v_add_f32 v25, v25, v61
	v_add_f32 v25, v25, v62
	v_mfma_f32_16x16x32_bf16 v[48:51], a[4:7], v[68:71], v[48:51]
	s_waitcnt lgkmcnt(6)
	ds_read_b64_tr_b16 a[162:163], v6 offset:2048
	v_add_f32 v25, v25, v63
	v_mfma_f32_16x16x32_bf16 v[48:51], a[8:11], v[72:75], v[48:51]
	s_waitcnt lgkmcnt(6)
	ds_read_b64_tr_b16 a[164:165], v7 offset:0
	v_exp_f32 v40, v40
	v_mfma_f32_16x16x32_bf16 v[48:51], a[12:15], v[76:79], v[48:51]
	s_waitcnt lgkmcnt(6)
	v_exp_f32 v41, v41
	v_mfma_f32_16x16x32_bf16 v[52:55], a[16:19], v[64:67], 0
	s_waitcnt lgkmcnt(5)
	ds_read_b64_tr_b16 a[166:167], v7 offset:2048
	v_exp_f32 v44, v44
	v_mfma_f32_16x16x32_bf16 v[52:55], a[20:23], v[68:71], v[52:55]
	s_waitcnt lgkmcnt(5)
	v_exp_f32 v45, v45
	v_mfma_f32_16x16x32_bf16 v[52:55], a[24:27], v[72:75], v[52:55]
	s_waitcnt lgkmcnt(4)
	ds_read_b64_tr_b16 a[168:169], v6 offset:512
	v_exp_f32 v42, v42
	v_mfma_f32_16x16x32_bf16 v[52:55], a[28:31], v[76:79], v[52:55]
	ds_read_b64_tr_b16 a[170:171], v6 offset:2560
	v_cvt_pk_bf16_f32 v28, v40, v41
	v_mfma_f32_16x16x32_bf16 v[160:163], a[96:99], v[36:39], v[160:163]
	s_add_u32 m0, s48, 8192
	ds_read_b64_tr_b16 a[172:173], v7 offset:512
	v_cvt_pk_bf16_f32 v30, v44, v45
	v_mfma_f32_16x16x32_bf16 v[164:167], a[100:103], v[36:39], v[164:167]
	ds_read_b64_tr_b16 a[174:175], v7 offset:2560
	v_exp_f32 v43, v43
	v_mfma_f32_16x16x32_bf16 v[168:171], a[104:107], v[36:39], v[168:171]
	s_waitcnt vmcnt(18)
	ds_read_b64_tr_b16 a[176:177], v6 offset:4096
	v_cvt_pk_bf16_f32 v29, v42, v43
	v_mfma_f32_16x16x32_bf16 v[172:175], a[108:111], v[36:39], v[172:175]
	buffer_load_dwordx4 v4, s[16:19], s49 offen nt lds
	v_exp_f32 v46, v46
	v_mfma_f32_16x16x32_bf16 v[176:179], a[112:115], v[36:39], v[176:179]
	ds_read_b64_tr_b16 a[178:179], v6 offset:6144
	v_add_f32 v26, v26, v40
	v_mfma_f32_16x16x32_bf16 v[180:183], a[116:119], v[36:39], v[180:183]
	ds_read_b64_tr_b16 a[180:181], v7 offset:4096
	v_exp_f32 v47, v47
	v_mfma_f32_16x16x32_bf16 v[184:187], a[120:123], v[36:39], v[184:187]
	ds_read_b64_tr_b16 a[182:183], v7 offset:6144
	v_cvt_pk_bf16_f32 v31, v46, v47
	v_mfma_f32_16x16x32_bf16 v[188:191], a[124:127], v[36:39], v[188:191]
	ds_read_b64_tr_b16 a[184:185], v6 offset:4608
	v_add_f32 v26, v26, v41
	v_add_f32 v26, v26, v42
	v_mfma_f32_16x16x32_bf16 v[56:59], a[0:3], v[80:83], 0
	ds_read_b64_tr_b16 a[186:187], v6 offset:6656
	v_add_f32 v26, v26, v43
	v_mfma_f32_16x16x32_bf16 v[56:59], a[4:7], v[84:87], v[56:59]
	ds_read_b64_tr_b16 a[188:189], v7 offset:4608
	v_add_f32 v26, v26, v44
	v_add_f32 v26, v26, v45
	v_mfma_f32_16x16x32_bf16 v[56:59], a[8:11], v[88:91], v[56:59]
	ds_read_b64_tr_b16 a[190:191], v7 offset:6656
	v_add_f32 v26, v26, v46
	v_mfma_f32_16x16x32_bf16 v[56:59], a[12:15], v[92:95], v[56:59]
	ds_read_b64_tr_b16 a[32:33], v16 offset:40960
	v_add_f32 v26, v26, v47
	v_mfma_f32_16x16x32_bf16 v[60:63], a[16:19], v[80:83], 0
	ds_read_b64_tr_b16 a[34:35], v16 offset:45056
	v_exp_f32 v48, v48
	v_mfma_f32_16x16x32_bf16 v[60:63], a[20:23], v[84:87], v[60:63]
	ds_read_b64_tr_b16 a[36:37], v20 offset:40960
	v_add_f32 v24, v24, v48
	v_mfma_f32_16x16x32_bf16 v[60:63], a[24:27], v[88:91], v[60:63]
	buffer_load_dwordx4 v4, s[16:19], s49 offen offset:2048 nt lds
	v_exp_f32 v49, v49
	v_mfma_f32_16x16x32_bf16 v[60:63], a[28:31], v[92:95], v[60:63]
	ds_read_b64_tr_b16 a[38:39], v20 offset:45056
	v_cvt_pk_bf16_f32 v32, v48, v49
	v_mfma_f32_16x16x32_bf16 v[192:195], a[96:99], v[28:31], v[192:195]
	ds_read_b64_tr_b16 a[40:41], v16 offset:41216
	v_exp_f32 v52, v52
	v_mfma_f32_16x16x32_bf16 v[196:199], a[100:103], v[28:31], v[196:199]
	ds_read_b64_tr_b16 a[42:43], v16 offset:45312
	v_add_f32 v24, v24, v49
	v_mfma_f32_16x16x32_bf16 v[200:203], a[104:107], v[28:31], v[200:203]
	ds_read_b64_tr_b16 a[44:45], v20 offset:41216
	v_exp_f32 v53, v53
	v_mfma_f32_16x16x32_bf16 v[204:207], a[108:111], v[28:31], v[204:207]
	ds_read_b64_tr_b16 a[46:47], v20 offset:45312
	v_cvt_pk_bf16_f32 v34, v52, v53
	v_mfma_f32_16x16x32_bf16 v[208:211], a[112:115], v[28:31], v[208:211]
	ds_read_b64_tr_b16 a[48:49], v16 offset:41472
	v_mfma_f32_16x16x32_bf16 v[212:215], a[116:119], v[28:31], v[212:215]
	ds_read_b64_tr_b16 a[50:51], v16 offset:45568
	v_exp_f32 v50, v50
	v_mfma_f32_16x16x32_bf16 v[216:219], a[120:123], v[28:31], v[216:219]
	s_add_u32 m0, s48, 16384
	ds_read_b64_tr_b16 a[52:53], v20 offset:41472
	v_add_f32 v24, v24, v50
	v_mfma_f32_16x16x32_bf16 v[220:223], a[124:127], v[28:31], v[220:223]
	s_add_u32 s49, s63, 106496
	ds_read_b64_tr_b16 a[54:55], v20 offset:45568
	v_exp_f32 v51, v51
	v_mfma_f32_16x16x32_bf16 v[40:43], a[0:3], v[112:115], 0
	s_and_b32 s49, s49, 0x1ffff
	v_exp_f32 v54, v54
	v_mfma_f32_16x16x32_bf16 v[40:43], a[4:7], v[116:119], v[40:43]
	buffer_load_dwordx4 v3, s[12:15], s49 offen nt lds
	v_exp_f32 v55, v55
	v_mfma_f32_16x16x32_bf16 v[40:43], a[8:11], v[120:123], v[40:43]
	ds_read_b64_tr_b16 a[56:57], v16 offset:41728
	v_cvt_pk_bf16_f32 v33, v50, v51
	v_mfma_f32_16x16x32_bf16 v[40:43], a[12:15], v[124:127], v[40:43]
	ds_read_b64_tr_b16 a[58:59], v16 offset:45824
	v_add_f32 v24, v24, v51
	v_cvt_pk_bf16_f32 v35, v54, v55
	v_mfma_f32_16x16x32_bf16 v[44:47], a[16:19], v[112:115], 0
	ds_read_b64_tr_b16 a[60:61], v20 offset:41728
	v_add_f32 v24, v24, v52
	v_mfma_f32_16x16x32_bf16 v[44:47], a[20:23], v[116:119], v[44:47]
	ds_read_b64_tr_b16 a[62:63], v20 offset:45824
	v_add_f32 v24, v24, v53
	v_mfma_f32_16x16x32_bf16 v[44:47], a[24:27], v[120:123], v[44:47]
	ds_read_b128 a[64:67], v10 offset:32768
	v_add_f32 v24, v24, v54
	v_add_f32 v24, v24, v55
	v_mfma_f32_16x16x32_bf16 v[44:47], a[28:31], v[124:127], v[44:47]
	s_waitcnt lgkmcnt(15)
	v_exp_f32 v56, v56
	v_mfma_f32_16x16x32_bf16 v[128:131], a[32:35], v[32:35], v[128:131]
	s_waitcnt lgkmcnt(13)
	ds_read_b128 a[68:71], v10 offset:33024
	v_exp_f32 v57, v57
	v_mfma_f32_16x16x32_bf16 v[132:135], a[36:39], v[32:35], v[132:135]
	s_waitcnt lgkmcnt(12)
	v_exp_f32 v60, v60
	v_mfma_f32_16x16x32_bf16 v[136:139], a[40:43], v[32:35], v[136:139]
	s_waitcnt lgkmcnt(10)
	v_cvt_pk_bf16_f32 v36, v56, v57
	v_exp_f32 v61, v61
	v_mfma_f32_16x16x32_bf16 v[140:143], a[44:47], v[32:35], v[140:143]
	s_waitcnt lgkmcnt(8)
	v_exp_f32 v58, v58
	v_mfma_f32_16x16x32_bf16 v[144:147], a[48:51], v[32:35], v[144:147]
	s_waitcnt lgkmcnt(6)
	buffer_load_dwordx4 v3, s[12:15], s49 offen offset:2048 nt lds
	v_exp_f32 v59, v59
	v_mfma_f32_16x16x32_bf16 v[148:151], a[52:55], v[32:35], v[148:151]
	s_waitcnt lgkmcnt(4)
	v_exp_f32 v62, v62
	v_mfma_f32_16x16x32_bf16 v[152:155], a[56:59], v[32:35], v[152:155]
	s_waitcnt lgkmcnt(2)
	v_exp_f32 v63, v63
	v_mfma_f32_16x16x32_bf16 v[156:159], a[60:63], v[32:35], v[156:159]
	v_cvt_pk_bf16_f32 v37, v58, v59
	v_cvt_pk_bf16_f32 v38, v60, v61
	v_cvt_pk_bf16_f32 v39, v62, v63
	v_mfma_f32_16x16x32_bf16 v[48:51], a[0:3], v[96:99], 0
	ds_read_b128 a[72:75], v14 offset:32768
	v_add_f32 v25, v25, v56
	v_mfma_f32_16x16x32_bf16 v[48:51], a[4:7], v[100:103], v[48:51]
	ds_read_b128 a[76:79], v14 offset:33024
	v_add_f32 v25, v25, v57
	v_add_f32 v25, v25, v58
	v_mfma_f32_16x16x32_bf16 v[48:51], a[8:11], v[104:107], v[48:51]
	ds_read_b128 a[80:83], v10 offset:36864
	v_add_f32 v25, v25, v59
	v_mfma_f32_16x16x32_bf16 v[48:51], a[12:15], v[108:111], v[48:51]
	ds_read_b128 a[84:87], v10 offset:37120
	v_add_f32 v25, v25, v60
	v_add_f32 v25, v25, v61
	v_mfma_f32_16x16x32_bf16 v[52:55], a[16:19], v[96:99], 0
	s_add_u32 m0, s48, 24576
	ds_read_b128 a[88:91], v14 offset:36864
	v_add_f32 v25, v25, v62
	v_mfma_f32_16x16x32_bf16 v[52:55], a[20:23], v[100:103], v[52:55]
	ds_read_b128 a[92:95], v14 offset:37120
	v_add_f32 v25, v25, v63
	v_mfma_f32_16x16x32_bf16 v[52:55], a[24:27], v[104:107], v[52:55]
	v_exp_f32 v40, v40
	v_mfma_f32_16x16x32_bf16 v[52:55], a[28:31], v[108:111], v[52:55]
	buffer_load_dwordx4 v4, s[16:19], s49 offen nt lds
	v_add_f32 v27, v27, v40
	v_mfma_f32_16x16x32_bf16 v[160:163], a[32:35], v[36:39], v[160:163]
	ds_read_b64_tr_b16 a[96:97], v18 offset:40960
	v_exp_f32 v41, v41
	v_mfma_f32_16x16x32_bf16 v[164:167], a[36:39], v[36:39], v[164:167]
	v_exp_f32 v44, v44
	v_mfma_f32_16x16x32_bf16 v[168:171], a[40:43], v[36:39], v[168:171]
	v_cvt_pk_bf16_f32 v28, v40, v41
	v_exp_f32 v45, v45
	v_mfma_f32_16x16x32_bf16 v[172:175], a[44:47], v[36:39], v[172:175]
	v_exp_f32 v42, v42
	v_mfma_f32_16x16x32_bf16 v[176:179], a[48:51], v[36:39], v[176:179]
	v_exp_f32 v43, v43
	v_cvt_pk_bf16_f32 v30, v44, v45
	v_mfma_f32_16x16x32_bf16 v[180:183], a[52:55], v[36:39], v[180:183]
	v_exp_f32 v46, v46
	v_mfma_f32_16x16x32_bf16 v[184:187], a[56:59], v[36:39], v[184:187]
	v_cvt_pk_bf16_f32 v29, v42, v43
	v_exp_f32 v47, v47
	v_mfma_f32_16x16x32_bf16 v[188:191], a[60:63], v[36:39], v[188:191]
	s_waitcnt lgkmcnt(8)
	v_add_f32 v27, v27, v41
	v_cvt_pk_bf16_f32 v31, v46, v47
	v_mfma_f32_16x16x32_bf16 v[56:59], a[64:67], v[64:67], 0
	s_waitcnt lgkmcnt(7)
	v_add_f32 v27, v27, v42
	v_add_f32 v27, v27, v43
	v_mfma_f32_16x16x32_bf16 v[56:59], a[68:71], v[68:71], v[56:59]
	s_waitcnt lgkmcnt(6)
	v_add_f32 v27, v27, v44
	v_add_f32 v27, v27, v45
	v_add_f32 v27, v27, v46
	v_mfma_f32_16x16x32_bf16 v[56:59], a[72:75], v[72:75], v[56:59]
	s_waitcnt lgkmcnt(5)
	buffer_load_dwordx4 v4, s[16:19], s49 offen offset:2048 nt lds
	v_add_f32 v27, v27, v47
	v_mfma_f32_16x16x32_bf16 v[56:59], a[76:79], v[76:79], v[56:59]
	s_waitcnt lgkmcnt(4)
	ds_read_b64_tr_b16 a[98:99], v18 offset:45056
	v_exp_f32 v48, v48
	v_mfma_f32_16x16x32_bf16 v[60:63], a[80:83], v[64:67], 0
	s_waitcnt lgkmcnt(4)
	v_exp_f32 v49, v49
	v_mfma_f32_16x16x32_bf16 v[60:63], a[84:87], v[68:71], v[60:63]
	s_waitcnt lgkmcnt(3)
	v_cvt_pk_bf16_f32 v32, v48, v49
	v_exp_f32 v52, v52
	v_mfma_f32_16x16x32_bf16 v[60:63], a[88:91], v[72:75], v[60:63]
	s_waitcnt lgkmcnt(2)
	v_exp_f32 v53, v53
	v_mfma_f32_16x16x32_bf16 v[60:63], a[92:95], v[76:79], v[60:63]
	v_exp_f32 v50, v50
	v_cvt_pk_bf16_f32 v34, v52, v53
	v_mfma_f32_16x16x32_bf16 v[224:227], a[32:35], v[28:31], v[224:227]
	v_exp_f32 v51, v51
	v_mfma_f32_16x16x32_bf16 v[228:231], a[36:39], v[28:31], v[228:231]
	v_cvt_pk_bf16_f32 v33, v50, v51
	v_exp_f32 v54, v54
	v_mfma_f32_16x16x32_bf16 v[232:235], a[40:43], v[28:31], v[232:235]
	s_add_u32 m0, s62, 131072
	v_exp_f32 v55, v55
	v_mfma_f32_16x16x32_bf16 v[236:239], a[44:47], v[28:31], v[236:239]
	s_add_u32 s50, s5, 73728
	ds_read_b64_tr_b16 a[100:101], v22 offset:40960
	v_cvt_pk_bf16_f32 v35, v54, v55
	v_mfma_f32_16x16x32_bf16 v[240:243], a[48:51], v[28:31], v[240:243]
	ds_read_b64_tr_b16 a[102:103], v22 offset:45056
	v_add_f32 v26, v26, v48
	v_add_f32 v26, v26, v49
	v_mfma_f32_16x16x32_bf16 v[244:247], a[52:55], v[28:31], v[244:247]
	buffer_load_dwordx4 v5, s[24:27], s50 offen lds
	v_add_f32 v26, v26, v50
	v_mfma_f32_16x16x32_bf16 v[248:251], a[56:59], v[28:31], v[248:251]
	s_add_u32 m0, s62, 132096
	ds_read_b64_tr_b16 a[104:105], v18 offset:41216
	v_add_f32 v26, v26, v51
	v_add_f32 v26, v26, v52
	v_mfma_f32_16x16x32_bf16 v[252:255], a[60:63], v[28:31], v[252:255]
	s_add_u32 s50, s5, 82944
	ds_read_b64_tr_b16 a[106:107], v18 offset:45312
	v_add_f32 v26, v26, v53
	v_mfma_f32_16x16x32_bf16 v[40:43], a[64:67], v[80:83], 0
	buffer_load_dwordx4 v5, s[24:27], s50 offen lds
	v_add_f32 v26, v26, v54
	v_add_f32 v26, v26, v55
	v_mfma_f32_16x16x32_bf16 v[40:43], a[68:71], v[84:87], v[40:43]
	s_add_u32 m0, s62, 133120
	ds_read_b64_tr_b16 a[108:109], v22 offset:41216
	v_mfma_f32_16x16x32_bf16 v[40:43], a[72:75], v[88:91], v[40:43]
	s_add_u32 s50, s5, 92160
	ds_read_b64_tr_b16 a[110:111], v22 offset:45312
	v_exp_f32 v56, v56
	v_mfma_f32_16x16x32_bf16 v[40:43], a[76:79], v[92:95], v[40:43]
	buffer_load_dwordx4 v5, s[24:27], s50 offen lds
	v_add_f32 v24, v24, v56
	v_mfma_f32_16x16x32_bf16 v[44:47], a[80:83], v[80:83], 0
	ds_read_b64_tr_b16 a[112:113], v18 offset:41472
	v_mfma_f32_16x16x32_bf16 v[44:47], a[84:87], v[84:87], v[44:47]
	ds_read_b64_tr_b16 a[114:115], v18 offset:45568
	v_exp_f32 v57, v57
	v_mfma_f32_16x16x32_bf16 v[44:47], a[88:91], v[88:91], v[44:47]
	s_add_u32 m0, s62, 134144
	ds_read_b64_tr_b16 a[116:117], v22 offset:41472
	v_cvt_pk_bf16_f32 v36, v56, v57
	v_mfma_f32_16x16x32_bf16 v[44:47], a[92:95], v[92:95], v[44:47]
	s_add_u32 s50, s5, 101376
	ds_read_b64_tr_b16 a[118:119], v22 offset:45568
	v_exp_f32 v60, v60
	v_mfma_f32_16x16x32_bf16 v[192:195], a[32:35], v[32:35], v[192:195]
	ds_read_b64_tr_b16 a[120:121], v18 offset:41728
	ds_read_b64_tr_b16 a[122:123], v18 offset:45824
	ds_read_b64_tr_b16 a[124:125], v22 offset:41728
	ds_read_b64_tr_b16 a[126:127], v22 offset:45824
	v_mfma_f32_16x16x32_bf16 v[196:199], a[36:39], v[32:35], v[196:199]
	buffer_load_dwordx4 v5, s[24:27], s50 offen lds
	v_exp_f32 v61, v61
	v_mfma_f32_16x16x32_bf16 v[200:203], a[40:43], v[32:35], v[200:203]
	s_add_u32 m0, s62, 135168
	s_add_u32 s50, s5, 110592
	buffer_load_dwordx4 v5, s[24:27], s50 offen lds
	v_cvt_pk_bf16_f32 v38, v60, v61
	v_mfma_f32_16x16x32_bf16 v[204:207], a[44:47], v[32:35], v[204:207]
	s_add_u32 m0, s62, 136192
	v_exp_f32 v58, v58
	v_add_f32 v24, v24, v57
	v_mfma_f32_16x16x32_bf16 v[208:211], a[48:51], v[32:35], v[208:211]
	s_waitcnt vmcnt(21) lgkmcnt(0)
	s_barrier
	s_add_u32 s50, s5, 119808
	buffer_load_dwordx4 v5, s[24:27], s50 offen lds
	v_add_f32 v24, v24, v58
	v_mfma_f32_16x16x32_bf16 v[212:215], a[52:55], v[32:35], v[212:215]
	s_add_u32 m0, s62, 137216
	v_exp_f32 v59, v59
	v_mfma_f32_16x16x32_bf16 v[216:219], a[56:59], v[32:35], v[216:219]
	s_add_u32 s50, s5, 129024
	v_cvt_pk_bf16_f32 v37, v58, v59
	v_exp_f32 v62, v62
	v_mfma_f32_16x16x32_bf16 v[220:223], a[60:63], v[32:35], v[220:223]
	buffer_load_dwordx4 v5, s[24:27], s50 offen lds
	v_add_f32 v24, v24, v59
	v_mfma_f32_16x16x32_bf16 v[48:51], a[64:67], v[96:99], 0
	s_add_u32 m0, s62, 138240
	ds_read_b128 a[0:3], v9 offset:0
	v_exp_f32 v63, v63
	v_mfma_f32_16x16x32_bf16 v[48:51], a[68:71], v[100:103], v[48:51]
	s_add_u32 s50, s5, 138240
	ds_read_b128 a[4:7], v9 offset:256
	v_cvt_pk_bf16_f32 v39, v62, v63
	v_mfma_f32_16x16x32_bf16 v[48:51], a[72:75], v[104:107], v[48:51]
	buffer_load_dwordx4 v5, s[24:27], s50 offen lds
	v_add_f32 v24, v24, v60
	v_add_f32 v24, v24, v61
	v_mfma_f32_16x16x32_bf16 v[48:51], a[76:79], v[108:111], v[48:51]
	s_add_u32 m0, s48, 32768
	ds_read_b128 a[8:11], v13 offset:0
	v_add_f32 v24, v24, v62
	v_mfma_f32_16x16x32_bf16 v[52:55], a[80:83], v[96:99], 0
	s_add_u32 s49, s63, 114688
	ds_read_b128 a[12:15], v13 offset:256
	v_add_f32 v24, v24, v63
	v_mfma_f32_16x16x32_bf16 v[52:55], a[84:87], v[100:103], v[52:55]
	s_and_b32 s49, s49, 0x1ffff
	buffer_load_dwordx4 v3, s[12:15], s49 offen nt lds
	v_mfma_f32_16x16x32_bf16 v[52:55], a[88:91], v[104:107], v[52:55]
	ds_read_b128 a[16:19], v9 offset:4096
	v_mfma_f32_16x16x32_bf16 v[52:55], a[92:95], v[108:111], v[52:55]
	ds_read_b128 a[20:23], v9 offset:4352
	v_exp_f32 v40, v40
	v_mfma_f32_16x16x32_bf16 v[128:131], a[96:99], v[36:39], v[128:131]
	ds_read_b128 a[24:27], v13 offset:4096
	v_add_f32 v25, v25, v40
	v_mfma_f32_16x16x32_bf16 v[132:135], a[100:103], v[36:39], v[132:135]
	ds_read_b128 a[28:31], v13 offset:4352
	v_exp_f32 v41, v41
	v_mfma_f32_16x16x32_bf16 v[136:139], a[104:107], v[36:39], v[136:139]
	v_exp_f32 v44, v44
	v_mfma_f32_16x16x32_bf16 v[140:143], a[108:111], v[36:39], v[140:143]
	v_cvt_pk_bf16_f32 v28, v40, v41
	v_exp_f32 v45, v45
	v_mfma_f32_16x16x32_bf16 v[144:147], a[112:115], v[36:39], v[144:147]
	v_exp_f32 v42, v42
	v_mfma_f32_16x16x32_bf16 v[148:151], a[116:119], v[36:39], v[148:151]
	v_exp_f32 v43, v43
	v_cvt_pk_bf16_f32 v30, v44, v45
	v_mfma_f32_16x16x32_bf16 v[152:155], a[120:123], v[36:39], v[152:155]
	v_exp_f32 v46, v46
	v_mfma_f32_16x16x32_bf16 v[156:159], a[124:127], v[36:39], v[156:159]
	s_waitcnt lgkmcnt(7)
	v_exp_f32 v47, v47
	v_mfma_f32_16x16x32_bf16 v[56:59], a[0:3], v[64:67], 0
	s_waitcnt lgkmcnt(6)
	buffer_load_dwordx4 v3, s[12:15], s49 offen offset:2048 nt lds
	v_cvt_pk_bf16_f32 v29, v42, v43
	v_cvt_pk_bf16_f32 v31, v46, v47
	v_mfma_f32_16x16x32_bf16 v[56:59], a[4:7], v[68:71], v[56:59]
	s_waitcnt lgkmcnt(5)
	v_add_f32 v25, v25, v41
	v_add_f32 v25, v25, v42
	v_mfma_f32_16x16x32_bf16 v[56:59], a[8:11], v[72:75], v[56:59]
	s_waitcnt lgkmcnt(4)
	v_add_f32 v25, v25, v43
	v_add_f32 v25, v25, v44
	v_add_f32 v25, v25, v45
	v_mfma_f32_16x16x32_bf16 v[56:59], a[12:15], v[76:79], v[56:59]
	s_waitcnt lgkmcnt(3)
	v_add_f32 v25, v25, v46
	v_add_f32 v25, v25, v47
	v_mfma_f32_16x16x32_bf16 v[60:63], a[16:19], v[64:67], 0
	s_waitcnt lgkmcnt(2)
	s_waitcnt vmcnt(22)
	ds_read_b64_tr_b16 a[192:193], v0 offset:32768
	v_exp_f32 v48, v48
	v_mfma_f32_16x16x32_bf16 v[60:63], a[20:23], v[68:71], v[60:63]
	s_waitcnt lgkmcnt(2)
	v_exp_f32 v49, v49
	v_mfma_f32_16x16x32_bf16 v[60:63], a[24:27], v[72:75], v[60:63]
	s_waitcnt lgkmcnt(1)
	ds_read_b64_tr_b16 a[194:195], v0 offset:34816
	v_exp_f32 v52, v52
	v_mfma_f32_16x16x32_bf16 v[60:63], a[28:31], v[76:79], v[60:63]
	v_exp_f32 v53, v53
	v_mfma_f32_16x16x32_bf16 v[160:163], a[96:99], v[28:31], v[160:163]
	s_add_u32 m0, s48, 40960
	ds_read_b64_tr_b16 a[196:197], v1 offset:32768
	v_cvt_pk_bf16_f32 v32, v48, v49
	v_mfma_f32_16x16x32_bf16 v[164:167], a[100:103], v[28:31], v[164:167]
	ds_read_b64_tr_b16 a[198:199], v1 offset:34816
	v_exp_f32 v50, v50
	v_mfma_f32_16x16x32_bf16 v[168:171], a[104:107], v[28:31], v[168:171]
	ds_read_b64_tr_b16 a[200:201], v0 offset:33280
	v_cvt_pk_bf16_f32 v34, v52, v53
	v_mfma_f32_16x16x32_bf16 v[172:175], a[108:111], v[28:31], v[172:175]
	buffer_load_dwordx4 v4, s[16:19], s49 offen nt lds
	v_exp_f32 v51, v51
	v_mfma_f32_16x16x32_bf16 v[176:179], a[112:115], v[28:31], v[176:179]
	ds_read_b64_tr_b16 a[202:203], v0 offset:35328
	v_cvt_pk_bf16_f32 v33, v50, v51
	v_mfma_f32_16x16x32_bf16 v[180:183], a[116:119], v[28:31], v[180:183]
	ds_read_b64_tr_b16 a[204:205], v1 offset:33280
	v_exp_f32 v54, v54
	v_mfma_f32_16x16x32_bf16 v[184:187], a[120:123], v[28:31], v[184:187]
	ds_read_b64_tr_b16 a[206:207], v1 offset:35328
	v_add_f32 v26, v26, v48
	v_mfma_f32_16x16x32_bf16 v[188:191], a[124:127], v[28:31], v[188:191]
	s_waitcnt vmcnt(19)
	ds_read_b64_tr_b16 a[208:209], v0 offset:36864
	v_exp_f32 v55, v55
	v_mfma_f32_16x16x32_bf16 v[40:43], a[0:3], v[80:83], 0
	ds_read_b64_tr_b16 a[210:211], v0 offset:38912
	v_cvt_pk_bf16_f32 v35, v54, v55
	v_mfma_f32_16x16x32_bf16 v[40:43], a[4:7], v[84:87], v[40:43]
	ds_read_b64_tr_b16 a[212:213], v1 offset:36864
	v_add_f32 v26, v26, v49
	v_add_f32 v26, v26, v50
	v_mfma_f32_16x16x32_bf16 v[40:43], a[8:11], v[88:91], v[40:43]
	ds_read_b64_tr_b16 a[214:215], v1 offset:38912
	v_add_f32 v26, v26, v51
	v_mfma_f32_16x16x32_bf16 v[40:43], a[12:15], v[92:95], v[40:43]
	ds_read_b64_tr_b16 a[216:217], v0 offset:37376
	v_add_f32 v26, v26, v52
	v_mfma_f32_16x16x32_bf16 v[44:47], a[16:19], v[80:83], 0
	ds_read_b64_tr_b16 a[218:219], v0 offset:39424
	ds_read_b64_tr_b16 a[220:221], v1 offset:37376
	ds_read_b64_tr_b16 a[222:223], v1 offset:39424
	v_mfma_f32_16x16x32_bf16 v[44:47], a[20:23], v[84:87], v[44:47]
	ds_read_b64_tr_b16 a[32:33], v17 offset:8192
	v_add_f32 v26, v26, v53
	v_mfma_f32_16x16x32_bf16 v[44:47], a[24:27], v[88:91], v[44:47]
	buffer_load_dwordx4 v4, s[16:19], s49 offen offset:2048 nt lds
	v_add_f32 v26, v26, v54
	v_add_f32 v26, v26, v55
	v_mfma_f32_16x16x32_bf16 v[44:47], a[28:31], v[92:95], v[44:47]
	ds_read_b64_tr_b16 a[34:35], v17 offset:12288
	v_mfma_f32_16x16x32_bf16 v[192:195], a[96:99], v[32:35], v[192:195]
	ds_read_b64_tr_b16 a[36:37], v21 offset:8192
	v_exp_f32 v56, v56
	v_mfma_f32_16x16x32_bf16 v[196:199], a[100:103], v[32:35], v[196:199]
	ds_read_b64_tr_b16 a[38:39], v21 offset:12288
	v_add_f32 v24, v24, v56
	v_mfma_f32_16x16x32_bf16 v[200:203], a[104:107], v[32:35], v[200:203]
	ds_read_b64_tr_b16 a[40:41], v17 offset:8448
	v_exp_f32 v57, v57
	v_mfma_f32_16x16x32_bf16 v[204:207], a[108:111], v[32:35], v[204:207]
	ds_read_b64_tr_b16 a[42:43], v17 offset:12544
	v_cvt_pk_bf16_f32 v36, v56, v57
	v_mfma_f32_16x16x32_bf16 v[208:211], a[112:115], v[32:35], v[208:211]
	ds_read_b64_tr_b16 a[44:45], v21 offset:8448
	v_add_f32 v24, v24, v57
	v_mfma_f32_16x16x32_bf16 v[212:215], a[116:119], v[32:35], v[212:215]
	ds_read_b64_tr_b16 a[46:47], v21 offset:12544
	v_exp_f32 v60, v60
	v_mfma_f32_16x16x32_bf16 v[216:219], a[120:123], v[32:35], v[216:219]
	ds_read_b64_tr_b16 a[48:49], v17 offset:8704
	v_mfma_f32_16x16x32_bf16 v[220:223], a[124:127], v[32:35], v[220:223]
	ds_read_b64_tr_b16 a[50:51], v17 offset:12800
	v_exp_f32 v61, v61
	v_mfma_f32_16x16x32_bf16 v[48:51], a[0:3], v[112:115], 0
	s_add_u32 m0, s48, 49152
	ds_read_b64_tr_b16 a[52:53], v21 offset:8704
	v_cvt_pk_bf16_f32 v38, v60, v61
	v_mfma_f32_16x16x32_bf16 v[48:51], a[4:7], v[116:119], v[48:51]
	s_add_u32 s49, s63, 122880
	ds_read_b64_tr_b16 a[54:55], v21 offset:12800
	v_exp_f32 v58, v58
	v_mfma_f32_16x16x32_bf16 v[48:51], a[8:11], v[120:123], v[48:51]
	s_and_b32 s49, s49, 0x1ffff
	v_exp_f32 v59, v59
	v_mfma_f32_16x16x32_bf16 v[48:51], a[12:15], v[124:127], v[48:51]
	buffer_load_dwordx4 v3, s[12:15], s49 offen nt lds
	v_exp_f32 v62, v62
	v_mfma_f32_16x16x32_bf16 v[52:55], a[16:19], v[112:115], 0
	v_exp_f32 v63, v63
	v_mfma_f32_16x16x32_bf16 v[52:55], a[20:23], v[116:119], v[52:55]
	ds_read_b64_tr_b16 a[56:57], v17 offset:8960
	ds_read_b64_tr_b16 a[58:59], v17 offset:13056
	v_mfma_f32_16x16x32_bf16 v[52:55], a[24:27], v[120:123], v[52:55]
	ds_read_b64_tr_b16 a[60:61], v21 offset:8960
	ds_read_b64_tr_b16 a[62:63], v21 offset:13056
	v_cvt_pk_bf16_f32 v37, v58, v59
	v_cvt_pk_bf16_f32 v39, v62, v63
	v_mfma_f32_16x16x32_bf16 v[52:55], a[28:31], v[124:127], v[52:55]
	s_waitcnt lgkmcnt(14)
	v_add_f32 v24, v24, v58
	v_add_f32 v24, v24, v59
	v_mfma_f32_16x16x32_bf16 v[128:131], a[32:35], v[36:39], v[128:131]
	s_waitcnt lgkmcnt(12)
	v_add_f32 v24, v24, v60
	v_add_f32 v24, v24, v61
	v_add_f32 v24, v24, v62
	v_mfma_f32_16x16x32_bf16 v[132:135], a[36:39], v[36:39], v[132:135]
	s_waitcnt lgkmcnt(10)
	ds_read_b128 a[64:67], v11 offset:0
	v_add_f32 v24, v24, v63
	v_mfma_f32_16x16x32_bf16 v[136:139], a[40:43], v[36:39], v[136:139]
	s_waitcnt lgkmcnt(9)
	ds_read_b128 a[68:71], v11 offset:256
	v_exp_f32 v40, v40
	v_mfma_f32_16x16x32_bf16 v[140:143], a[44:47], v[36:39], v[140:143]
	s_waitcnt lgkmcnt(8)
	v_exp_f32 v41, v41
	v_mfma_f32_16x16x32_bf16 v[144:147], a[48:51], v[36:39], v[144:147]
	s_waitcnt lgkmcnt(6)
	buffer_load_dwordx4 v3, s[12:15], s49 offen offset:2048 nt lds
	v_exp_f32 v44, v44
	v_mfma_f32_16x16x32_bf16 v[148:151], a[52:55], v[36:39], v[148:151]
	s_waitcnt lgkmcnt(4)
	v_exp_f32 v45, v45
	v_mfma_f32_16x16x32_bf16 v[152:155], a[56:59], v[36:39], v[152:155]
	s_waitcnt lgkmcnt(2)
	v_exp_f32 v42, v42
	v_mfma_f32_16x16x32_bf16 v[156:159], a[60:63], v[36:39], v[156:159]
	v_exp_f32 v43, v43
	v_cvt_pk_bf16_f32 v28, v40, v41
	v_mfma_f32_16x16x32_bf16 v[56:59], a[0:3], v[96:99], 0
	v_exp_f32 v46, v46
	v_mfma_f32_16x16x32_bf16 v[56:59], a[4:7], v[100:103], v[56:59]
	v_cvt_pk_bf16_f32 v29, v42, v43
	v_exp_f32 v47, v47
	v_mfma_f32_16x16x32_bf16 v[56:59], a[8:11], v[104:107], v[56:59]
	v_cvt_pk_bf16_f32 v30, v44, v45
	v_cvt_pk_bf16_f32 v31, v46, v47
	v_mfma_f32_16x16x32_bf16 v[56:59], a[12:15], v[108:111], v[56:59]
	ds_read_b128 a[72:75], v15 offset:0
	v_add_f32 v25, v25, v40
	v_add_f32 v25, v25, v41
	v_mfma_f32_16x16x32_bf16 v[60:63], a[16:19], v[96:99], 0
	s_add_u32 m0, s48, 57344
	ds_read_b128 a[76:79], v15 offset:256
	v_add_f32 v25, v25, v42
	v_mfma_f32_16x16x32_bf16 v[60:63], a[20:23], v[100:103], v[60:63]
	ds_read_b128 a[80:83], v11 offset:4096
	v_add_f32 v25, v25, v43
	v_add_f32 v25, v25, v44
	v_mfma_f32_16x16x32_bf16 v[60:63], a[24:27], v[104:107], v[60:63]
	ds_read_b128 a[84:87], v11 offset:4352
	v_add_f32 v25, v25, v45
	v_mfma_f32_16x16x32_bf16 v[60:63], a[28:31], v[108:111], v[60:63]
	buffer_load_dwordx4 v4, s[16:19], s49 offen nt lds
	v_add_f32 v25, v25, v46
	v_mfma_f32_16x16x32_bf16 v[160:163], a[32:35], v[28:31], v[160:163]
	ds_read_b128 a[88:91], v15 offset:4096
	v_add_f32 v25, v25, v47
	v_mfma_f32_16x16x32_bf16 v[164:167], a[36:39], v[28:31], v[164:167]
	ds_read_b128 a[92:95], v15 offset:4352
	v_mfma_f32_16x16x32_bf16 v[168:171], a[40:43], v[28:31], v[168:171]
	ds_read_b64_tr_b16 a[96:97], v19 offset:8192
	v_exp_f32 v48, v48
	v_mfma_f32_16x16x32_bf16 v[172:175], a[44:47], v[28:31], v[172:175]
	v_exp_f32 v49, v49
	v_mfma_f32_16x16x32_bf16 v[176:179], a[48:51], v[28:31], v[176:179]
	v_cvt_pk_bf16_f32 v32, v48, v49
	v_exp_f32 v52, v52
	v_mfma_f32_16x16x32_bf16 v[180:183], a[52:55], v[28:31], v[180:183]
	v_exp_f32 v53, v53
	v_mfma_f32_16x16x32_bf16 v[184:187], a[56:59], v[28:31], v[184:187]
	v_exp_f32 v50, v50
	v_cvt_pk_bf16_f32 v34, v52, v53
	v_mfma_f32_16x16x32_bf16 v[188:191], a[60:63], v[28:31], v[188:191]
	s_waitcnt lgkmcnt(8)
	v_exp_f32 v51, v51
	v_mfma_f32_16x16x32_bf16 v[40:43], a[64:67], v[64:67], 0
	s_waitcnt lgkmcnt(7)
	v_exp_f32 v54, v54
	v_mfma_f32_16x16x32_bf16 v[40:43], a[68:71], v[68:71], v[40:43]
	s_waitcnt lgkmcnt(6)
	v_cvt_pk_bf16_f32 v33, v50, v51
	v_exp_f32 v55, v55
	v_mfma_f32_16x16x32_bf16 v[40:43], a[72:75], v[72:75], v[40:43]
	s_waitcnt lgkmcnt(5)
	buffer_load_dwordx4 v4, s[16:19], s49 offen offset:2048 nt lds
	v_cvt_pk_bf16_f32 v35, v54, v55
	v_mfma_f32_16x16x32_bf16 v[40:43], a[76:79], v[76:79], v[40:43]
	s_waitcnt lgkmcnt(4)
	v_add_f32 v27, v27, v48
	v_add_f32 v27, v27, v49
	v_add_f32 v27, v27, v50
	v_mfma_f32_16x16x32_bf16 v[44:47], a[80:83], v[64:67], 0
	s_waitcnt lgkmcnt(3)
	v_add_f32 v27, v27, v51
	v_add_f32 v27, v27, v52
	v_mfma_f32_16x16x32_bf16 v[44:47], a[84:87], v[68:71], v[44:47]
	s_waitcnt lgkmcnt(2)
	v_add_f32 v27, v27, v53
	v_add_f32 v27, v27, v54
	v_add_f32 v27, v27, v55
	v_mfma_f32_16x16x32_bf16 v[44:47], a[88:91], v[72:75], v[44:47]
	s_waitcnt lgkmcnt(1)
	v_exp_f32 v56, v56
	v_mfma_f32_16x16x32_bf16 v[44:47], a[92:95], v[76:79], v[44:47]
	ds_read_b64_tr_b16 a[98:99], v19 offset:12288
	v_exp_f32 v57, v57
	v_mfma_f32_16x16x32_bf16 v[224:227], a[32:35], v[32:35], v[224:227]
	v_exp_f32 v60, v60
	v_mfma_f32_16x16x32_bf16 v[228:231], a[36:39], v[32:35], v[228:231]
	v_cvt_pk_bf16_f32 v36, v56, v57
	v_exp_f32 v61, v61
	v_mfma_f32_16x16x32_bf16 v[232:235], a[40:43], v[32:35], v[232:235]
	s_add_u32 m0, s62, 98304
	v_exp_f32 v58, v58
	v_mfma_f32_16x16x32_bf16 v[236:239], a[44:47], v[32:35], v[236:239]
	s_add_u32 s50, s6, 0
	v_exp_f32 v59, v59
	v_mfma_f32_16x16x32_bf16 v[240:243], a[48:51], v[32:35], v[240:243]
	v_cvt_pk_bf16_f32 v37, v58, v59
	v_exp_f32 v62, v62
	v_mfma_f32_16x16x32_bf16 v[244:247], a[52:55], v[32:35], v[244:247]
	buffer_load_dwordx4 v5, s[24:27], s50 offen lds
	v_cvt_pk_bf16_f32 v38, v60, v61
	v_mfma_f32_16x16x32_bf16 v[248:251], a[56:59], v[32:35], v[248:251]
	s_add_u32 m0, s62, 99328
	ds_read_b64_tr_b16 a[100:101], v23 offset:8192
	v_exp_f32 v63, v63
	v_mfma_f32_16x16x32_bf16 v[252:255], a[60:63], v[32:35], v[252:255]
	s_add_u32 s50, s6, 9216
	ds_read_b64_tr_b16 a[102:103], v23 offset:12288
	v_cvt_pk_bf16_f32 v39, v62, v63
	v_mfma_f32_16x16x32_bf16 v[48:51], a[64:67], v[80:83], 0
	buffer_load_dwordx4 v5, s[24:27], s50 offen lds
	v_add_f32 v26, v26, v56
	v_add_f32 v26, v26, v57
	v_mfma_f32_16x16x32_bf16 v[48:51], a[68:71], v[84:87], v[48:51]
	s_add_u32 m0, s62, 100352
	ds_read_b64_tr_b16 a[104:105], v19 offset:8448
	v_add_f32 v26, v26, v58
	v_mfma_f32_16x16x32_bf16 v[48:51], a[72:75], v[88:91], v[48:51]
	s_add_u32 s50, s6, 18432
	ds_read_b64_tr_b16 a[106:107], v19 offset:12544
	v_add_f32 v26, v26, v59
	v_add_f32 v26, v26, v60
	v_mfma_f32_16x16x32_bf16 v[48:51], a[76:79], v[92:95], v[48:51]
	buffer_load_dwordx4 v5, s[24:27], s50 offen lds
	v_add_f32 v26, v26, v61
	v_mfma_f32_16x16x32_bf16 v[52:55], a[80:83], v[80:83], 0
	ds_read_b64_tr_b16 a[108:109], v23 offset:8448
	v_add_f32 v26, v26, v62
	v_mfma_f32_16x16x32_bf16 v[52:55], a[84:87], v[84:87], v[52:55]
	ds_read_b64_tr_b16 a[110:111], v23 offset:12544
	v_add_f32 v26, v26, v63
	v_mfma_f32_16x16x32_bf16 v[52:55], a[88:91], v[88:91], v[52:55]
	s_add_u32 m0, s62, 101376
	ds_read_b64_tr_b16 a[112:113], v19 offset:8704
	v_mfma_f32_16x16x32_bf16 v[52:55], a[92:95], v[92:95], v[52:55]
	s_add_u32 s50, s6, 27648
	ds_read_b64_tr_b16 a[114:115], v19 offset:12800
	v_exp_f32 v40, v40
	v_mfma_f32_16x16x32_bf16 v[192:195], a[32:35], v[36:39], v[192:195]
	ds_read_b64_tr_b16 a[116:117], v23 offset:8704
	ds_read_b64_tr_b16 a[118:119], v23 offset:12800
	ds_read_b64_tr_b16 a[120:121], v19 offset:8960
	ds_read_b64_tr_b16 a[122:123], v19 offset:13056
	ds_read_b64_tr_b16 a[124:125], v23 offset:8960
	ds_read_b64_tr_b16 a[126:127], v23 offset:13056
	v_mfma_f32_16x16x32_bf16 v[196:199], a[36:39], v[36:39], v[196:199]
	buffer_load_dwordx4 v5, s[24:27], s50 offen lds
	v_exp_f32 v41, v41
	v_mfma_f32_16x16x32_bf16 v[200:203], a[40:43], v[36:39], v[200:203]
	s_add_u32 m0, s62, 102400
	s_add_u32 s50, s6, 36864
	buffer_load_dwordx4 v5, s[24:27], s50 offen lds
	v_cvt_pk_bf16_f32 v28, v40, v41
	v_mfma_f32_16x16x32_bf16 v[204:207], a[44:47], v[36:39], v[204:207]
	s_add_u32 m0, s62, 103424
	v_add_f32 v24, v24, v40
	v_exp_f32 v44, v44
	v_mfma_f32_16x16x32_bf16 v[208:211], a[48:51], v[36:39], v[208:211]
	s_waitcnt vmcnt(21) lgkmcnt(0)
	s_barrier
	s_add_u32 s50, s6, 46080
	buffer_load_dwordx4 v5, s[24:27], s50 offen lds
	v_add_f32 v24, v24, v41
	v_mfma_f32_16x16x32_bf16 v[212:215], a[52:55], v[36:39], v[212:215]
	s_add_u32 m0, s62, 104448
	v_exp_f32 v45, v45
	v_mfma_f32_16x16x32_bf16 v[216:219], a[56:59], v[36:39], v[216:219]
	s_add_u32 s50, s6, 55296
	v_exp_f32 v42, v42
	v_cvt_pk_bf16_f32 v30, v44, v45
	v_mfma_f32_16x16x32_bf16 v[220:223], a[60:63], v[36:39], v[220:223]
	buffer_load_dwordx4 v5, s[24:27], s50 offen lds
	v_add_f32 v24, v24, v42
	v_mfma_f32_16x16x32_bf16 v[56:59], a[64:67], v[96:99], 0
	s_add_u32 m0, s62, 105472
	ds_read_b128 a[0:3], v8 offset:0
	v_exp_f32 v43, v43
	v_mfma_f32_16x16x32_bf16 v[56:59], a[68:71], v[100:103], v[56:59]
	s_add_u32 s50, s6, 64512
	v_exp_f32 v46, v46
	v_mfma_f32_16x16x32_bf16 v[56:59], a[72:75], v[104:107], v[56:59]
	buffer_load_dwordx4 v5, s[24:27], s50 offen lds
	v_exp_f32 v47, v47
	v_mfma_f32_16x16x32_bf16 v[56:59], a[76:79], v[108:111], v[56:59]
	v_cvt_pk_bf16_f32 v29, v42, v43
	v_cvt_pk_bf16_f32 v31, v46, v47
	v_mfma_f32_16x16x32_bf16 v[60:63], a[80:83], v[96:99], 0
	ds_read_b128 a[4:7], v8 offset:256
	v_add_f32 v24, v24, v43
	v_add_f32 v24, v24, v44
	v_mfma_f32_16x16x32_bf16 v[60:63], a[84:87], v[100:103], v[60:63]
	ds_read_b128 a[8:11], v12 offset:0
	v_add_f32 v24, v24, v45
	v_mfma_f32_16x16x32_bf16 v[60:63], a[88:91], v[104:107], v[60:63]
	ds_read_b128 a[12:15], v12 offset:256
	v_add_f32 v24, v24, v46
	v_mfma_f32_16x16x32_bf16 v[60:63], a[92:95], v[108:111], v[60:63]
	ds_read_b128 a[16:19], v8 offset:4096
	v_add_f32 v24, v24, v47
	v_mfma_f32_16x16x32_bf16 v[128:131], a[96:99], v[28:31], v[128:131]
	ds_read_b128 a[20:23], v8 offset:4352
	v_mfma_f32_16x16x32_bf16 v[132:135], a[100:103], v[28:31], v[132:135]
	ds_read_b128 a[24:27], v12 offset:4096
	v_exp_f32 v48, v48
	v_mfma_f32_16x16x32_bf16 v[136:139], a[104:107], v[28:31], v[136:139]
	ds_read_b128 a[28:31], v12 offset:4352
	v_add_f32 v25, v25, v48
	v_mfma_f32_16x16x32_bf16 v[140:143], a[108:111], v[28:31], v[140:143]
	s_waitcnt vmcnt(20)
	ds_read_b64_tr_b16 a[224:225], v6 offset:0
	v_exp_f32 v49, v49
	v_mfma_f32_16x16x32_bf16 v[144:147], a[112:115], v[28:31], v[144:147]
	v_exp_f32 v52, v52
	v_mfma_f32_16x16x32_bf16 v[148:151], a[116:119], v[28:31], v[148:151]
	v_cvt_pk_bf16_f32 v32, v48, v49
	v_exp_f32 v53, v53
	v_mfma_f32_16x16x32_bf16 v[152:155], a[120:123], v[28:31], v[152:155]
	v_exp_f32 v50, v50
	v_mfma_f32_16x16x32_bf16 v[156:159], a[124:127], v[28:31], v[156:159]
	s_waitcnt lgkmcnt(8)
	v_exp_f32 v51, v51
	v_mfma_f32_16x16x32_bf16 v[40:43], a[0:3], v[64:67], 0
	s_waitcnt lgkmcnt(7)
	v_cvt_pk_bf16_f32 v33, v50, v51
	v_exp_f32 v54, v54
	v_mfma_f32_16x16x32_bf16 v[40:43], a[4:7], v[68:71], v[40:43]
	s_waitcnt lgkmcnt(6)
	v_exp_f32 v55, v55
	v_mfma_f32_16x16x32_bf16 v[40:43], a[8:11], v[72:75], v[40:43]
	s_waitcnt lgkmcnt(5)
	v_add_f32 v25, v25, v49
	v_cvt_pk_bf16_f32 v34, v52, v53
	v_cvt_pk_bf16_f32 v35, v54, v55
	v_mfma_f32_16x16x32_bf16 v[40:43], a[12:15], v[76:79], v[40:43]
	s_waitcnt lgkmcnt(4)
	v_add_f32 v25, v25, v50
	v_add_f32 v25, v25, v51
	v_mfma_f32_16x16x32_bf16 v[44:47], a[16:19], v[64:67], 0
	s_waitcnt lgkmcnt(3)
	v_add_f32 v25, v25, v52
	v_add_f32 v25, v25, v53
	v_add_f32 v25, v25, v54
	v_mfma_f32_16x16x32_bf16 v[44:47], a[20:23], v[68:71], v[44:47]
	s_waitcnt lgkmcnt(2)
	ds_read_b64_tr_b16 a[226:227], v6 offset:2048
	v_add_f32 v25, v25, v55
	v_mfma_f32_16x16x32_bf16 v[44:47], a[24:27], v[72:75], v[44:47]
	s_waitcnt lgkmcnt(2)
	ds_read_b64_tr_b16 a[228:229], v7 offset:0
	v_exp_f32 v56, v56
	v_mfma_f32_16x16x32_bf16 v[44:47], a[28:31], v[76:79], v[44:47]
	v_exp_f32 v57, v57
	v_mfma_f32_16x16x32_bf16 v[160:163], a[96:99], v[32:35], v[160:163]
	ds_read_b64_tr_b16 a[230:231], v7 offset:2048
	v_exp_f32 v60, v60
	v_mfma_f32_16x16x32_bf16 v[164:167], a[100:103], v[32:35], v[164:167]
	v_exp_f32 v61, v61
	v_mfma_f32_16x16x32_bf16 v[168:171], a[104:107], v[32:35], v[168:171]
	ds_read_b64_tr_b16 a[232:233], v6 offset:512
	v_cvt_pk_bf16_f32 v36, v56, v57
	v_mfma_f32_16x16x32_bf16 v[172:175], a[108:111], v[32:35], v[172:175]
	ds_read_b64_tr_b16 a[234:235], v6 offset:2560
	v_exp_f32 v58, v58
	v_mfma_f32_16x16x32_bf16 v[176:179], a[112:115], v[32:35], v[176:179]
	ds_read_b64_tr_b16 a[236:237], v7 offset:512
	v_cvt_pk_bf16_f32 v38, v60, v61
	v_mfma_f32_16x16x32_bf16 v[180:183], a[116:119], v[32:35], v[180:183]
	ds_read_b64_tr_b16 a[238:239], v7 offset:2560
	v_exp_f32 v59, v59
	v_mfma_f32_16x16x32_bf16 v[184:187], a[120:123], v[32:35], v[184:187]
	s_waitcnt vmcnt(16)
	ds_read_b64_tr_b16 a[240:241], v6 offset:4096
	v_cvt_pk_bf16_f32 v37, v58, v59
	v_mfma_f32_16x16x32_bf16 v[188:191], a[124:127], v[32:35], v[188:191]
	ds_read_b64_tr_b16 a[242:243], v6 offset:6144
	v_exp_f32 v62, v62
	v_mfma_f32_16x16x32_bf16 v[48:51], a[0:3], v[80:83], 0
	ds_read_b64_tr_b16 a[244:245], v7 offset:4096
	v_add_f32 v26, v26, v56
	v_mfma_f32_16x16x32_bf16 v[48:51], a[4:7], v[84:87], v[48:51]
	ds_read_b64_tr_b16 a[246:247], v7 offset:6144
	v_exp_f32 v63, v63
	v_mfma_f32_16x16x32_bf16 v[48:51], a[8:11], v[88:91], v[48:51]
	ds_read_b64_tr_b16 a[248:249], v6 offset:4608
	v_cvt_pk_bf16_f32 v39, v62, v63
	v_mfma_f32_16x16x32_bf16 v[48:51], a[12:15], v[92:95], v[48:51]
	ds_read_b64_tr_b16 a[250:251], v6 offset:6656
	v_add_f32 v26, v26, v57
	v_mfma_f32_16x16x32_bf16 v[52:55], a[16:19], v[80:83], 0
	ds_read_b64_tr_b16 a[252:253], v7 offset:4608
	ds_read_b64_tr_b16 a[254:255], v7 offset:6656
	v_add_f32 v26, v26, v58
	v_mfma_f32_16x16x32_bf16 v[52:55], a[20:23], v[84:87], v[52:55]
	ds_read_b64_tr_b16 a[32:33], v16 offset:8192
	v_add_f32 v26, v26, v59
	v_mfma_f32_16x16x32_bf16 v[52:55], a[24:27], v[88:91], v[52:55]
	ds_read_b64_tr_b16 a[34:35], v16 offset:12288
	v_add_f32 v26, v26, v60
	v_add_f32 v26, v26, v61
	v_mfma_f32_16x16x32_bf16 v[52:55], a[28:31], v[92:95], v[52:55]
	ds_read_b64_tr_b16 a[36:37], v20 offset:8192
	v_add_f32 v26, v26, v62
	v_mfma_f32_16x16x32_bf16 v[192:195], a[96:99], v[36:39], v[192:195]
	ds_read_b64_tr_b16 a[38:39], v20 offset:12288
	v_add_f32 v26, v26, v63
	v_mfma_f32_16x16x32_bf16 v[196:199], a[100:103], v[36:39], v[196:199]
	s_add_u32 m0, s62, 131072
	ds_read_b64_tr_b16 a[40:41], v16 offset:8448
	v_mfma_f32_16x16x32_bf16 v[200:203], a[104:107], v[36:39], v[200:203]
	s_add_u32 s50, s6, 73728
	ds_read_b64_tr_b16 a[42:43], v16 offset:12544
	v_exp_f32 v40, v40
	v_mfma_f32_16x16x32_bf16 v[204:207], a[108:111], v[36:39], v[204:207]
	ds_read_b64_tr_b16 a[44:45], v20 offset:8448
	v_add_f32 v24, v24, v40
	v_mfma_f32_16x16x32_bf16 v[208:211], a[112:115], v[36:39], v[208:211]
	s_waitcnt lgkmcnt(15)
	buffer_load_dwordx4 v5, s[24:27], s50 offen lds
	v_mfma_f32_16x16x32_bf16 v[212:215], a[116:119], v[36:39], v[212:215]
	s_add_u32 m0, s62, 132096
	ds_read_b64_tr_b16 a[46:47], v20 offset:12544
	v_exp_f32 v41, v41
	v_mfma_f32_16x16x32_bf16 v[216:219], a[120:123], v[36:39], v[216:219]
	s_add_u32 s50, s6, 82944
	ds_read_b64_tr_b16 a[48:49], v16 offset:8704
	v_cvt_pk_bf16_f32 v28, v40, v41
	v_mfma_f32_16x16x32_bf16 v[220:223], a[124:127], v[36:39], v[220:223]
	buffer_load_dwordx4 v5, s[24:27], s50 offen lds
	v_exp_f32 v44, v44
	v_mfma_f32_16x16x32_bf16 v[56:59], a[0:3], v[112:115], 0
	ds_read_b64_tr_b16 a[50:51], v16 offset:12800
	v_add_f32 v24, v24, v41
	v_mfma_f32_16x16x32_bf16 v[56:59], a[4:7], v[116:119], v[56:59]
	ds_read_b64_tr_b16 a[52:53], v20 offset:8704
	v_exp_f32 v45, v45
	v_mfma_f32_16x16x32_bf16 v[56:59], a[8:11], v[120:123], v[56:59]
	s_add_u32 m0, s62, 133120
	ds_read_b64_tr_b16 a[54:55], v20 offset:12800
	v_cvt_pk_bf16_f32 v30, v44, v45
	v_mfma_f32_16x16x32_bf16 v[56:59], a[12:15], v[124:127], v[56:59]
	s_add_u32 s50, s6, 92160
	ds_read_b64_tr_b16 a[56:57], v16 offset:8960
	v_exp_f32 v42, v42
	v_mfma_f32_16x16x32_bf16 v[60:63], a[16:19], v[112:115], 0
	v_exp_f32 v43, v43
	v_exp_f32 v46, v46
	v_exp_f32 v47, v47
	v_mfma_f32_16x16x32_bf16 v[60:63], a[20:23], v[116:119], v[60:63]
	ds_read_b64_tr_b16 a[58:59], v16 offset:13056
	buffer_load_dwordx4 v5, s[24:27], s50 offen lds
	v_mfma_f32_16x16x32_bf16 v[60:63], a[24:27], v[120:123], v[60:63]
	s_add_u32 m0, s62, 134144
	ds_read_b64_tr_b16 a[60:61], v20 offset:8960
	ds_read_b64_tr_b16 a[62:63], v20 offset:13056
	v_cvt_pk_bf16_f32 v29, v42, v43
	v_cvt_pk_bf16_f32 v31, v46, v47
	v_mfma_f32_16x16x32_bf16 v[60:63], a[28:31], v[124:127], v[60:63]
	s_waitcnt lgkmcnt(14)
	s_add_u32 s50, s6, 101376
	buffer_load_dwordx4 v5, s[24:27], s50 offen lds
	v_add_f32 v24, v24, v42
	v_mfma_f32_16x16x32_bf16 v[128:131], a[32:35], v[28:31], v[128:131]
	s_waitcnt lgkmcnt(12)
	s_add_u32 m0, s62, 135168
	s_add_u32 s50, s6, 110592
	buffer_load_dwordx4 v5, s[24:27], s50 offen lds
	v_add_f32 v24, v24, v43
	v_add_f32 v24, v24, v44
	v_mfma_f32_16x16x32_bf16 v[132:135], a[36:39], v[28:31], v[132:135]
	s_waitcnt lgkmcnt(10)
	v_add_f32 v24, v24, v45
	v_add_f32 v24, v24, v46
	v_mfma_f32_16x16x32_bf16 v[136:139], a[40:43], v[28:31], v[136:139]
	s_waitcnt lgkmcnt(8)
	v_add_f32 v24, v24, v47
	v_exp_f32 v48, v48
	v_mfma_f32_16x16x32_bf16 v[140:143], a[44:47], v[28:31], v[140:143]
	s_waitcnt lgkmcnt(6)
	s_add_u32 m0, s62, 136192
	s_add_u32 s50, s6, 119808
	buffer_load_dwordx4 v5, s[24:27], s50 offen lds
	v_add_f32 v25, v25, v48
	v_mfma_f32_16x16x32_bf16 v[144:147], a[48:51], v[28:31], v[144:147]
	s_waitcnt lgkmcnt(4)
	ds_read_b128 a[64:67], v10 offset:0
	v_exp_f32 v49, v49
	v_mfma_f32_16x16x32_bf16 v[148:151], a[52:55], v[28:31], v[148:151]
	s_waitcnt lgkmcnt(3)
	v_exp_f32 v52, v52
	v_mfma_f32_16x16x32_bf16 v[152:155], a[56:59], v[28:31], v[152:155]
	s_waitcnt lgkmcnt(1)
	s_add_u32 m0, s62, 137216
	s_add_u32 s50, s6, 129024
	buffer_load_dwordx4 v5, s[24:27], s50 offen lds
	v_cvt_pk_bf16_f32 v32, v48, v49
	v_mfma_f32_16x16x32_bf16 v[156:159], a[60:63], v[28:31], v[156:159]
	s_add_u32 m0, s62, 138240
	ds_read_b128 a[68:71], v10 offset:256
	v_exp_f32 v53, v53
	v_mfma_f32_16x16x32_bf16 v[40:43], a[0:3], v[96:99], 0
	s_add_u32 s50, s6, 138240
	v_exp_f32 v50, v50
	v_mfma_f32_16x16x32_bf16 v[40:43], a[4:7], v[100:103], v[40:43]
	buffer_load_dwordx4 v5, s[24:27], s50 offen lds
	v_exp_f32 v51, v51
	v_mfma_f32_16x16x32_bf16 v[40:43], a[8:11], v[104:107], v[40:43]
	s_add_u32 m0, s62, 65536
	v_exp_f32 v54, v54
	v_mfma_f32_16x16x32_bf16 v[40:43], a[12:15], v[108:111], v[40:43]
	s_add_u32 s50, s7, 0
	v_cvt_pk_bf16_f32 v33, v50, v51
	v_exp_f32 v55, v55
	v_mfma_f32_16x16x32_bf16 v[44:47], a[16:19], v[96:99], 0
	v_cvt_pk_bf16_f32 v34, v52, v53
	v_cvt_pk_bf16_f32 v35, v54, v55
	v_mfma_f32_16x16x32_bf16 v[44:47], a[20:23], v[100:103], v[44:47]
	buffer_load_dwordx4 v5, s[24:27], s50 offen lds
	v_add_f32 v25, v25, v49
	v_add_f32 v25, v25, v50
	v_mfma_f32_16x16x32_bf16 v[44:47], a[24:27], v[104:107], v[44:47]
	s_add_u32 m0, s62, 66560
	ds_read_b128 a[72:75], v14 offset:0
	v_add_f32 v25, v25, v51
	v_mfma_f32_16x16x32_bf16 v[44:47], a[28:31], v[108:111], v[44:47]
	s_add_u32 s50, s7, 9216
	ds_read_b128 a[76:79], v14 offset:256
	v_add_f32 v25, v25, v52
	v_mfma_f32_16x16x32_bf16 v[160:163], a[32:35], v[32:35], v[160:163]
	buffer_load_dwordx4 v5, s[24:27], s50 offen lds
	v_add_f32 v25, v25, v53
	v_add_f32 v25, v25, v54
	v_mfma_f32_16x16x32_bf16 v[164:167], a[36:39], v[32:35], v[164:167]
	s_add_u32 m0, s62, 67584
	ds_read_b128 a[80:83], v10 offset:4096
	v_add_f32 v25, v25, v55
	v_mfma_f32_16x16x32_bf16 v[168:171], a[40:43], v[32:35], v[168:171]
	s_add_u32 s50, s7, 18432
	ds_read_b128 a[84:87], v10 offset:4352
	v_exp_f32 v56, v56
	v_mfma_f32_16x16x32_bf16 v[172:175], a[44:47], v[32:35], v[172:175]
	ds_read_b128 a[88:91], v14 offset:4096
	v_add_f32 v27, v27, v56
	v_mfma_f32_16x16x32_bf16 v[176:179], a[48:51], v[32:35], v[176:179]
	buffer_load_dwordx4 v5, s[24:27], s50 offen lds
	v_exp_f32 v57, v57
	v_mfma_f32_16x16x32_bf16 v[180:183], a[52:55], v[32:35], v[180:183]
	s_add_u32 m0, s62, 68608
	ds_read_b128 a[92:95], v14 offset:4352
	v_cvt_pk_bf16_f32 v36, v56, v57
	v_mfma_f32_16x16x32_bf16 v[184:187], a[56:59], v[32:35], v[184:187]
	s_add_u32 s50, s7, 27648
	buffer_load_dwordx4 v5, s[24:27], s50 offen lds
	v_exp_f32 v60, v60
	v_mfma_f32_16x16x32_bf16 v[188:191], a[60:63], v[32:35], v[188:191]
	s_waitcnt lgkmcnt(7)
	v_exp_f32 v61, v61
	v_mfma_f32_16x16x32_bf16 v[48:51], a[64:67], v[64:67], 0
	s_waitcnt lgkmcnt(6)
	s_add_u32 m0, s62, 69632
	s_add_u32 s50, s7, 36864
	buffer_load_dwordx4 v5, s[24:27], s50 offen lds
	v_exp_f32 v58, v58
	v_mfma_f32_16x16x32_bf16 v[48:51], a[68:71], v[68:71], v[48:51]
	s_waitcnt lgkmcnt(5)
	v_exp_f32 v59, v59
	v_mfma_f32_16x16x32_bf16 v[48:51], a[72:75], v[72:75], v[48:51]
	s_waitcnt lgkmcnt(4)
	v_exp_f32 v62, v62
	v_mfma_f32_16x16x32_bf16 v[48:51], a[76:79], v[76:79], v[48:51]
	s_waitcnt lgkmcnt(3)
	v_cvt_pk_bf16_f32 v37, v58, v59
	v_exp_f32 v63, v63
	v_mfma_f32_16x16x32_bf16 v[52:55], a[80:83], v[64:67], 0
	s_waitcnt lgkmcnt(2)
	v_cvt_pk_bf16_f32 v38, v60, v61
	v_cvt_pk_bf16_f32 v39, v62, v63
	v_mfma_f32_16x16x32_bf16 v[52:55], a[84:87], v[68:71], v[52:55]
	s_waitcnt lgkmcnt(1)
	s_add_u32 m0, s62, 70656
	s_add_u32 s50, s7, 46080
	buffer_load_dwordx4 v5, s[24:27], s50 offen lds
	v_add_f32 v27, v27, v57
	v_add_f32 v27, v27, v58
	v_mfma_f32_16x16x32_bf16 v[52:55], a[88:91], v[72:75], v[52:55]
	s_waitcnt lgkmcnt(0)
	s_add_u32 m0, s62, 71680
	s_add_u32 s50, s7, 55296
	buffer_load_dwordx4 v5, s[24:27], s50 offen lds
	v_add_f32 v27, v27, v59
	v_mfma_f32_16x16x32_bf16 v[52:55], a[92:95], v[76:79], v[52:55]
	s_add_u32 m0, s62, 72704
	v_add_f32 v27, v27, v60
	v_add_f32 v27, v27, v61
	v_add_f32 v27, v27, v62
	v_mfma_f32_16x16x32_bf16 v[224:227], a[32:35], v[36:39], v[224:227]
	s_add_u32 s50, s7, 64512
	ds_read_b64_tr_b16 a[96:97], v18 offset:8192
	v_add_f32 v27, v27, v63
	v_mfma_f32_16x16x32_bf16 v[228:231], a[36:39], v[36:39], v[228:231]
	buffer_load_dwordx4 v5, s[24:27], s50 offen lds
	v_exp_f32 v40, v40
	v_mfma_f32_16x16x32_bf16 v[232:235], a[40:43], v[36:39], v[232:235]
	v_exp_f32 v41, v41
	v_mfma_f32_16x16x32_bf16 v[236:239], a[44:47], v[36:39], v[236:239]
	v_exp_f32 v44, v44
	v_mfma_f32_16x16x32_bf16 v[240:243], a[48:51], v[36:39], v[240:243]
	v_cvt_pk_bf16_f32 v28, v40, v41
	v_exp_f32 v45, v45
	v_mfma_f32_16x16x32_bf16 v[244:247], a[52:55], v[36:39], v[244:247]
	v_exp_f32 v42, v42
	v_mfma_f32_16x16x32_bf16 v[248:251], a[56:59], v[36:39], v[248:251]
	v_exp_f32 v43, v43
	v_cvt_pk_bf16_f32 v30, v44, v45
	v_mfma_f32_16x16x32_bf16 v[252:255], a[60:63], v[36:39], v[252:255]
	v_exp_f32 v46, v46
	v_mfma_f32_16x16x32_bf16 v[56:59], a[64:67], v[80:83], 0
	v_cvt_pk_bf16_f32 v29, v42, v43
	v_exp_f32 v47, v47
	v_mfma_f32_16x16x32_bf16 v[56:59], a[68:71], v[84:87], v[56:59]
	ds_read_b64_tr_b16 a[98:99], v18 offset:12288
	v_cvt_pk_bf16_f32 v31, v46, v47
	v_mfma_f32_16x16x32_bf16 v[56:59], a[72:75], v[88:91], v[56:59]
	ds_read_b64_tr_b16 a[100:101], v22 offset:8192
	v_add_f32 v26, v26, v40
	v_add_f32 v26, v26, v41
	v_mfma_f32_16x16x32_bf16 v[56:59], a[76:79], v[92:95], v[56:59]
	ds_read_b64_tr_b16 a[102:103], v22 offset:12288
	v_add_f32 v26, v26, v42
	v_mfma_f32_16x16x32_bf16 v[60:63], a[80:83], v[80:83], 0
	ds_read_b64_tr_b16 a[104:105], v18 offset:8448
	v_add_f32 v26, v26, v43
	v_mfma_f32_16x16x32_bf16 v[60:63], a[84:87], v[84:87], v[60:63]
	ds_read_b64_tr_b16 a[106:107], v18 offset:12544
	v_add_f32 v26, v26, v44
	v_add_f32 v26, v26, v45
	v_mfma_f32_16x16x32_bf16 v[60:63], a[88:91], v[88:91], v[60:63]
	ds_read_b64_tr_b16 a[108:109], v22 offset:8448
	v_add_f32 v26, v26, v46
	v_mfma_f32_16x16x32_bf16 v[60:63], a[92:95], v[92:95], v[60:63]
	ds_read_b64_tr_b16 a[110:111], v22 offset:12544
	v_add_f32 v26, v26, v47
	v_mfma_f32_16x16x32_bf16 v[192:195], a[32:35], v[28:31], v[192:195]
	ds_read_b64_tr_b16 a[112:113], v18 offset:8704
	ds_read_b64_tr_b16 a[114:115], v18 offset:12800
	ds_read_b64_tr_b16 a[116:117], v22 offset:8704
	ds_read_b64_tr_b16 a[118:119], v22 offset:12800
	ds_read_b64_tr_b16 a[120:121], v18 offset:8960
	ds_read_b64_tr_b16 a[122:123], v18 offset:13056
	ds_read_b64_tr_b16 a[124:125], v22 offset:8960
	ds_read_b64_tr_b16 a[126:127], v22 offset:13056
	v_mfma_f32_16x16x32_bf16 v[196:199], a[36:39], v[28:31], v[196:199]
	v_exp_f32 v48, v48
	v_mfma_f32_16x16x32_bf16 v[200:203], a[40:43], v[28:31], v[200:203]
	s_add_u32 m0, s62, 0
	v_exp_f32 v49, v49
	v_mfma_f32_16x16x32_bf16 v[204:207], a[44:47], v[28:31], v[204:207]
	s_add_u32 s50, s7, 73728
	v_cvt_pk_bf16_f32 v32, v48, v49
	v_exp_f32 v52, v52
	v_mfma_f32_16x16x32_bf16 v[208:211], a[48:51], v[28:31], v[208:211]
	s_waitcnt vmcnt(24) lgkmcnt(0)
	s_barrier
	v_exp_f32 v53, v53
	v_mfma_f32_16x16x32_bf16 v[212:215], a[52:55], v[28:31], v[212:215]
	buffer_load_dwordx4 v5, s[24:27], s50 offen lds
	v_cvt_pk_bf16_f32 v34, v52, v53
	v_mfma_f32_16x16x32_bf16 v[216:219], a[56:59], v[28:31], v[216:219]
	s_add_u32 m0, s62, 1024
	ds_read_b128 a[0:3], v8 offset:32768
	v_exp_f32 v50, v50
	v_mfma_f32_16x16x32_bf16 v[220:223], a[60:63], v[28:31], v[220:223]
	s_add_u32 s50, s7, 82944
	v_exp_f32 v51, v51
	v_mfma_f32_16x16x32_bf16 v[40:43], a[64:67], v[96:99], 0
	buffer_load_dwordx4 v5, s[24:27], s50 offen lds
	v_exp_f32 v54, v54
	v_mfma_f32_16x16x32_bf16 v[40:43], a[68:71], v[100:103], v[40:43]
	s_add_u32 m0, s62, 2048
	v_exp_f32 v55, v55
	v_mfma_f32_16x16x32_bf16 v[40:43], a[72:75], v[104:107], v[40:43]
	s_add_u32 s50, s7, 92160
	ds_read_b128 a[4:7], v8 offset:33024
	v_cvt_pk_bf16_f32 v33, v50, v51
	v_cvt_pk_bf16_f32 v35, v54, v55
	v_mfma_f32_16x16x32_bf16 v[40:43], a[76:79], v[108:111], v[40:43]
	buffer_load_dwordx4 v5, s[24:27], s50 offen lds
	v_add_f32 v24, v24, v48
	v_mfma_f32_16x16x32_bf16 v[44:47], a[80:83], v[96:99], 0
	s_add_u32 m0, s62, 3072
	ds_read_b128 a[8:11], v12 offset:32768
	v_add_f32 v24, v24, v49
	v_add_f32 v24, v24, v50
	v_mfma_f32_16x16x32_bf16 v[44:47], a[84:87], v[100:103], v[44:47]
	s_add_u32 s50, s7, 101376
	ds_read_b128 a[12:15], v12 offset:33024
	v_add_f32 v24, v24, v51
	v_mfma_f32_16x16x32_bf16 v[44:47], a[88:91], v[104:107], v[44:47]
	buffer_load_dwordx4 v5, s[24:27], s50 offen lds
	v_add_f32 v24, v24, v52
	v_mfma_f32_16x16x32_bf16 v[44:47], a[92:95], v[108:111], v[44:47]
	s_add_u32 m0, s62, 4096
	ds_read_b128 a[16:19], v8 offset:36864
	v_add_f32 v24, v24, v53
	v_add_f32 v24, v24, v54
	v_mfma_f32_16x16x32_bf16 v[128:131], a[96:99], v[32:35], v[128:131]
	s_add_u32 s50, s7, 110592
	ds_read_b128 a[20:23], v8 offset:37120
	v_add_f32 v24, v24, v55
	v_mfma_f32_16x16x32_bf16 v[132:135], a[100:103], v[32:35], v[132:135]
	buffer_load_dwordx4 v5, s[24:27], s50 offen lds
	v_exp_f32 v56, v56
	v_mfma_f32_16x16x32_bf16 v[136:139], a[104:107], v[32:35], v[136:139]
	s_add_u32 m0, s62, 5120
	ds_read_b128 a[24:27], v12 offset:36864
	v_add_f32 v25, v25, v56
	v_mfma_f32_16x16x32_bf16 v[140:143], a[108:111], v[32:35], v[140:143]
	s_add_u32 s50, s7, 119808
	ds_read_b128 a[28:31], v12 offset:37120
	v_exp_f32 v57, v57
	v_mfma_f32_16x16x32_bf16 v[144:147], a[112:115], v[32:35], v[144:147]
	buffer_load_dwordx4 v5, s[24:27], s50 offen lds
	v_cvt_pk_bf16_f32 v36, v56, v57
	v_mfma_f32_16x16x32_bf16 v[148:151], a[116:119], v[32:35], v[148:151]
	s_add_u32 m0, s62, 6144
	ds_read_b128 a[64:67], v10 offset:32768
	v_exp_f32 v60, v60
	v_mfma_f32_16x16x32_bf16 v[152:155], a[120:123], v[32:35], v[152:155]
	s_add_u32 s50, s7, 129024
	v_exp_f32 v61, v61
	v_mfma_f32_16x16x32_bf16 v[156:159], a[124:127], v[32:35], v[156:159]
	s_waitcnt lgkmcnt(8)
	buffer_load_dwordx4 v5, s[24:27], s50 offen lds
	v_cvt_pk_bf16_f32 v38, v60, v61
	v_mfma_f32_16x16x32_bf16 v[48:51], a[0:3], v[64:67], 0
	s_waitcnt lgkmcnt(7)
	ds_read_b128 a[68:71], v10 offset:33024
	v_exp_f32 v58, v58
	v_mfma_f32_16x16x32_bf16 v[48:51], a[4:7], v[68:71], v[48:51]
	s_waitcnt lgkmcnt(7)
	v_exp_f32 v59, v59
	v_mfma_f32_16x16x32_bf16 v[48:51], a[8:11], v[72:75], v[48:51]
	s_waitcnt lgkmcnt(6)
	s_add_u32 m0, s62, 7168
	s_add_u32 s50, s7, 138240
	buffer_load_dwordx4 v5, s[24:27], s50 offen lds
	v_exp_f32 v62, v62
	v_mfma_f32_16x16x32_bf16 v[48:51], a[12:15], v[76:79], v[48:51]
	s_waitcnt lgkmcnt(5)
	v_exp_f32 v63, v63
	v_mfma_f32_16x16x32_bf16 v[52:55], a[16:19], v[64:67], 0
	s_waitcnt lgkmcnt(4)
	ds_read_b128 a[72:75], v14 offset:32768
	v_cvt_pk_bf16_f32 v37, v58, v59
	v_cvt_pk_bf16_f32 v39, v62, v63
	v_mfma_f32_16x16x32_bf16 v[52:55], a[20:23], v[68:71], v[52:55]
	s_waitcnt lgkmcnt(4)
	ds_read_b128 a[76:79], v14 offset:33024
	v_add_f32 v25, v25, v57
	v_mfma_f32_16x16x32_bf16 v[52:55], a[24:27], v[72:75], v[52:55]
	s_waitcnt lgkmcnt(4)
	ds_read_b128 a[80:83], v10 offset:36864
	v_add_f32 v25, v25, v58
	v_add_f32 v25, v25, v59
	v_mfma_f32_16x16x32_bf16 v[52:55], a[28:31], v[76:79], v[52:55]
	ds_read_b128 a[84:87], v10 offset:37120
	v_add_f32 v25, v25, v60
	v_mfma_f32_16x16x32_bf16 v[160:163], a[96:99], v[36:39], v[160:163]
	ds_read_b128 a[88:91], v14 offset:36864
	v_add_f32 v25, v25, v61
	v_add_f32 v25, v25, v62
	v_mfma_f32_16x16x32_bf16 v[164:167], a[100:103], v[36:39], v[164:167]
	ds_read_b128 a[92:95], v14 offset:37120
	v_add_f32 v25, v25, v63
	v_mfma_f32_16x16x32_bf16 v[168:171], a[104:107], v[36:39], v[168:171]
	v_exp_f32 v40, v40
	v_mfma_f32_16x16x32_bf16 v[172:175], a[108:111], v[36:39], v[172:175]
	ds_read_b64_tr_b16 a[32:33], v16 offset:40960
	v_exp_f32 v41, v41
	v_mfma_f32_16x16x32_bf16 v[176:179], a[112:115], v[36:39], v[176:179]
	v_exp_f32 v44, v44
	v_mfma_f32_16x16x32_bf16 v[180:183], a[116:119], v[36:39], v[180:183]
	v_cvt_pk_bf16_f32 v28, v40, v41
	v_exp_f32 v45, v45
	v_mfma_f32_16x16x32_bf16 v[184:187], a[120:123], v[36:39], v[184:187]
	v_exp_f32 v42, v42
	v_mfma_f32_16x16x32_bf16 v[188:191], a[124:127], v[36:39], v[188:191]
	s_waitcnt lgkmcnt(8)
	v_exp_f32 v43, v43
	v_cvt_pk_bf16_f32 v30, v44, v45
	v_mfma_f32_16x16x32_bf16 v[56:59], a[64:67], v[64:67], 0
	s_waitcnt lgkmcnt(7)
	v_exp_f32 v46, v46
	v_mfma_f32_16x16x32_bf16 v[56:59], a[68:71], v[68:71], v[56:59]
	s_waitcnt lgkmcnt(6)
	v_cvt_pk_bf16_f32 v29, v42, v43
	v_exp_f32 v47, v47
	v_mfma_f32_16x16x32_bf16 v[56:59], a[72:75], v[72:75], v[56:59]
	s_waitcnt lgkmcnt(5)
	ds_read_b64_tr_b16 a[34:35], v16 offset:45056
	v_cvt_pk_bf16_f32 v31, v46, v47
	v_mfma_f32_16x16x32_bf16 v[56:59], a[76:79], v[76:79], v[56:59]
	s_waitcnt lgkmcnt(5)
	v_add_f32 v26, v26, v40
	v_add_f32 v26, v26, v41
	v_mfma_f32_16x16x32_bf16 v[60:63], a[80:83], v[64:67], 0
	s_waitcnt lgkmcnt(4)
	ds_read_b64_tr_b16 a[36:37], v20 offset:40960
	v_add_f32 v26, v26, v42
	v_add_f32 v26, v26, v43
	v_mfma_f32_16x16x32_bf16 v[60:63], a[84:87], v[68:71], v[60:63]
	s_waitcnt lgkmcnt(4)
	ds_read_b64_tr_b16 a[38:39], v20 offset:45056
	v_add_f32 v26, v26, v44
	v_mfma_f32_16x16x32_bf16 v[60:63], a[88:91], v[72:75], v[60:63]
	s_waitcnt lgkmcnt(4)
	ds_read_b64_tr_b16 a[40:41], v16 offset:41216
	v_add_f32 v26, v26, v45
	v_add_f32 v26, v26, v46
	v_mfma_f32_16x16x32_bf16 v[60:63], a[92:95], v[76:79], v[60:63]
	ds_read_b64_tr_b16 a[42:43], v16 offset:45312
	v_add_f32 v26, v26, v47
	v_mfma_f32_16x16x32_bf16 v[192:195], a[96:99], v[28:31], v[192:195]
	ds_read_b64_tr_b16 a[44:45], v20 offset:41216
	v_exp_f32 v48, v48
	v_mfma_f32_16x16x32_bf16 v[196:199], a[100:103], v[28:31], v[196:199]
	ds_read_b64_tr_b16 a[46:47], v20 offset:45312
	v_add_f32 v24, v24, v48
	v_mfma_f32_16x16x32_bf16 v[200:203], a[104:107], v[28:31], v[200:203]
	ds_read_b64_tr_b16 a[48:49], v16 offset:41472
	v_exp_f32 v49, v49
	v_mfma_f32_16x16x32_bf16 v[204:207], a[108:111], v[28:31], v[204:207]
	ds_read_b64_tr_b16 a[50:51], v16 offset:45568
	v_cvt_pk_bf16_f32 v32, v48, v49
	v_mfma_f32_16x16x32_bf16 v[208:211], a[112:115], v[28:31], v[208:211]
	v_exp_f32 v52, v52
	v_mfma_f32_16x16x32_bf16 v[212:215], a[116:119], v[28:31], v[212:215]
	ds_read_b64_tr_b16 a[52:53], v20 offset:41472
	v_exp_f32 v53, v53
	v_mfma_f32_16x16x32_bf16 v[216:219], a[120:123], v[28:31], v[216:219]
	ds_read_b64_tr_b16 a[54:55], v20 offset:45568
	v_cvt_pk_bf16_f32 v34, v52, v53
	v_mfma_f32_16x16x32_bf16 v[220:223], a[124:127], v[28:31], v[220:223]
	ds_read_b64_tr_b16 a[56:57], v16 offset:41728
	v_exp_f32 v50, v50
	v_mfma_f32_16x16x32_bf16 v[40:43], a[0:3], v[80:83], 0
	v_exp_f32 v51, v51
	v_mfma_f32_16x16x32_bf16 v[40:43], a[4:7], v[84:87], v[40:43]
	ds_read_b64_tr_b16 a[58:59], v16 offset:45824
	v_exp_f32 v54, v54
	v_mfma_f32_16x16x32_bf16 v[40:43], a[8:11], v[88:91], v[40:43]
	v_exp_f32 v55, v55
	v_mfma_f32_16x16x32_bf16 v[40:43], a[12:15], v[92:95], v[40:43]
	ds_read_b64_tr_b16 a[60:61], v20 offset:41728
	v_cvt_pk_bf16_f32 v33, v50, v51
	v_cvt_pk_bf16_f32 v35, v54, v55
	v_mfma_f32_16x16x32_bf16 v[44:47], a[16:19], v[80:83], 0
	ds_read_b64_tr_b16 a[62:63], v20 offset:45824
	v_add_f32 v24, v24, v49
	v_mfma_f32_16x16x32_bf16 v[44:47], a[20:23], v[84:87], v[44:47]
	v_add_f32 v24, v24, v50
	v_add_f32 v24, v24, v51
	v_mfma_f32_16x16x32_bf16 v[44:47], a[24:27], v[88:91], v[44:47]
	ds_read_b64_tr_b16 a[96:97], v18 offset:40960
	v_add_f32 v24, v24, v52
	v_add_f32 v24, v24, v53
	v_mfma_f32_16x16x32_bf16 v[44:47], a[28:31], v[92:95], v[44:47]
	s_waitcnt lgkmcnt(15)
	ds_read_b64_tr_b16 a[98:99], v18 offset:45056
	v_add_f32 v24, v24, v54
	v_mfma_f32_16x16x32_bf16 v[128:131], a[32:35], v[32:35], v[128:131]
	s_waitcnt lgkmcnt(14)
	ds_read_b64_tr_b16 a[100:101], v22 offset:40960
	v_add_f32 v24, v24, v55
	v_mfma_f32_16x16x32_bf16 v[132:135], a[36:39], v[32:35], v[132:135]
	s_waitcnt lgkmcnt(13)
	ds_read_b64_tr_b16 a[102:103], v22 offset:45056
	v_mfma_f32_16x16x32_bf16 v[136:139], a[40:43], v[32:35], v[136:139]
	s_waitcnt lgkmcnt(12)
	ds_read_b64_tr_b16 a[104:105], v18 offset:41216
	v_exp_f32 v56, v56
	v_mfma_f32_16x16x32_bf16 v[140:143], a[44:47], v[32:35], v[140:143]
	s_waitcnt lgkmcnt(11)
	ds_read_b64_tr_b16 a[106:107], v18 offset:45312
	v_add_f32 v24, v24, v56
	v_mfma_f32_16x16x32_bf16 v[144:147], a[48:51], v[32:35], v[144:147]
	s_waitcnt lgkmcnt(10)
	ds_read_b64_tr_b16 a[108:109], v22 offset:41216
	v_exp_f32 v57, v57
	v_mfma_f32_16x16x32_bf16 v[148:151], a[52:55], v[32:35], v[148:151]
	s_waitcnt lgkmcnt(9)
	ds_read_b64_tr_b16 a[110:111], v22 offset:45312
	v_cvt_pk_bf16_f32 v36, v56, v57
	v_mfma_f32_16x16x32_bf16 v[152:155], a[56:59], v[32:35], v[152:155]
	s_waitcnt lgkmcnt(8)
	v_exp_f32 v60, v60
	v_mfma_f32_16x16x32_bf16 v[156:159], a[60:63], v[32:35], v[156:159]
	ds_read_b64_tr_b16 a[112:113], v18 offset:41472
	v_exp_f32 v61, v61
	v_mfma_f32_16x16x32_bf16 v[48:51], a[64:67], v[80:83], 0
	ds_read_b64_tr_b16 a[114:115], v18 offset:45568
	v_cvt_pk_bf16_f32 v38, v60, v61
	v_mfma_f32_16x16x32_bf16 v[48:51], a[68:71], v[84:87], v[48:51]
	ds_read_b64_tr_b16 a[116:117], v22 offset:41472
	v_exp_f32 v58, v58
	v_mfma_f32_16x16x32_bf16 v[48:51], a[72:75], v[88:91], v[48:51]
	v_exp_f32 v59, v59
	v_mfma_f32_16x16x32_bf16 v[48:51], a[76:79], v[92:95], v[48:51]
	ds_read_b64_tr_b16 a[118:119], v22 offset:45568
	v_exp_f32 v62, v62
	v_mfma_f32_16x16x32_bf16 v[52:55], a[80:83], v[80:83], 0
	v_exp_f32 v63, v63
	v_mfma_f32_16x16x32_bf16 v[52:55], a[84:87], v[84:87], v[52:55]
	ds_read_b64_tr_b16 a[120:121], v18 offset:41728
	ds_read_b64_tr_b16 a[122:123], v18 offset:45824
	v_cvt_pk_bf16_f32 v37, v58, v59
	v_mfma_f32_16x16x32_bf16 v[52:55], a[88:91], v[88:91], v[52:55]
	ds_read_b64_tr_b16 a[124:125], v22 offset:41728
	ds_read_b64_tr_b16 a[126:127], v22 offset:45824
	v_cvt_pk_bf16_f32 v39, v62, v63
	v_mfma_f32_16x16x32_bf16 v[52:55], a[92:95], v[92:95], v[52:55]
	s_waitcnt lgkmcnt(14)
	v_add_f32 v24, v24, v57
	v_add_f32 v24, v24, v58
	v_add_f32 v24, v24, v59
	v_mfma_f32_16x16x32_bf16 v[128:131], a[96:99], v[36:39], v[128:131]
	s_waitcnt lgkmcnt(12)
	v_add_f32 v24, v24, v60
	v_add_f32 v24, v24, v61
	v_add_f32 v24, v24, v62
	v_add_f32 v24, v24, v63
	v_mfma_f32_16x16x32_bf16 v[132:135], a[100:103], v[36:39], v[132:135]
	s_waitcnt lgkmcnt(10)
	v_exp_f32 v40, v40
	v_mov_b32 v21, v24
	v_mfma_f32_16x16x32_bf16 v[136:139], a[104:107], v[36:39], v[136:139]
	s_waitcnt lgkmcnt(8)
	v_exp_f32 v41, v41
	v_add_f32 v25, v25, v40
	v_permlane32_swap_b32 v24, v21
	v_mfma_f32_16x16x32_bf16 v[140:143], a[108:111], v[36:39], v[140:143]
	s_waitcnt lgkmcnt(6)
	v_cvt_pk_bf16_f32 v28, v40, v41
	v_exp_f32 v44, v44
	v_add_f32 v24, v24, v21
	v_mfma_f32_16x16x32_bf16 v[144:147], a[112:115], v[36:39], v[144:147]
	s_waitcnt lgkmcnt(4)
	v_add_f32 v25, v25, v41
	v_exp_f32 v45, v45
	v_mov_b32 v21, v24
	v_mfma_f32_16x16x32_bf16 v[148:151], a[116:119], v[36:39], v[148:151]
	s_waitcnt lgkmcnt(2)
	v_exp_f32 v42, v42
	v_cvt_pk_bf16_f32 v30, v44, v45
	v_permlane16_swap_b32 v24, v21
	v_mfma_f32_16x16x32_bf16 v[152:155], a[120:123], v[36:39], v[152:155]
	s_waitcnt lgkmcnt(0)
	v_exp_f32 v43, v43
	v_add_f32 v25, v25, v42
	v_add_f32 v24, v24, v21
	v_mfma_f32_16x16x32_bf16 v[156:159], a[124:127], v[36:39], v[156:159]
	v_exp_f32 v46, v46
	v_rcp_f32 v9, v24
	v_mfma_f32_16x16x32_bf16 v[56:59], a[0:3], v[112:115], 0
	s_barrier
	s_add_u32 s70, s62, 32768
	s_xor_b32 s71, s70, 0x2000
	v_add_u32 v17, s71, v2
	v_add_u32 v19, s70, v2
	v_cvt_pk_bf16_f32 v29, v42, v43
	v_exp_f32 v47, v47
	v_mul_f32 v128, v9, v128
	v_mfma_f32_16x16x32_bf16 v[56:59], a[4:7], v[116:119], v[56:59]
	v_cvt_pk_bf16_f32 v31, v46, v47
	v_mul_f32 v129, v9, v129
	v_mul_f32 v130, v9, v130
	v_mul_f32 v131, v9, v131
	v_mfma_f32_16x16x32_bf16 v[56:59], a[8:11], v[120:123], v[56:59]
	v_mul_f32 v132, v9, v132
	v_mul_f32 v133, v9, v133
	v_mul_f32 v134, v9, v134
	v_mul_f32 v135, v9, v135
	v_mfma_f32_16x16x32_bf16 v[56:59], a[12:15], v[124:127], v[56:59]
	v_cvt_pk_bf16_f32 v128, v128, v129
	v_cvt_pk_bf16_f32 v129, v130, v131
	v_cvt_pk_bf16_f32 v130, v132, v133
	v_cvt_pk_bf16_f32 v131, v134, v135
	v_mfma_f32_16x16x32_bf16 v[60:63], a[16:19], v[112:115], 0
	v_mul_f32 v136, v9, v136
	v_mul_f32 v137, v9, v137
	v_mul_f32 v138, v9, v138
	v_mul_f32 v139, v9, v139
	v_mfma_f32_16x16x32_bf16 v[60:63], a[20:23], v[116:119], v[60:63]
	v_mul_f32 v140, v9, v140
	v_mul_f32 v141, v9, v141
	v_mul_f32 v142, v9, v142
	v_mul_f32 v143, v9, v143
	v_mfma_f32_16x16x32_bf16 v[60:63], a[24:27], v[120:123], v[60:63]
	buffer_store_dwordx4 v[128:131], v2, s[20:23], s52 offen sc1
	v_cvt_pk_bf16_f32 v136, v136, v137
	v_cvt_pk_bf16_f32 v137, v138, v139
	v_cvt_pk_bf16_f32 v138, v140, v141
	v_mfma_f32_16x16x32_bf16 v[60:63], a[28:31], v[124:127], v[60:63]
	v_cvt_pk_bf16_f32 v139, v142, v143
	v_mul_f32 v144, v9, v144
	v_mul_f32 v145, v9, v145
	v_mul_f32 v146, v9, v146
	v_mfma_f32_16x16x32_bf16 v[160:163], a[32:35], v[28:31], v[160:163]
	v_mul_f32 v147, v9, v147
	v_mul_f32 v148, v9, v148
	v_mul_f32 v149, v9, v149
	v_mul_f32 v150, v9, v150
	v_mfma_f32_16x16x32_bf16 v[164:167], a[36:39], v[28:31], v[164:167]
	buffer_store_dwordx4 v[136:139], v2, s[20:23], s52 offen offset:1024 sc1
	v_add_f32 v25, v25, v43
	v_mul_f32 v151, v9, v151
	v_cvt_pk_bf16_f32 v144, v144, v145
	v_mfma_f32_16x16x32_bf16 v[168:171], a[40:43], v[28:31], v[168:171]
	v_cvt_pk_bf16_f32 v145, v146, v147
	v_cvt_pk_bf16_f32 v146, v148, v149
	v_cvt_pk_bf16_f32 v147, v150, v151
	v_mul_f32 v152, v9, v152
	v_mfma_f32_16x16x32_bf16 v[172:175], a[44:47], v[28:31], v[172:175]
	v_mul_f32 v153, v9, v153
	v_mul_f32 v154, v9, v154
	v_mul_f32 v155, v9, v155
	v_mul_f32 v156, v9, v156
	v_mfma_f32_16x16x32_bf16 v[176:179], a[48:51], v[28:31], v[176:179]
	v_add_f32 v25, v25, v44
	v_mul_f32 v157, v9, v157
	v_mul_f32 v158, v9, v158
	v_mul_f32 v159, v9, v159
	v_mfma_f32_16x16x32_bf16 v[180:183], a[52:55], v[28:31], v[180:183]
	buffer_store_dwordx4 v[144:147], v2, s[20:23], s52 offen offset:2048 sc1
	v_add_f32 v25, v25, v45
	v_add_f32 v25, v25, v46
	v_add_f32 v25, v25, v47
	v_mfma_f32_16x16x32_bf16 v[184:187], a[56:59], v[28:31], v[184:187]
	v_cvt_pk_bf16_f32 v152, v152, v153
	v_cvt_pk_bf16_f32 v153, v154, v155
	v_cvt_pk_bf16_f32 v154, v156, v157
	v_cvt_pk_bf16_f32 v155, v158, v159
	v_mfma_f32_16x16x32_bf16 v[188:191], a[60:63], v[28:31], v[188:191]
	v_exp_f32 v48, v48
	v_exp_f32 v49, v49
	v_mfma_f32_16x16x32_bf16 v[40:43], a[0:3], v[96:99], 0
	v_exp_f32 v52, v52
	v_exp_f32 v53, v53
	v_mfma_f32_16x16x32_bf16 v[40:43], a[4:7], v[100:103], v[40:43]
	v_exp_f32 v50, v50
	v_exp_f32 v51, v51
	v_mfma_f32_16x16x32_bf16 v[40:43], a[8:11], v[104:107], v[40:43]
	v_exp_f32 v54, v54
	v_exp_f32 v55, v55
	v_mfma_f32_16x16x32_bf16 v[40:43], a[12:15], v[108:111], v[40:43]
	buffer_store_dwordx4 v[152:155], v2, s[20:23], s52 offen offset:3072 sc1
	v_cvt_pk_bf16_f32 v32, v48, v49
	v_cvt_pk_bf16_f32 v33, v50, v51
	v_cvt_pk_bf16_f32 v34, v52, v53
	v_mfma_f32_16x16x32_bf16 v[44:47], a[16:19], v[96:99], 0
	s_waitcnt vmcnt(32)
	ds_read_b64_tr_b16 v[128:129], v0 offset:32768
	v_add_f32 v25, v25, v48
	v_add_f32 v25, v25, v49
	v_cvt_pk_bf16_f32 v35, v54, v55
	v_mfma_f32_16x16x32_bf16 v[44:47], a[20:23], v[100:103], v[44:47]
	ds_read_b64_tr_b16 v[130:131], v0 offset:34816
	v_add_f32 v25, v25, v50
	v_add_f32 v25, v25, v51
	v_add_f32 v25, v25, v52
	v_mfma_f32_16x16x32_bf16 v[44:47], a[24:27], v[104:107], v[44:47]
	ds_read_b64_tr_b16 v[132:133], v1 offset:32768
	v_add_f32 v25, v25, v53
	v_add_f32 v25, v25, v54
	v_add_f32 v25, v25, v55
	v_mfma_f32_16x16x32_bf16 v[44:47], a[28:31], v[108:111], v[44:47]
	ds_read_b64_tr_b16 v[134:135], v1 offset:34816
	ds_read_b64_tr_b16 v[136:137], v0 offset:33280
	ds_read_b64_tr_b16 v[138:139], v0 offset:35328
	ds_read_b64_tr_b16 v[140:141], v1 offset:33280
	ds_read_b64_tr_b16 v[142:143], v1 offset:35328
	v_mfma_f32_16x16x32_bf16 v[160:163], a[96:99], v[32:35], v[160:163]
	s_waitcnt vmcnt(28)
	ds_read_b64_tr_b16 v[144:145], v0 offset:36864
	v_exp_f32 v56, v56
	v_mov_b32 v23, v25
	v_mfma_f32_16x16x32_bf16 v[164:167], a[100:103], v[32:35], v[164:167]
	s_add_u32 m0, s62, 98304
	ds_read_b64_tr_b16 v[146:147], v0 offset:38912
	v_exp_f32 v57, v57
	v_permlane32_swap_b32 v25, v23
	v_mfma_f32_16x16x32_bf16 v[168:171], a[104:107], v[32:35], v[168:171]
	s_add_u32 s50, s8, 73728
	ds_read_b64_tr_b16 v[148:149], v1 offset:36864
	v_exp_f32 v60, v60
	v_add_f32 v25, v25, v23
	v_mfma_f32_16x16x32_bf16 v[172:175], a[108:111], v[32:35], v[172:175]
	ds_read_b64_tr_b16 v[150:151], v1 offset:38912
	ds_read_b64_tr_b16 v[152:153], v0 offset:37376
	ds_read_b64_tr_b16 v[154:155], v0 offset:39424
	ds_read_b64_tr_b16 v[156:157], v1 offset:37376
	ds_read_b64_tr_b16 v[158:159], v1 offset:39424
	v_mfma_f32_16x16x32_bf16 v[176:179], a[112:115], v[32:35], v[176:179]
	s_waitcnt lgkmcnt(8)
	buffer_load_dwordx4 v5, s[24:27], s50 offen lds
	v_exp_f32 v61, v61
	v_mov_b32 v23, v25
	v_mfma_f32_16x16x32_bf16 v[180:183], a[116:119], v[32:35], v[180:183]
	s_add_u32 m0, s62, 99328
	s_add_u32 s50, s8, 82944
	buffer_load_dwordx4 v5, s[24:27], s50 offen lds
	v_exp_f32 v58, v58
	v_permlane16_swap_b32 v25, v23
	v_mfma_f32_16x16x32_bf16 v[184:187], a[120:123], v[32:35], v[184:187]
	s_add_u32 m0, s62, 100352
	s_add_u32 s50, s8, 92160
	buffer_load_dwordx4 v5, s[24:27], s50 offen lds
	v_exp_f32 v59, v59
	v_add_f32 v25, v25, v23
	v_mfma_f32_16x16x32_bf16 v[188:191], a[124:127], v[32:35], v[188:191]
	s_add_u32 m0, s62, 101376
	s_add_u32 s50, s8, 101376
	buffer_load_dwordx4 v5, s[24:27], s50 offen lds
	v_cvt_pk_bf16_f32 v36, v56, v57
	v_rcp_f32 v11, v25
	v_mfma_f32_16x16x32_bf16 v[48:51], a[64:67], v[96:99], 0
	s_add_u32 m0, s62, 102400
	s_add_u32 s50, s8, 110592
	s_waitcnt lgkmcnt(0)
	buffer_load_dwordx4 v5, s[24:27], s50 offen lds
	v_cvt_pk_bf16_f32 v37, v58, v59
	v_exp_f32 v62, v62
	v_mfma_f32_16x16x32_bf16 v[48:51], a[68:71], v[100:103], v[48:51]
	s_add_u32 m0, s62, 103424
	s_add_u32 s50, s8, 119808
	buffer_load_dwordx4 v5, s[24:27], s50 offen lds
	v_exp_f32 v63, v63
	v_cvt_pk_bf16_f32 v38, v60, v61
	v_mfma_f32_16x16x32_bf16 v[48:51], a[72:75], v[104:107], v[48:51]
	s_add_u32 m0, s62, 104448
	s_add_u32 s50, s8, 129024
	buffer_load_dwordx4 v5, s[24:27], s50 offen lds
	v_cvt_pk_bf16_f32 v39, v62, v63
	v_mul_f32 v160, v11, v160
	v_mul_f32 v161, v11, v161
	v_mfma_f32_16x16x32_bf16 v[48:51], a[76:79], v[108:111], v[48:51]
	s_add_u32 m0, s62, 105472
	s_add_u32 s50, s8, 138240
	buffer_load_dwordx4 v5, s[24:27], s50 offen lds
	v_mul_f32 v162, v11, v162
	v_mul_f32 v163, v11, v163
	v_mul_f32 v164, v11, v164
	v_mfma_f32_16x16x32_bf16 v[52:55], a[80:83], v[96:99], 0
	v_mul_f32 v165, v11, v165
	v_mul_f32 v166, v11, v166
	v_mul_f32 v167, v11, v167
	v_cvt_pk_bf16_f32 v160, v160, v161
	v_mfma_f32_16x16x32_bf16 v[52:55], a[84:87], v[100:103], v[52:55]
	v_exp_f32 v40, v40
	v_exp_f32 v41, v41
	v_mfma_f32_16x16x32_bf16 v[52:55], a[88:91], v[104:107], v[52:55]
	v_exp_f32 v44, v44
	v_exp_f32 v45, v45
	v_mfma_f32_16x16x32_bf16 v[52:55], a[92:95], v[108:111], v[52:55]
	v_exp_f32 v42, v42
	v_exp_f32 v43, v43
	v_mfma_f32_16x16x32_bf16 v[224:227], a[32:35], v[36:39], v[224:227]
	v_exp_f32 v46, v46
	v_exp_f32 v47, v47
	v_mfma_f32_16x16x32_bf16 v[228:231], a[36:39], v[36:39], v[228:231]
	v_cvt_pk_bf16_f32 v161, v162, v163
	v_cvt_pk_bf16_f32 v162, v164, v165
	v_cvt_pk_bf16_f32 v163, v166, v167
	v_mul_f32 v168, v11, v168
	v_mfma_f32_16x16x32_bf16 v[232:235], a[40:43], v[36:39], v[232:235]
	v_mul_f32 v169, v11, v169
	v_mul_f32 v170, v11, v170
	v_mul_f32 v171, v11, v171
	v_mul_f32 v172, v11, v172
	v_mfma_f32_16x16x32_bf16 v[236:239], a[44:47], v[36:39], v[236:239]
	v_cvt_pk_bf16_f32 v28, v40, v41
	v_mul_f32 v173, v11, v173
	v_mul_f32 v174, v11, v174
	v_mul_f32 v175, v11, v175
	v_mfma_f32_16x16x32_bf16 v[240:243], a[48:51], v[36:39], v[240:243]
	buffer_store_dwordx4 v[160:163], v2, s[20:23], s53 offen sc1
	v_cvt_pk_bf16_f32 v29, v42, v43
	v_cvt_pk_bf16_f32 v30, v44, v45
	v_cvt_pk_bf16_f32 v31, v46, v47
	v_mfma_f32_16x16x32_bf16 v[244:247], a[52:55], v[36:39], v[244:247]
	v_cvt_pk_bf16_f32 v168, v168, v169
	v_cvt_pk_bf16_f32 v169, v170, v171
	v_cvt_pk_bf16_f32 v170, v172, v173
	v_cvt_pk_bf16_f32 v171, v174, v175
	v_mfma_f32_16x16x32_bf16 v[248:251], a[56:59], v[36:39], v[248:251]
	v_mul_f32 v176, v11, v176
	v_mul_f32 v177, v11, v177
	v_mul_f32 v178, v11, v178
	v_mul_f32 v179, v11, v179
	v_mul_f32 v180, v11, v180
	v_mul_f32 v181, v11, v181
	v_mul_f32 v182, v11, v182
	v_mul_f32 v183, v11, v183
	v_mfma_f32_16x16x32_bf16 v[252:255], a[60:63], v[36:39], v[252:255]
	buffer_store_dwordx4 v[168:171], v2, s[20:23], s53 offen offset:1024 sc1
	v_cvt_pk_bf16_f32 v176, v176, v177
	v_cvt_pk_bf16_f32 v177, v178, v179
	v_cvt_pk_bf16_f32 v178, v180, v181
	v_mfma_f32_16x16x32_bf16 v[192:195], a[32:35], v[28:31], v[192:195]
	v_cvt_pk_bf16_f32 v179, v182, v183
	v_mul_f32 v184, v11, v184
	v_mul_f32 v185, v11, v185
	v_mul_f32 v186, v11, v186
	v_mul_f32 v187, v11, v187
	v_mul_f32 v188, v11, v188
	v_mul_f32 v189, v11, v189
	v_mul_f32 v190, v11, v190
	v_mul_f32 v191, v11, v191
	v_mfma_f32_16x16x32_bf16 v[196:199], a[36:39], v[28:31], v[196:199]
	v_add_f32 v27, v27, v56
	v_add_f32 v27, v27, v57
	v_add_f32 v27, v27, v58
	v_add_f32 v27, v27, v59
	v_mfma_f32_16x16x32_bf16 v[200:203], a[40:43], v[28:31], v[200:203]
	buffer_store_dwordx4 v[176:179], v2, s[20:23], s53 offen offset:2048 sc1
	v_add_f32 v27, v27, v60
	v_add_f32 v27, v27, v61
	v_add_f32 v27, v27, v62
	v_add_f32 v27, v27, v63
	v_cvt_pk_bf16_f32 v184, v184, v185
	v_cvt_pk_bf16_f32 v185, v186, v187
	v_cvt_pk_bf16_f32 v186, v188, v189
	v_cvt_pk_bf16_f32 v187, v190, v191
	v_mfma_f32_16x16x32_bf16 v[204:207], a[44:47], v[28:31], v[204:207]
	v_exp_f32 v48, v48
	v_exp_f32 v49, v49
	v_exp_f32 v52, v52
	v_exp_f32 v53, v53
	v_mfma_f32_16x16x32_bf16 v[208:211], a[48:51], v[28:31], v[208:211]
	buffer_store_dwordx4 v[184:187], v2, s[20:23], s53 offen offset:3072 sc1
	v_exp_f32 v50, v50
	v_exp_f32 v51, v51
	v_exp_f32 v54, v54
	v_exp_f32 v55, v55
	v_mfma_f32_16x16x32_bf16 v[212:215], a[52:55], v[28:31], v[212:215]
	v_cvt_pk_bf16_f32 v32, v48, v49
	v_cvt_pk_bf16_f32 v33, v50, v51
	v_cvt_pk_bf16_f32 v34, v52, v53
	v_cvt_pk_bf16_f32 v35, v54, v55
	v_mfma_f32_16x16x32_bf16 v[216:219], a[56:59], v[28:31], v[216:219]
	s_cmp_eq_u32 s41, 1
	s_cbranch_scc1 L_xw1a
	ds_write_b128 v17, v[240:243] offset:0
	ds_write_b128 v17, v[244:247] offset:1024
	ds_write_b128 v17, v[248:251] offset:2048
	ds_write_b128 v17, v[252:255] offset:3072
	s_branch L_xwda
L_xw1a:
	ds_write_b128 v17, v[224:227] offset:0
	ds_write_b128 v17, v[228:231] offset:1024
	ds_write_b128 v17, v[232:235] offset:2048
	ds_write_b128 v17, v[236:239] offset:3072
L_xwda:
	ds_write_b32 v17, v27 offset:4096
	v_add_f32 v26, v26, v40
	v_add_f32 v26, v26, v41
	v_add_f32 v26, v26, v42
	v_add_f32 v26, v26, v43
	v_mfma_f32_16x16x32_bf16 v[220:223], a[60:63], v[28:31], v[220:223]
	v_add_f32 v26, v26, v44
	v_add_f32 v26, v26, v45
	v_add_f32 v26, v26, v46
	v_add_f32 v26, v26, v47
	v_mfma_f32_16x16x32_bf16 v[192:195], a[96:99], v[32:35], v[192:195]
	v_add_f32 v26, v26, v48
	v_add_f32 v26, v26, v49
	v_add_f32 v26, v26, v50
	v_add_f32 v26, v26, v51
	v_mfma_f32_16x16x32_bf16 v[196:199], a[100:103], v[32:35], v[196:199]
	v_add_f32 v26, v26, v52
	v_add_f32 v26, v26, v53
	v_add_f32 v26, v26, v54
	v_add_f32 v26, v26, v55
	v_mfma_f32_16x16x32_bf16 v[200:203], a[104:107], v[32:35], v[200:203]
	v_mfma_f32_16x16x32_bf16 v[204:207], a[108:111], v[32:35], v[204:207]
	v_mfma_f32_16x16x32_bf16 v[208:211], a[112:115], v[32:35], v[208:211]
	v_mfma_f32_16x16x32_bf16 v[212:215], a[116:119], v[32:35], v[212:215]
	v_mfma_f32_16x16x32_bf16 v[216:219], a[120:123], v[32:35], v[216:219]
	v_mfma_f32_16x16x32_bf16 v[220:223], a[124:127], v[32:35], v[220:223]
	s_mov_b32 s65, 0
L_epi:
	v_mov_b32 v44, v27
	v_mov_b32 v40, v26
	v_mov_b32 v41, v44
	s_nop 0
	v_permlane32_swap_b32 v26, v40
	v_permlane32_swap_b32 v44, v41
	v_add_f32 v26, v26, v40
	v_add_f32 v44, v44, v41
	v_mov_b32 v40, v26
	v_mov_b32 v41, v44
	s_nop 0
	v_permlane16_swap_b32 v26, v40
	v_permlane16_swap_b32 v44, v41
	v_add_f32 v26, v26, v40
	v_add_f32 v44, v44, v41
	v_rcp_f32 v13, v26
	v_max3_f32 v40, v24, v25, v26
	v_min3_f32 v41, v24, v25, v26
	v_add_f32 v42, v24, v25
	v_add_f32 v43, v26, v44
	v_max_f32 v40, v40, v44
	v_min_f32 v41, v41, v44
	v_add_f32 v42, v42, v43
	v_cmp_lt_f32 vcc, 0x49800000, v40
	s_mov_b64 s[72:73], vcc
	v_cmp_gt_f32 vcc, 0x35800000, v41
	s_or_b64 s[72:73], s[72:73], vcc
	v_cmp_u_f32 vcc, v42, v42
	s_or_b64 s[72:73], s[72:73], vcc
	s_or_b32 s72, s72, s73
	v_mov_b32 v40, s72
	v_bfe_u32 v41, v2, 4, 2
	v_lshlrev_b32 v41, 13, v41
	s_lshl_b32 s73, s40, 2
	v_add_u32 v41, s73, v41
	ds_write_b32 v41, v40 offset:38912
	v_subrev_u32 v21, 65536, v0
	v_xor_b32 v23, 32, v21
	v_pk_mul_f32 v[192:193], v[192:193], v[12:13] op_sel:[0,1] op_sel_hi:[1,1]
	v_pk_mul_f32 v[194:195], v[194:195], v[12:13] op_sel:[0,1] op_sel_hi:[1,1]
	v_pk_mul_f32 v[196:197], v[196:197], v[12:13] op_sel:[0,1] op_sel_hi:[1,1]
	v_pk_mul_f32 v[198:199], v[198:199], v[12:13] op_sel:[0,1] op_sel_hi:[1,1]
	v_cvt_pk_bf16_f32 v192, v192, v193
	v_cvt_pk_bf16_f32 v193, v194, v195
	v_cvt_pk_bf16_f32 v194, v196, v197
	v_cvt_pk_bf16_f32 v195, v198, v199
	buffer_store_dwordx4 v[192:195], v2, s[20:23], s54 offen sc1
	s_waitcnt lgkmcnt(0)
	s_barrier
	s_add_u32 s70, s62, 38912
	v_mov_b32 v61, s70
	ds_read_b128 v[28:31], v61 offset:0
	ds_read_b32 v60, v19 offset:4096
	ds_read_b128 v[44:47], v19 offset:0
	ds_read_b128 v[48:51], v19 offset:1024
	ds_read_b128 v[52:55], v19 offset:2048
	ds_read_b128 v[56:59], v19 offset:3072
	v_pk_mul_f32 v[200:201], v[200:201], v[12:13] op_sel:[0,1] op_sel_hi:[1,1]
	v_pk_mul_f32 v[202:203], v[202:203], v[12:13] op_sel:[0,1] op_sel_hi:[1,1]
	s_waitcnt vmcnt(37)
	ds_read_b64_tr_b16 v[160:161], v6 offset:0
	v_pk_mul_f32 v[204:205], v[204:205], v[12:13] op_sel:[0,1] op_sel_hi:[1,1]
	v_pk_mul_f32 v[206:207], v[206:207], v[12:13] op_sel:[0,1] op_sel_hi:[1,1]
	ds_read_b64_tr_b16 v[162:163], v6 offset:2048
	v_cvt_pk_bf16_f32 v200, v200, v201
	v_cvt_pk_bf16_f32 v201, v202, v203
	ds_read_b64_tr_b16 v[164:165], v7 offset:0
	v_cvt_pk_bf16_f32 v202, v204, v205
	v_cvt_pk_bf16_f32 v203, v206, v207
	ds_read_b64_tr_b16 v[166:167], v7 offset:2048
	buffer_store_dwordx4 v[200:203], v2, s[20:23], s54 offen offset:1024 sc1
	v_pk_mul_f32 v[208:209], v[208:209], v[12:13] op_sel:[0,1] op_sel_hi:[1,1]
	ds_read_b64_tr_b16 v[168:169], v6 offset:512
	v_pk_mul_f32 v[210:211], v[210:211], v[12:13] op_sel:[0,1] op_sel_hi:[1,1]
	v_pk_mul_f32 v[212:213], v[212:213], v[12:13] op_sel:[0,1] op_sel_hi:[1,1]
	ds_read_b64_tr_b16 v[170:171], v6 offset:2560
	v_pk_mul_f32 v[214:215], v[214:215], v[12:13] op_sel:[0,1] op_sel_hi:[1,1]
	v_cvt_pk_bf16_f32 v208, v208, v209
	ds_read_b64_tr_b16 v[172:173], v7 offset:512
	v_cvt_pk_bf16_f32 v209, v210, v211
	v_cvt_pk_bf16_f32 v210, v212, v213
	ds_read_b64_tr_b16 v[174:175], v7 offset:2560
	v_cvt_pk_bf16_f32 v211, v214, v215
	buffer_store_dwordx4 v[208:211], v2, s[20:23], s54 offen offset:2048 sc1
	s_waitcnt vmcnt(35)
	ds_read_b64_tr_b16 v[176:177], v6 offset:4096
	v_pk_mul_f32 v[216:217], v[216:217], v[12:13] op_sel:[0,1] op_sel_hi:[1,1]
	v_pk_mul_f32 v[218:219], v[218:219], v[12:13] op_sel:[0,1] op_sel_hi:[1,1]
	ds_read_b64_tr_b16 v[178:179], v6 offset:6144
	v_pk_mul_f32 v[220:221], v[220:221], v[12:13] op_sel:[0,1] op_sel_hi:[1,1]
	v_pk_mul_f32 v[222:223], v[222:223], v[12:13] op_sel:[0,1] op_sel_hi:[1,1]
	ds_read_b64_tr_b16 v[180:181], v7 offset:4096
	v_cvt_pk_bf16_f32 v216, v216, v217
	v_cvt_pk_bf16_f32 v217, v218, v219
	ds_read_b64_tr_b16 v[182:183], v7 offset:6144
	v_cvt_pk_bf16_f32 v218, v220, v221
	v_cvt_pk_bf16_f32 v219, v222, v223
	ds_read_b64_tr_b16 v[184:185], v6 offset:4608
	buffer_store_dwordx4 v[216:219], v2, s[20:23], s54 offen offset:3072 sc1
	s_waitcnt lgkmcnt(15)
	v_or3_b32 v61, v28, v29, v30
	v_or_b32 v61, v61, v31
	v_add_f32 v27, v27, v60
	v_readfirstlane_b32 s70, v61
	v_mov_b32 v40, v27
	s_nop 1
	v_permlane32_swap_b32 v27, v40
	v_add_f32 v27, v27, v40
	v_mov_b32 v40, v27
	s_nop 1
	v_permlane16_swap_b32 v27, v40
	v_add_f32 v27, v27, v40
	v_rcp_f32 v15, v27
	s_andn2_b32 s70, s70, s65
	s_cbranch_scc1 L_slow
	s_waitcnt lgkmcnt(13)
	s_cmp_eq_u32 s41, 1
	s_cbranch_scc1 L_ep1
	v_pk_add_f32 v[224:225], v[224:225], v[44:45]
	v_pk_add_f32 v[226:227], v[226:227], v[46:47]
	v_pk_add_f32 v[228:229], v[228:229], v[48:49]
	v_pk_add_f32 v[230:231], v[230:231], v[50:51]
	v_pk_add_f32 v[232:233], v[232:233], v[52:53]
	v_pk_add_f32 v[234:235], v[234:235], v[54:55]
	v_pk_add_f32 v[236:237], v[236:237], v[56:57]
	v_pk_add_f32 v[238:239], v[238:239], v[58:59]
	v_pk_mul_f32 v[224:225], v[224:225], v[14:15] op_sel:[0,1] op_sel_hi:[1,1]
	v_pk_mul_f32 v[226:227], v[226:227], v[14:15] op_sel:[0,1] op_sel_hi:[1,1]
	v_pk_mul_f32 v[228:229], v[228:229], v[14:15] op_sel:[0,1] op_sel_hi:[1,1]
	v_pk_mul_f32 v[230:231], v[230:231], v[14:15] op_sel:[0,1] op_sel_hi:[1,1]
	v_cvt_pk_bf16_f32 v224, v224, v225
	v_cvt_pk_bf16_f32 v225, v226, v227
	v_cvt_pk_bf16_f32 v226, v228, v229
	v_cvt_pk_bf16_f32 v227, v230, v231
	buffer_store_dwordx4 v[224:227], v2, s[20:23], s55 offen sc1
	v_pk_mul_f32 v[232:233], v[232:233], v[14:15] op_sel:[0,1] op_sel_hi:[1,1]
	v_pk_mul_f32 v[234:235], v[234:235], v[14:15] op_sel:[0,1] op_sel_hi:[1,1]
	v_pk_mul_f32 v[236:237], v[236:237], v[14:15] op_sel:[0,1] op_sel_hi:[1,1]
	v_pk_mul_f32 v[238:239], v[238:239], v[14:15] op_sel:[0,1] op_sel_hi:[1,1]
	v_cvt_pk_bf16_f32 v232, v232, v233
	v_cvt_pk_bf16_f32 v233, v234, v235
	v_cvt_pk_bf16_f32 v234, v236, v237
	v_cvt_pk_bf16_f32 v235, v238, v239
	buffer_store_dwordx4 v[232:235], v2, s[20:23], s55 offen offset:1024 sc1
	s_branch L_ep_done
L_ep1:
	v_pk_add_f32 v[240:241], v[240:241], v[44:45]
	v_pk_add_f32 v[242:243], v[242:243], v[46:47]
	v_pk_add_f32 v[244:245], v[244:245], v[48:49]
	v_pk_add_f32 v[246:247], v[246:247], v[50:51]
	v_pk_add_f32 v[248:249], v[248:249], v[52:53]
	v_pk_add_f32 v[250:251], v[250:251], v[54:55]
	v_pk_add_f32 v[252:253], v[252:253], v[56:57]
	v_pk_add_f32 v[254:255], v[254:255], v[58:59]
	v_pk_mul_f32 v[240:241], v[240:241], v[14:15] op_sel:[0,1] op_sel_hi:[1,1]
	v_pk_mul_f32 v[242:243], v[242:243], v[14:15] op_sel:[0,1] op_sel_hi:[1,1]
	v_pk_mul_f32 v[244:245], v[244:245], v[14:15] op_sel:[0,1] op_sel_hi:[1,1]
	v_pk_mul_f32 v[246:247], v[246:247], v[14:15] op_sel:[0,1] op_sel_hi:[1,1]
	v_cvt_pk_bf16_f32 v240, v240, v241
	v_cvt_pk_bf16_f32 v241, v242, v243
	v_cvt_pk_bf16_f32 v242, v244, v245
	v_cvt_pk_bf16_f32 v243, v246, v247
	buffer_store_dwordx4 v[240:243], v2, s[20:23], s55 offen offset:2048 sc1
	v_pk_mul_f32 v[248:249], v[248:249], v[14:15] op_sel:[0,1] op_sel_hi:[1,1]
	v_pk_mul_f32 v[250:251], v[250:251], v[14:15] op_sel:[0,1] op_sel_hi:[1,1]
	v_pk_mul_f32 v[252:253], v[252:253], v[14:15] op_sel:[0,1] op_sel_hi:[1,1]
	v_pk_mul_f32 v[254:255], v[254:255], v[14:15] op_sel:[0,1] op_sel_hi:[1,1]
	v_cvt_pk_bf16_f32 v248, v248, v249
	v_cvt_pk_bf16_f32 v249, v250, v251
	v_cvt_pk_bf16_f32 v250, v252, v253
	v_cvt_pk_bf16_f32 v251, v254, v255
	buffer_store_dwordx4 v[248:251], v2, s[20:23], s55 offen offset:3072 sc1
L_ep_done:
	s_add_u32 m0, s62, 32768
	s_add_u32 s50, s8, 0
	buffer_load_dwordx4 v5, s[24:27], s50 offen lds
	s_add_u32 m0, s62, 33792
	s_add_u32 s50, s8, 9216
	buffer_load_dwordx4 v5, s[24:27], s50 offen lds
	s_add_u32 m0, s62, 34816
	s_add_u32 s50, s8, 18432
	buffer_load_dwordx4 v5, s[24:27], s50 offen lds
	s_add_u32 m0, s62, 35840
	s_add_u32 s50, s8, 27648
	buffer_load_dwordx4 v5, s[24:27], s50 offen lds
	s_add_u32 m0, s62, 36864
	s_add_u32 s50, s8, 36864
	buffer_load_dwordx4 v5, s[24:27], s50 offen lds
	s_add_u32 m0, s62, 37888
	s_add_u32 s50, s8, 46080
	buffer_load_dwordx4 v5, s[24:27], s50 offen lds
	s_add_u32 m0, s62, 38912
	s_add_u32 s50, s8, 55296
	buffer_load_dwordx4 v5, s[24:27], s50 offen lds
	s_add_u32 m0, s62, 39936
	s_add_u32 s50, s8, 64512
	buffer_load_dwordx4 v5, s[24:27], s50 offen lds
	ds_read_b64_tr_b16 v[186:187], v6 offset:6656
	ds_read_b64_tr_b16 v[188:189], v7 offset:4608
	ds_read_b64_tr_b16 v[190:191], v7 offset:6656
	s_waitcnt vmcnt(42)
	ds_read_b64_tr_b16 a[0:1], v0 offset:0
	ds_read_b64_tr_b16 a[2:3], v0 offset:2048
	ds_read_b64_tr_b16 a[4:5], v1 offset:0
	ds_read_b64_tr_b16 a[6:7], v1 offset:2048
	ds_read_b64_tr_b16 a[8:9], v0 offset:512
	s_waitcnt vmcnt(8)
	s_barrier
	s_cmp_lg_u32 s40, 0
	s_cbranch_scc1 L_nosig
	s_lshl_b32 s71, s43, 5
	v_mov_b32 v14, 0
	v_mov_b32 v15, 1
	s_mov_b64 exec, 1
	buffer_atomic_add v15, v14, s[32:35], s71 offen
	s_mov_b64 exec, -1
L_nosig:
	s_cmp_ge_u32 s60, 7
	s_cbranch_scc1 L_fin
	ds_read_b64_tr_b16 a[10:11], v0 offset:2560
	ds_read_b64_tr_b16 a[12:13], v1 offset:512
	ds_read_b64_tr_b16 a[14:15], v1 offset:2560
	ds_read_b64_tr_b16 a[16:17], v0 offset:4096
	ds_read_b64_tr_b16 a[18:19], v0 offset:6144
	ds_read_b64_tr_b16 a[20:21], v1 offset:4096
	ds_read_b64_tr_b16 a[22:23], v1 offset:6144
	ds_read_b64_tr_b16 a[24:25], v0 offset:4608
	ds_read_b64_tr_b16 a[26:27], v0 offset:6656
	ds_read_b64_tr_b16 a[28:29], v1 offset:4608
	ds_read_b64_tr_b16 a[30:31], v1 offset:6656
	s_add_u32 m0, s62, 131072
	s_add_u32 s50, s9, 0
	s_waitcnt lgkmcnt(15)
	buffer_load_dwordx4 v5, s[24:27], s50 offen lds
	s_add_u32 m0, s62, 132096
	s_add_u32 s50, s9, 9216
	buffer_load_dwordx4 v5, s[24:27], s50 offen lds
	s_add_u32 m0, s62, 133120
	s_add_u32 s50, s9, 18432
	buffer_load_dwordx4 v5, s[24:27], s50 offen lds
	s_add_u32 m0, s62, 134144
	s_add_u32 s50, s9, 27648
	buffer_load_dwordx4 v5, s[24:27], s50 offen lds
	s_add_u32 m0, s62, 135168
	s_add_u32 s50, s9, 36864
	buffer_load_dwordx4 v5, s[24:27], s50 offen lds
	s_add_u32 m0, s62, 136192
	s_add_u32 s50, s9, 46080
	buffer_load_dwordx4 v5, s[24:27], s50 offen lds
	s_add_u32 m0, s62, 137216
	s_add_u32 s50, s9, 55296
	buffer_load_dwordx4 v5, s[24:27], s50 offen lds
	s_add_u32 m0, s62, 138240
	s_add_u32 s50, s9, 64512
	buffer_load_dwordx4 v5, s[24:27], s50 offen lds
	s_add_u32 m0, s62, 65536
	s_add_u32 s50, s9, 73728
	s_waitcnt lgkmcnt(8)
	buffer_load_dwordx4 v5, s[24:27], s50 offen lds
	s_add_u32 m0, s62, 66560
	s_add_u32 s50, s9, 82944
	buffer_load_dwordx4 v5, s[24:27], s50 offen lds
	s_add_u32 m0, s62, 67584
	s_add_u32 s50, s9, 92160
	buffer_load_dwordx4 v5, s[24:27], s50 offen lds
	s_add_u32 m0, s62, 68608
	s_add_u32 s50, s9, 101376
	buffer_load_dwordx4 v5, s[24:27], s50 offen lds
	s_add_u32 m0, s62, 69632
	s_add_u32 s50, s9, 110592
	s_waitcnt lgkmcnt(0)
	buffer_load_dwordx4 v5, s[24:27], s50 offen lds
	s_add_u32 m0, s62, 70656
	s_add_u32 s50, s9, 119808
	buffer_load_dwordx4 v5, s[24:27], s50 offen lds
	s_add_u32 m0, s62, 71680
	s_add_u32 s50, s9, 129024
	buffer_load_dwordx4 v5, s[24:27], s50 offen lds
	s_add_u32 m0, s62, 72704
	s_add_u32 s50, s9, 138240
	buffer_load_dwordx4 v5, s[24:27], s50 offen lds
	ds_read_b64_tr_b16 a[32:33], v21 offset:0
	ds_read_b64_tr_b16 a[34:35], v21 offset:2048
	ds_read_b64_tr_b16 a[36:37], v23 offset:0
	ds_read_b64_tr_b16 a[38:39], v23 offset:2048
	ds_read_b64_tr_b16 a[40:41], v21 offset:512
	ds_read_b64_tr_b16 a[42:43], v21 offset:2560
	ds_read_b64_tr_b16 a[44:45], v23 offset:512
	ds_read_b64_tr_b16 a[46:47], v23 offset:2560
	ds_read_b64_tr_b16 a[48:49], v21 offset:4096
	ds_read_b64_tr_b16 a[50:51], v21 offset:6144
	ds_read_b64_tr_b16 a[52:53], v23 offset:4096
	ds_read_b64_tr_b16 a[54:55], v23 offset:6144
	ds_read_b64_tr_b16 a[56:57], v21 offset:4608
	ds_read_b64_tr_b16 a[58:59], v21 offset:6656
	ds_read_b64_tr_b16 a[60:61], v23 offset:4608
	ds_read_b64_tr_b16 a[62:63], v23 offset:6656
	s_add_u32 m0, s62, 0
	s_add_u32 s50, s10, 0
	s_waitcnt lgkmcnt(8)
	buffer_load_dwordx4 v5, s[24:27], s50 offen lds
	s_add_u32 m0, s62, 1024
	s_add_u32 s50, s10, 9216
	buffer_load_dwordx4 v5, s[24:27], s50 offen lds
	s_add_u32 m0, s62, 2048
	s_add_u32 s50, s10, 18432
	buffer_load_dwordx4 v5, s[24:27], s50 offen lds
	s_add_u32 m0, s62, 3072
	s_add_u32 s50, s10, 27648
	buffer_load_dwordx4 v5, s[24:27], s50 offen lds
	s_add_u32 m0, s62, 4096
	s_add_u32 s50, s10, 36864
	s_waitcnt lgkmcnt(0)
	buffer_load_dwordx4 v5, s[24:27], s50 offen lds
	s_add_u32 m0, s62, 5120
	s_add_u32 s50, s10, 46080
	buffer_load_dwordx4 v5, s[24:27], s50 offen lds
	s_add_u32 m0, s62, 6144
	s_add_u32 s50, s10, 55296
	buffer_load_dwordx4 v5, s[24:27], s50 offen lds
	s_add_u32 m0, s62, 7168
	s_add_u32 s50, s10, 64512
	buffer_load_dwordx4 v5, s[24:27], s50 offen lds
	ds_read_b64_tr_b16 a[96:97], v0 offset:32768
	ds_read_b64_tr_b16 a[98:99], v0 offset:34816
	ds_read_b64_tr_b16 a[100:101], v1 offset:32768
	ds_read_b64_tr_b16 a[102:103], v1 offset:34816
	ds_read_b64_tr_b16 a[104:105], v0 offset:33280
	ds_read_b64_tr_b16 a[106:107], v0 offset:35328
	ds_read_b64_tr_b16 a[108:109], v1 offset:33280
	ds_read_b64_tr_b16 a[110:111], v1 offset:35328
	ds_read_b64_tr_b16 a[112:113], v0 offset:36864
	ds_read_b64_tr_b16 a[114:115], v0 offset:38912
	ds_read_b64_tr_b16 a[116:117], v1 offset:36864
	ds_read_b64_tr_b16 a[118:119], v1 offset:38912
	ds_read_b64_tr_b16 a[120:121], v0 offset:37376
	ds_read_b64_tr_b16 a[122:123], v0 offset:39424
	ds_read_b64_tr_b16 a[124:125], v1 offset:37376
	ds_read_b64_tr_b16 a[126:127], v1 offset:39424
	s_add_u32 m0, s62, 98304
	s_add_u32 s50, s11, 0
	s_waitcnt lgkmcnt(8)
	buffer_load_dwordx4 v5, s[24:27], s50 offen lds
	s_add_u32 m0, s62, 99328
	s_add_u32 s50, s11, 9216
	buffer_load_dwordx4 v5, s[24:27], s50 offen lds
	s_add_u32 m0, s62, 100352
	s_add_u32 s50, s11, 18432
	buffer_load_dwordx4 v5, s[24:27], s50 offen lds
	s_add_u32 m0, s62, 101376
	s_add_u32 s50, s11, 27648
	buffer_load_dwordx4 v5, s[24:27], s50 offen lds
	s_waitcnt vmcnt(32)
	ds_read_b64_tr_b16 a[64:65], v21 offset:32768
	ds_read_b64_tr_b16 a[66:67], v21 offset:34816
	ds_read_b64_tr_b16 a[68:69], v23 offset:32768
	ds_read_b64_tr_b16 a[70:71], v23 offset:34816
	ds_read_b64_tr_b16 a[72:73], v21 offset:33280
	ds_read_b64_tr_b16 a[74:75], v21 offset:35328
	ds_read_b64_tr_b16 a[76:77], v23 offset:33280
	ds_read_b64_tr_b16 a[78:79], v23 offset:35328
	s_add_u32 m0, s62, 102400
	s_add_u32 s50, s11, 36864
	s_waitcnt lgkmcnt(8)
	buffer_load_dwordx4 v5, s[24:27], s50 offen lds
	s_add_u32 m0, s62, 103424
	s_add_u32 s50, s11, 46080
	buffer_load_dwordx4 v5, s[24:27], s50 offen lds
	s_add_u32 m0, s62, 104448
	s_add_u32 s50, s11, 55296
	buffer_load_dwordx4 v5, s[24:27], s50 offen lds
	s_add_u32 m0, s62, 105472
	s_add_u32 s50, s11, 64512
	buffer_load_dwordx4 v5, s[24:27], s50 offen lds
	s_waitcnt vmcnt(32)
	ds_read_b64_tr_b16 a[80:81], v21 offset:36864
	ds_read_b64_tr_b16 a[82:83], v21 offset:38912
	ds_read_b64_tr_b16 a[84:85], v23 offset:36864
	ds_read_b64_tr_b16 a[86:87], v23 offset:38912
	ds_read_b64_tr_b16 a[88:89], v21 offset:37376
	ds_read_b64_tr_b16 a[90:91], v21 offset:39424
	ds_read_b64_tr_b16 a[92:93], v23 offset:37376
	ds_read_b64_tr_b16 a[94:95], v23 offset:39424
	s_add_u32 m0, s62, 32768
	s_add_u32 s50, s10, 73728
	s_waitcnt lgkmcnt(8)
	buffer_load_dwordx4 v5, s[24:27], s50 offen lds
	s_add_u32 m0, s62, 33792
	s_add_u32 s50, s10, 82944
	buffer_load_dwordx4 v5, s[24:27], s50 offen lds
	s_add_u32 m0, s62, 34816
	s_add_u32 s50, s10, 92160
	buffer_load_dwordx4 v5, s[24:27], s50 offen lds
	s_add_u32 m0, s62, 35840
	s_add_u32 s50, s10, 101376
	buffer_load_dwordx4 v5, s[24:27], s50 offen lds
	s_waitcnt vmcnt(32)
	ds_read_b64_tr_b16 v[28:29], v6 offset:0
	ds_read_b64_tr_b16 v[30:31], v6 offset:2048
	ds_read_b64_tr_b16 v[32:33], v7 offset:0
	ds_read_b64_tr_b16 v[34:35], v7 offset:2048
	ds_read_b64_tr_b16 v[36:37], v6 offset:512
	ds_read_b64_tr_b16 v[38:39], v6 offset:2560
	ds_read_b64_tr_b16 v[40:41], v7 offset:512
	ds_read_b64_tr_b16 v[42:43], v7 offset:2560
	s_add_u32 m0, s62, 36864
	s_add_u32 s50, s10, 110592
	s_waitcnt lgkmcnt(8)
	buffer_load_dwordx4 v5, s[24:27], s50 offen lds
	s_add_u32 m0, s62, 37888
	s_add_u32 s50, s10, 119808
	buffer_load_dwordx4 v5, s[24:27], s50 offen lds
	s_add_u32 m0, s62, 38912
	s_add_u32 s50, s10, 129024
	buffer_load_dwordx4 v5, s[24:27], s50 offen lds
	s_add_u32 m0, s62, 39936
	s_add_u32 s50, s10, 138240
	buffer_load_dwordx4 v5, s[24:27], s50 offen lds
	s_waitcnt vmcnt(32)
	ds_read_b64_tr_b16 v[44:45], v6 offset:4096
	ds_read_b64_tr_b16 v[46:47], v6 offset:6144
	ds_read_b64_tr_b16 v[48:49], v7 offset:4096
	ds_read_b64_tr_b16 v[50:51], v7 offset:6144
	ds_read_b64_tr_b16 v[52:53], v6 offset:4608
	ds_read_b64_tr_b16 v[54:55], v6 offset:6656
	ds_read_b64_tr_b16 v[56:57], v7 offset:4608
	ds_read_b64_tr_b16 v[58:59], v7 offset:6656
	s_add_u32 m0, s62, 131072
	s_add_u32 s50, s11, 73728
	s_waitcnt lgkmcnt(8)
	buffer_load_dwordx4 v5, s[24:27], s50 offen lds
	s_add_u32 m0, s62, 132096
	s_add_u32 s50, s11, 82944
	buffer_load_dwordx4 v5, s[24:27], s50 offen lds
	s_add_u32 m0, s62, 133120
	s_add_u32 s50, s11, 92160
	buffer_load_dwordx4 v5, s[24:27], s50 offen lds
	s_add_u32 m0, s62, 134144
	s_add_u32 s50, s11, 101376
	buffer_load_dwordx4 v5, s[24:27], s50 offen lds
	s_add_u32 m0, s62, 135168
	s_add_u32 s50, s11, 110592
	s_waitcnt lgkmcnt(0)
	buffer_load_dwordx4 v5, s[24:27], s50 offen lds
	s_add_u32 m0, s62, 136192
	s_add_u32 s50, s11, 119808
	buffer_load_dwordx4 v5, s[24:27], s50 offen lds
	s_add_u32 m0, s62, 137216
	s_add_u32 s50, s11, 129024
	buffer_load_dwordx4 v5, s[24:27], s50 offen lds
	s_add_u32 m0, s62, 138240
	s_add_u32 s50, s11, 138240
	buffer_load_dwordx4 v5, s[24:27], s50 offen lds
	v_add_u32 v8, 0, v2
	v_add_u32 v9, 4096, v2
	v_add_u32 v10, 8192, v2
	v_add_u32 v11, 12288, v2
	v_add_u32 v24, 16384, v2
	v_add_u32 v25, 20480, v2
	v_add_u32 v26, 24576, v2
	v_add_u32 v27, 28672, v2
	s_cmp_lg_u32 s40, 0
	s_cbranch_scc1 L_go
	s_cmp_eq_u32 s60, 3
	s_cselect_b32 s70, 32, 0
	v_lshlrev_b32 v14, 1, v2
	v_and_b32 v14, s70, v14
	s_mov_b32 s73, 200000
	s_lshl_b32 s74, s51, 5
L_poll:
	buffer_load_dword v15, v14, s[32:35], s74 offen sc1
	s_sub_u32 s73, s73, 1
	s_waitcnt vmcnt(0)
	v_cmp_gt_u32 vcc, 32, v15
	s_cmp_eq_u32 s73, 0
	s_cbranch_scc1 L_go
	s_cbranch_vccz L_go
	s_sleep 4
	s_branch L_poll
L_go:
	s_barrier
	buffer_load_dwordx4 v[192:195], v8, s[20:23], s66 offen sc1
	buffer_load_dwordx4 v[196:199], v8, s[20:23], s67 offen sc1
	buffer_load_dwordx4 v[200:203], v8, s[20:23], s68 offen sc1
	buffer_load_dwordx4 v[204:207], v8, s[20:23], s69 offen sc1
	buffer_load_dwordx4 v[208:211], v8, s[20:23], s66 offen offset:1024 sc1
	buffer_load_dwordx4 v[212:215], v8, s[20:23], s67 offen offset:1024 sc1
	buffer_load_dwordx4 v[216:219], v8, s[20:23], s68 offen offset:1024 sc1
	buffer_load_dwordx4 v[220:223], v8, s[20:23], s69 offen offset:1024 sc1
	buffer_load_dwordx4 v[224:227], v8, s[20:23], s66 offen offset:2048 sc1
	buffer_load_dwordx4 v[228:231], v8, s[20:23], s67 offen offset:2048 sc1
	buffer_load_dwordx4 v[232:235], v8, s[20:23], s68 offen offset:2048 sc1
	buffer_load_dwordx4 v[236:239], v8, s[20:23], s69 offen offset:2048 sc1
	s_waitcnt vmcnt(11)
	v_mfma_f32_16x16x32_bf16 v[64:67], a[128:131], v[192:195], 0
	buffer_load_dwordx4 v[240:243], v8, s[20:23], s66 offen offset:3072 sc1
	v_mfma_f32_16x16x32_bf16 v[68:71], a[132:135], v[192:195], 0
	buffer_load_dwordx4 v[244:247], v8, s[20:23], s67 offen offset:3072 sc1
	v_mfma_f32_16x16x32_bf16 v[72:75], a[136:139], v[192:195], 0
	buffer_load_dwordx4 v[248:251], v8, s[20:23], s68 offen offset:3072 sc1
	v_mfma_f32_16x16x32_bf16 v[76:79], a[140:143], v[192:195], 0
	s_waitcnt vmcnt(13)
	buffer_load_dwordx4 v[252:255], v8, s[20:23], s69 offen offset:3072 sc1
	v_mfma_f32_16x16x32_bf16 v[80:83], a[128:131], v[196:199], 0
	v_mfma_f32_16x16x32_bf16 v[84:87], a[132:135], v[196:199], 0
	v_mfma_f32_16x16x32_bf16 v[88:91], a[136:139], v[196:199], 0
	v_mfma_f32_16x16x32_bf16 v[92:95], a[140:143], v[196:199], 0
	s_waitcnt vmcnt(13)
	v_mfma_f32_16x16x32_bf16 v[96:99], a[128:131], v[200:203], 0
	v_mfma_f32_16x16x32_bf16 v[100:103], a[132:135], v[200:203], 0
	v_mfma_f32_16x16x32_bf16 v[104:107], a[136:139], v[200:203], 0
	v_mfma_f32_16x16x32_bf16 v[108:111], a[140:143], v[200:203], 0
	s_waitcnt vmcnt(12)
	v_mfma_f32_16x16x32_bf16 v[112:115], a[128:131], v[204:207], 0
	v_mfma_f32_16x16x32_bf16 v[116:119], a[132:135], v[204:207], 0
	v_mfma_f32_16x16x32_bf16 v[120:123], a[136:139], v[204:207], 0
	v_mfma_f32_16x16x32_bf16 v[124:127], a[140:143], v[204:207], 0
	s_waitcnt vmcnt(11)
	v_mfma_f32_16x16x32_bf16 v[64:67], a[144:147], v[208:211], v[64:67]
	buffer_load_dwordx4 v[192:195], v9, s[20:23], s66 offen sc1
	v_mfma_f32_16x16x32_bf16 v[68:71], a[148:151], v[208:211], v[68:71]
	buffer_load_dwordx4 v[196:199], v9, s[20:23], s67 offen sc1
	v_mfma_f32_16x16x32_bf16 v[72:75], a[152:155], v[208:211], v[72:75]
	buffer_load_dwordx4 v[200:203], v9, s[20:23], s68 offen sc1
	v_mfma_f32_16x16x32_bf16 v[76:79], a[156:159], v[208:211], v[76:79]
	s_waitcnt vmcnt(13)
	buffer_load_dwordx4 v[204:207], v9, s[20:23], s69 offen sc1
	v_mfma_f32_16x16x32_bf16 v[80:83], a[144:147], v[212:215], v[80:83]
	v_mfma_f32_16x16x32_bf16 v[84:87], a[148:151], v[212:215], v[84:87]
	v_mfma_f32_16x16x32_bf16 v[88:91], a[152:155], v[212:215], v[88:91]
	v_mfma_f32_16x16x32_bf16 v[92:95], a[156:159], v[212:215], v[92:95]
	s_waitcnt vmcnt(13)
	v_mfma_f32_16x16x32_bf16 v[96:99], a[144:147], v[216:219], v[96:99]
	v_mfma_f32_16x16x32_bf16 v[100:103], a[148:151], v[216:219], v[100:103]
	v_mfma_f32_16x16x32_bf16 v[104:107], a[152:155], v[216:219], v[104:107]
	v_mfma_f32_16x16x32_bf16 v[108:111], a[156:159], v[216:219], v[108:111]
	s_waitcnt vmcnt(12)
	v_mfma_f32_16x16x32_bf16 v[112:115], a[144:147], v[220:223], v[112:115]
	v_mfma_f32_16x16x32_bf16 v[116:119], a[148:151], v[220:223], v[116:119]
	v_mfma_f32_16x16x32_bf16 v[120:123], a[152:155], v[220:223], v[120:123]
	v_mfma_f32_16x16x32_bf16 v[124:127], a[156:159], v[220:223], v[124:127]
	s_waitcnt vmcnt(11)
	v_mfma_f32_16x16x32_bf16 v[64:67], a[160:163], v[224:227], v[64:67]
	buffer_load_dwordx4 v[208:211], v9, s[20:23], s66 offen offset:1024 sc1
	v_mfma_f32_16x16x32_bf16 v[68:71], a[164:167], v[224:227], v[68:71]
	buffer_load_dwordx4 v[212:215], v9, s[20:23], s67 offen offset:1024 sc1
	v_mfma_f32_16x16x32_bf16 v[72:75], a[168:171], v[224:227], v[72:75]
	buffer_load_dwordx4 v[216:219], v9, s[20:23], s68 offen offset:1024 sc1
	v_mfma_f32_16x16x32_bf16 v[76:79], a[172:175], v[224:227], v[76:79]
	s_waitcnt vmcnt(13)
	buffer_load_dwordx4 v[220:223], v9, s[20:23], s69 offen offset:1024 sc1
	v_mfma_f32_16x16x32_bf16 v[80:83], a[160:163], v[228:231], v[80:83]
	v_mfma_f32_16x16x32_bf16 v[84:87], a[164:167], v[228:231], v[84:87]
	v_mfma_f32_16x16x32_bf16 v[88:91], a[168:171], v[228:231], v[88:91]
	v_mfma_f32_16x16x32_bf16 v[92:95], a[172:175], v[228:231], v[92:95]
	s_waitcnt vmcnt(13)
	v_mfma_f32_16x16x32_bf16 v[96:99], a[160:163], v[232:235], v[96:99]
	v_mfma_f32_16x16x32_bf16 v[100:103], a[164:167], v[232:235], v[100:103]
	v_mfma_f32_16x16x32_bf16 v[104:107], a[168:171], v[232:235], v[104:107]
	v_mfma_f32_16x16x32_bf16 v[108:111], a[172:175], v[232:235], v[108:111]
	s_waitcnt vmcnt(12)
	v_mfma_f32_16x16x32_bf16 v[112:115], a[160:163], v[236:239], v[112:115]
	v_mfma_f32_16x16x32_bf16 v[116:119], a[164:167], v[236:239], v[116:119]
	v_mfma_f32_16x16x32_bf16 v[120:123], a[168:171], v[236:239], v[120:123]
	v_mfma_f32_16x16x32_bf16 v[124:127], a[172:175], v[236:239], v[124:127]
	s_waitcnt vmcnt(11)
	v_mfma_f32_16x16x32_bf16 v[64:67], a[176:179], v[240:243], v[64:67]
	buffer_load_dwordx4 v[224:227], v9, s[20:23], s66 offen offset:2048 sc1
	v_mfma_f32_16x16x32_bf16 v[68:71], a[180:183], v[240:243], v[68:71]
	buffer_load_dwordx4 v[228:231], v9, s[20:23], s67 offen offset:2048 sc1
	v_mfma_f32_16x16x32_bf16 v[72:75], a[184:187], v[240:243], v[72:75]
	buffer_load_dwordx4 v[232:235], v9, s[20:23], s68 offen offset:2048 sc1
	v_mfma_f32_16x16x32_bf16 v[76:79], a[188:191], v[240:243], v[76:79]
	s_waitcnt vmcnt(13)
	buffer_load_dwordx4 v[236:239], v9, s[20:23], s69 offen offset:2048 sc1
	v_mfma_f32_16x16x32_bf16 v[80:83], a[176:179], v[244:247], v[80:83]
	ds_read_b64_tr_b16 a[128:129], v0 offset:0
	v_mfma_f32_16x16x32_bf16 v[84:87], a[180:183], v[244:247], v[84:87]
	ds_read_b64_tr_b16 a[130:131], v0 offset:2048
	v_mfma_f32_16x16x32_bf16 v[88:91], a[184:187], v[244:247], v[88:91]
	ds_read_b64_tr_b16 a[132:133], v1 offset:0
	v_mfma_f32_16x16x32_bf16 v[92:95], a[188:191], v[244:247], v[92:95]
	s_waitcnt vmcnt(13)
	ds_read_b64_tr_b16 a[134:135], v1 offset:2048
	v_mfma_f32_16x16x32_bf16 v[96:99], a[176:179], v[248:251], v[96:99]
	ds_read_b64_tr_b16 a[136:137], v0 offset:512
	v_mfma_f32_16x16x32_bf16 v[100:103], a[180:183], v[248:251], v[100:103]
	ds_read_b64_tr_b16 a[138:139], v0 offset:2560
	v_mfma_f32_16x16x32_bf16 v[104:107], a[184:187], v[248:251], v[104:107]
	ds_read_b64_tr_b16 a[140:141], v1 offset:512
	v_mfma_f32_16x16x32_bf16 v[108:111], a[188:191], v[248:251], v[108:111]
	s_waitcnt vmcnt(12)
	ds_read_b64_tr_b16 a[142:143], v1 offset:2560
	v_mfma_f32_16x16x32_bf16 v[112:115], a[176:179], v[252:255], v[112:115]
	v_mfma_f32_16x16x32_bf16 v[116:119], a[180:183], v[252:255], v[116:119]
	v_mfma_f32_16x16x32_bf16 v[120:123], a[184:187], v[252:255], v[120:123]
	v_mfma_f32_16x16x32_bf16 v[124:127], a[188:191], v[252:255], v[124:127]
	s_waitcnt vmcnt(11)
	v_mfma_f32_16x16x32_bf16 v[64:67], a[192:195], v[192:195], v[64:67]
	buffer_load_dwordx4 v[240:243], v9, s[20:23], s66 offen offset:3072 sc1
	v_mfma_f32_16x16x32_bf16 v[68:71], a[196:199], v[192:195], v[68:71]
	buffer_load_dwordx4 v[244:247], v9, s[20:23], s67 offen offset:3072 sc1
	v_mfma_f32_16x16x32_bf16 v[72:75], a[200:203], v[192:195], v[72:75]
	buffer_load_dwordx4 v[248:251], v9, s[20:23], s68 offen offset:3072 sc1
	v_mfma_f32_16x16x32_bf16 v[76:79], a[204:207], v[192:195], v[76:79]
	s_waitcnt vmcnt(13)
	buffer_load_dwordx4 v[252:255], v9, s[20:23], s69 offen offset:3072 sc1
	v_mfma_f32_16x16x32_bf16 v[80:83], a[192:195], v[196:199], v[80:83]
	ds_read_b64_tr_b16 a[144:145], v0 offset:4096
	v_mfma_f32_16x16x32_bf16 v[84:87], a[196:199], v[196:199], v[84:87]
	ds_read_b64_tr_b16 a[146:147], v0 offset:6144
	v_mfma_f32_16x16x32_bf16 v[88:91], a[200:203], v[196:199], v[88:91]
	ds_read_b64_tr_b16 a[148:149], v1 offset:4096
	v_mfma_f32_16x16x32_bf16 v[92:95], a[204:207], v[196:199], v[92:95]
	s_waitcnt vmcnt(13)
	ds_read_b64_tr_b16 a[150:151], v1 offset:6144
	v_mfma_f32_16x16x32_bf16 v[96:99], a[192:195], v[200:203], v[96:99]
	ds_read_b64_tr_b16 a[152:153], v0 offset:4608
	v_mfma_f32_16x16x32_bf16 v[100:103], a[196:199], v[200:203], v[100:103]
	ds_read_b64_tr_b16 a[154:155], v0 offset:6656
	v_mfma_f32_16x16x32_bf16 v[104:107], a[200:203], v[200:203], v[104:107]
	ds_read_b64_tr_b16 a[156:157], v1 offset:4608
	v_mfma_f32_16x16x32_bf16 v[108:111], a[204:207], v[200:203], v[108:111]
	s_waitcnt vmcnt(12)
	ds_read_b64_tr_b16 a[158:159], v1 offset:6656
	v_mfma_f32_16x16x32_bf16 v[112:115], a[192:195], v[204:207], v[112:115]
	v_mfma_f32_16x16x32_bf16 v[116:119], a[196:199], v[204:207], v[116:119]
	v_mfma_f32_16x16x32_bf16 v[120:123], a[200:203], v[204:207], v[120:123]
	v_mfma_f32_16x16x32_bf16 v[124:127], a[204:207], v[204:207], v[124:127]
	s_waitcnt vmcnt(11)
	v_mfma_f32_16x16x32_bf16 v[64:67], a[208:211], v[208:211], v[64:67]
	buffer_load_dwordx4 v[192:195], v10, s[20:23], s66 offen sc1
	v_mfma_f32_16x16x32_bf16 v[68:71], a[212:215], v[208:211], v[68:71]
	buffer_load_dwordx4 v[196:199], v10, s[20:23], s67 offen sc1
	v_mfma_f32_16x16x32_bf16 v[72:75], a[216:219], v[208:211], v[72:75]
	buffer_load_dwordx4 v[200:203], v10, s[20:23], s68 offen sc1
	v_mfma_f32_16x16x32_bf16 v[76:79], a[220:223], v[208:211], v[76:79]
	s_waitcnt vmcnt(13)
	buffer_load_dwordx4 v[204:207], v10, s[20:23], s69 offen sc1
	v_mfma_f32_16x16x32_bf16 v[80:83], a[208:211], v[212:215], v[80:83]
	ds_read_b64_tr_b16 a[160:161], v21 offset:0
	v_mfma_f32_16x16x32_bf16 v[84:87], a[212:215], v[212:215], v[84:87]
	ds_read_b64_tr_b16 a[162:163], v21 offset:2048
	v_mfma_f32_16x16x32_bf16 v[88:91], a[216:219], v[212:215], v[88:91]
	ds_read_b64_tr_b16 a[164:165], v23 offset:0
	v_mfma_f32_16x16x32_bf16 v[92:95], a[220:223], v[212:215], v[92:95]
	s_waitcnt vmcnt(13)
	ds_read_b64_tr_b16 a[166:167], v23 offset:2048
	v_mfma_f32_16x16x32_bf16 v[96:99], a[208:211], v[216:219], v[96:99]
	ds_read_b64_tr_b16 a[168:169], v21 offset:512
	v_mfma_f32_16x16x32_bf16 v[100:103], a[212:215], v[216:219], v[100:103]
	ds_read_b64_tr_b16 a[170:171], v21 offset:2560
	v_mfma_f32_16x16x32_bf16 v[104:107], a[216:219], v[216:219], v[104:107]
	ds_read_b64_tr_b16 a[172:173], v23 offset:512
	v_mfma_f32_16x16x32_bf16 v[108:111], a[220:223], v[216:219], v[108:111]
	s_waitcnt vmcnt(12)
	ds_read_b64_tr_b16 a[174:175], v23 offset:2560
	v_mfma_f32_16x16x32_bf16 v[112:115], a[208:211], v[220:223], v[112:115]
	v_mfma_f32_16x16x32_bf16 v[116:119], a[212:215], v[220:223], v[116:119]
	v_mfma_f32_16x16x32_bf16 v[120:123], a[216:219], v[220:223], v[120:123]
	v_mfma_f32_16x16x32_bf16 v[124:127], a[220:223], v[220:223], v[124:127]
	s_waitcnt vmcnt(11)
	v_mfma_f32_16x16x32_bf16 v[64:67], a[224:227], v[224:227], v[64:67]
	buffer_load_dwordx4 v[208:211], v10, s[20:23], s66 offen offset:1024 sc1
	v_mfma_f32_16x16x32_bf16 v[68:71], a[228:231], v[224:227], v[68:71]
	buffer_load_dwordx4 v[212:215], v10, s[20:23], s67 offen offset:1024 sc1
	v_mfma_f32_16x16x32_bf16 v[72:75], a[232:235], v[224:227], v[72:75]
	buffer_load_dwordx4 v[216:219], v10, s[20:23], s68 offen offset:1024 sc1
	v_mfma_f32_16x16x32_bf16 v[76:79], a[236:239], v[224:227], v[76:79]
	s_waitcnt vmcnt(13)
	buffer_load_dwordx4 v[220:223], v10, s[20:23], s69 offen offset:1024 sc1
	v_mfma_f32_16x16x32_bf16 v[80:83], a[224:227], v[228:231], v[80:83]
	ds_read_b64_tr_b16 a[176:177], v21 offset:4096
	v_mfma_f32_16x16x32_bf16 v[84:87], a[228:231], v[228:231], v[84:87]
	ds_read_b64_tr_b16 a[178:179], v21 offset:6144
	v_mfma_f32_16x16x32_bf16 v[88:91], a[232:235], v[228:231], v[88:91]
	ds_read_b64_tr_b16 a[180:181], v23 offset:4096
	v_mfma_f32_16x16x32_bf16 v[92:95], a[236:239], v[228:231], v[92:95]
	s_waitcnt vmcnt(13)
	ds_read_b64_tr_b16 a[182:183], v23 offset:6144
	v_mfma_f32_16x16x32_bf16 v[96:99], a[224:227], v[232:235], v[96:99]
	ds_read_b64_tr_b16 a[184:185], v21 offset:4608
	v_mfma_f32_16x16x32_bf16 v[100:103], a[228:231], v[232:235], v[100:103]
	ds_read_b64_tr_b16 a[186:187], v21 offset:6656
	v_mfma_f32_16x16x32_bf16 v[104:107], a[232:235], v[232:235], v[104:107]
	ds_read_b64_tr_b16 a[188:189], v23 offset:4608
	v_mfma_f32_16x16x32_bf16 v[108:111], a[236:239], v[232:235], v[108:111]
	s_waitcnt vmcnt(12)
	ds_read_b64_tr_b16 a[190:191], v23 offset:6656
	v_mfma_f32_16x16x32_bf16 v[112:115], a[224:227], v[236:239], v[112:115]
	v_mfma_f32_16x16x32_bf16 v[116:119], a[228:231], v[236:239], v[116:119]
	v_mfma_f32_16x16x32_bf16 v[120:123], a[232:235], v[236:239], v[120:123]
	v_mfma_f32_16x16x32_bf16 v[124:127], a[236:239], v[236:239], v[124:127]
	s_waitcnt vmcnt(11)
	v_mfma_f32_16x16x32_bf16 v[64:67], a[240:243], v[240:243], v[64:67]
	buffer_load_dwordx4 v[224:227], v10, s[20:23], s66 offen offset:2048 sc1
	v_mfma_f32_16x16x32_bf16 v[68:71], a[244:247], v[240:243], v[68:71]
	buffer_load_dwordx4 v[228:231], v10, s[20:23], s67 offen offset:2048 sc1
	v_mfma_f32_16x16x32_bf16 v[72:75], a[248:251], v[240:243], v[72:75]
	buffer_load_dwordx4 v[232:235], v10, s[20:23], s68 offen offset:2048 sc1
	v_mfma_f32_16x16x32_bf16 v[76:79], a[252:255], v[240:243], v[76:79]
	s_waitcnt vmcnt(13)
	buffer_load_dwordx4 v[236:239], v10, s[20:23], s69 offen offset:2048 sc1
	v_mfma_f32_16x16x32_bf16 v[80:83], a[240:243], v[244:247], v[80:83]
	ds_read_b64_tr_b16 a[192:193], v21 offset:32768
	v_mfma_f32_16x16x32_bf16 v[84:87], a[244:247], v[244:247], v[84:87]
	ds_read_b64_tr_b16 a[194:195], v21 offset:34816
	v_mfma_f32_16x16x32_bf16 v[88:91], a[248:251], v[244:247], v[88:91]
	ds_read_b64_tr_b16 a[196:197], v23 offset:32768
	v_mfma_f32_16x16x32_bf16 v[92:95], a[252:255], v[244:247], v[92:95]
	s_waitcnt vmcnt(13)
	ds_read_b64_tr_b16 a[198:199], v23 offset:34816
	v_mfma_f32_16x16x32_bf16 v[96:99], a[240:243], v[248:251], v[96:99]
	ds_read_b64_tr_b16 a[200:201], v21 offset:33280
	v_mfma_f32_16x16x32_bf16 v[100:103], a[244:247], v[248:251], v[100:103]
	ds_read_b64_tr_b16 a[202:203], v21 offset:35328
	v_mfma_f32_16x16x32_bf16 v[104:107], a[248:251], v[248:251], v[104:107]
	ds_read_b64_tr_b16 a[204:205], v23 offset:33280
	v_mfma_f32_16x16x32_bf16 v[108:111], a[252:255], v[248:251], v[108:111]
	s_waitcnt vmcnt(12)
	ds_read_b64_tr_b16 a[206:207], v23 offset:35328
	v_mfma_f32_16x16x32_bf16 v[112:115], a[240:243], v[252:255], v[112:115]
	v_mfma_f32_16x16x32_bf16 v[116:119], a[244:247], v[252:255], v[116:119]
	v_mfma_f32_16x16x32_bf16 v[120:123], a[248:251], v[252:255], v[120:123]
	v_mfma_f32_16x16x32_bf16 v[124:127], a[252:255], v[252:255], v[124:127]
	s_waitcnt vmcnt(11)
	v_mfma_f32_16x16x32_bf16 v[64:67], v[128:131], v[192:195], v[64:67]
	buffer_load_dwordx4 v[240:243], v10, s[20:23], s66 offen offset:3072 sc1
	v_mfma_f32_16x16x32_bf16 v[68:71], v[132:135], v[192:195], v[68:71]
	buffer_load_dwordx4 v[244:247], v10, s[20:23], s67 offen offset:3072 sc1
	v_mfma_f32_16x16x32_bf16 v[72:75], v[136:139], v[192:195], v[72:75]
	buffer_load_dwordx4 v[248:251], v10, s[20:23], s68 offen offset:3072 sc1
	v_mfma_f32_16x16x32_bf16 v[76:79], v[140:143], v[192:195], v[76:79]
	s_waitcnt vmcnt(13)
	buffer_load_dwordx4 v[252:255], v10, s[20:23], s69 offen offset:3072 sc1
	v_mfma_f32_16x16x32_bf16 v[80:83], v[128:131], v[196:199], v[80:83]
	ds_read_b64_tr_b16 a[208:209], v21 offset:36864
	v_mfma_f32_16x16x32_bf16 v[84:87], v[132:135], v[196:199], v[84:87]
	ds_read_b64_tr_b16 a[210:211], v21 offset:38912
	v_mfma_f32_16x16x32_bf16 v[88:91], v[136:139], v[196:199], v[88:91]
	ds_read_b64_tr_b16 a[212:213], v23 offset:36864
	v_mfma_f32_16x16x32_bf16 v[92:95], v[140:143], v[196:199], v[92:95]
	s_waitcnt vmcnt(13)
	ds_read_b64_tr_b16 a[214:215], v23 offset:38912
	v_mfma_f32_16x16x32_bf16 v[96:99], v[128:131], v[200:203], v[96:99]
	ds_read_b64_tr_b16 a[216:217], v21 offset:37376
	v_mfma_f32_16x16x32_bf16 v[100:103], v[132:135], v[200:203], v[100:103]
	ds_read_b64_tr_b16 a[218:219], v21 offset:39424
	v_mfma_f32_16x16x32_bf16 v[104:107], v[136:139], v[200:203], v[104:107]
	ds_read_b64_tr_b16 a[220:221], v23 offset:37376
	v_mfma_f32_16x16x32_bf16 v[108:111], v[140:143], v[200:203], v[108:111]
	s_waitcnt vmcnt(12)
	ds_read_b64_tr_b16 a[222:223], v23 offset:39424
	v_mfma_f32_16x16x32_bf16 v[112:115], v[128:131], v[204:207], v[112:115]
	v_mfma_f32_16x16x32_bf16 v[116:119], v[132:135], v[204:207], v[116:119]
	v_mfma_f32_16x16x32_bf16 v[120:123], v[136:139], v[204:207], v[120:123]
	v_mfma_f32_16x16x32_bf16 v[124:127], v[140:143], v[204:207], v[124:127]
	s_waitcnt vmcnt(11)
	v_mfma_f32_16x16x32_bf16 v[64:67], v[144:147], v[208:211], v[64:67]
	buffer_load_dwordx4 v[192:195], v11, s[20:23], s66 offen sc1
	v_mfma_f32_16x16x32_bf16 v[68:71], v[148:151], v[208:211], v[68:71]
	buffer_load_dwordx4 v[196:199], v11, s[20:23], s67 offen sc1
	v_mfma_f32_16x16x32_bf16 v[72:75], v[152:155], v[208:211], v[72:75]
	buffer_load_dwordx4 v[200:203], v11, s[20:23], s68 offen sc1
	v_mfma_f32_16x16x32_bf16 v[76:79], v[156:159], v[208:211], v[76:79]
	s_waitcnt vmcnt(13)
	buffer_load_dwordx4 v[204:207], v11, s[20:23], s69 offen sc1
	v_mfma_f32_16x16x32_bf16 v[80:83], v[144:147], v[212:215], v[80:83]
	ds_read_b64_tr_b16 a[224:225], v0 offset:32768
	v_mfma_f32_16x16x32_bf16 v[84:87], v[148:151], v[212:215], v[84:87]
	ds_read_b64_tr_b16 a[226:227], v0 offset:34816
	v_mfma_f32_16x16x32_bf16 v[88:91], v[152:155], v[212:215], v[88:91]
	ds_read_b64_tr_b16 a[228:229], v1 offset:32768
	v_mfma_f32_16x16x32_bf16 v[92:95], v[156:159], v[212:215], v[92:95]
	s_waitcnt vmcnt(13)
	ds_read_b64_tr_b16 a[230:231], v1 offset:34816
	v_mfma_f32_16x16x32_bf16 v[96:99], v[144:147], v[216:219], v[96:99]
	ds_read_b64_tr_b16 a[232:233], v0 offset:33280
	v_mfma_f32_16x16x32_bf16 v[100:103], v[148:151], v[216:219], v[100:103]
	ds_read_b64_tr_b16 a[234:235], v0 offset:35328
	v_mfma_f32_16x16x32_bf16 v[104:107], v[152:155], v[216:219], v[104:107]
	ds_read_b64_tr_b16 a[236:237], v1 offset:33280
	v_mfma_f32_16x16x32_bf16 v[108:111], v[156:159], v[216:219], v[108:111]
	s_waitcnt vmcnt(12)
	ds_read_b64_tr_b16 a[238:239], v1 offset:35328
	v_mfma_f32_16x16x32_bf16 v[112:115], v[144:147], v[220:223], v[112:115]
	v_mfma_f32_16x16x32_bf16 v[116:119], v[148:151], v[220:223], v[116:119]
	v_mfma_f32_16x16x32_bf16 v[120:123], v[152:155], v[220:223], v[120:123]
	v_mfma_f32_16x16x32_bf16 v[124:127], v[156:159], v[220:223], v[124:127]
	s_waitcnt vmcnt(11)
	v_mfma_f32_16x16x32_bf16 v[64:67], v[160:163], v[224:227], v[64:67]
	buffer_load_dwordx4 v[208:211], v11, s[20:23], s66 offen offset:1024 sc1
	v_mfma_f32_16x16x32_bf16 v[68:71], v[164:167], v[224:227], v[68:71]
	buffer_load_dwordx4 v[212:215], v11, s[20:23], s67 offen offset:1024 sc1
	v_mfma_f32_16x16x32_bf16 v[72:75], v[168:171], v[224:227], v[72:75]
	buffer_load_dwordx4 v[216:219], v11, s[20:23], s68 offen offset:1024 sc1
	v_mfma_f32_16x16x32_bf16 v[76:79], v[172:175], v[224:227], v[76:79]
	s_waitcnt vmcnt(13)
	buffer_load_dwordx4 v[220:223], v11, s[20:23], s69 offen offset:1024 sc1
	v_mfma_f32_16x16x32_bf16 v[80:83], v[160:163], v[228:231], v[80:83]
	ds_read_b64_tr_b16 a[240:241], v0 offset:36864
	v_mfma_f32_16x16x32_bf16 v[84:87], v[164:167], v[228:231], v[84:87]
	ds_read_b64_tr_b16 a[242:243], v0 offset:38912
	v_mfma_f32_16x16x32_bf16 v[88:91], v[168:171], v[228:231], v[88:91]
	ds_read_b64_tr_b16 a[244:245], v1 offset:36864
	v_mfma_f32_16x16x32_bf16 v[92:95], v[172:175], v[228:231], v[92:95]
	s_waitcnt vmcnt(13)
	ds_read_b64_tr_b16 a[246:247], v1 offset:38912
	v_mfma_f32_16x16x32_bf16 v[96:99], v[160:163], v[232:235], v[96:99]
	ds_read_b64_tr_b16 a[248:249], v0 offset:37376
	v_mfma_f32_16x16x32_bf16 v[100:103], v[164:167], v[232:235], v[100:103]
	ds_read_b64_tr_b16 a[250:251], v0 offset:39424
	v_mfma_f32_16x16x32_bf16 v[104:107], v[168:171], v[232:235], v[104:107]
	ds_read_b64_tr_b16 a[252:253], v1 offset:37376
	v_mfma_f32_16x16x32_bf16 v[108:111], v[172:175], v[232:235], v[108:111]
	s_waitcnt vmcnt(12)
	ds_read_b64_tr_b16 a[254:255], v1 offset:39424
	v_mfma_f32_16x16x32_bf16 v[112:115], v[160:163], v[236:239], v[112:115]
	v_mfma_f32_16x16x32_bf16 v[116:119], v[164:167], v[236:239], v[116:119]
	v_mfma_f32_16x16x32_bf16 v[120:123], v[168:171], v[236:239], v[120:123]
	v_mfma_f32_16x16x32_bf16 v[124:127], v[172:175], v[236:239], v[124:127]
	s_waitcnt vmcnt(11)
	v_mfma_f32_16x16x32_bf16 v[64:67], v[176:179], v[240:243], v[64:67]
	buffer_load_dwordx4 v[224:227], v11, s[20:23], s66 offen offset:2048 sc1
	v_mfma_f32_16x16x32_bf16 v[68:71], v[180:183], v[240:243], v[68:71]
	buffer_load_dwordx4 v[228:231], v11, s[20:23], s67 offen offset:2048 sc1
	v_mfma_f32_16x16x32_bf16 v[72:75], v[184:187], v[240:243], v[72:75]
	buffer_load_dwordx4 v[232:235], v11, s[20:23], s68 offen offset:2048 sc1
	v_mfma_f32_16x16x32_bf16 v[76:79], v[188:191], v[240:243], v[76:79]
	s_waitcnt vmcnt(13)
	buffer_load_dwordx4 v[236:239], v11, s[20:23], s69 offen offset:2048 sc1
	v_mfma_f32_16x16x32_bf16 v[80:83], v[176:179], v[244:247], v[80:83]
	ds_read_b64_tr_b16 v[128:129], v6 offset:0
	v_mfma_f32_16x16x32_bf16 v[84:87], v[180:183], v[244:247], v[84:87]
	ds_read_b64_tr_b16 v[130:131], v6 offset:2048
	v_mfma_f32_16x16x32_bf16 v[88:91], v[184:187], v[244:247], v[88:91]
	ds_read_b64_tr_b16 v[132:133], v7 offset:0
	v_mfma_f32_16x16x32_bf16 v[92:95], v[188:191], v[244:247], v[92:95]
	s_waitcnt vmcnt(13)
	ds_read_b64_tr_b16 v[134:135], v7 offset:2048
	v_mfma_f32_16x16x32_bf16 v[96:99], v[176:179], v[248:251], v[96:99]
	ds_read_b64_tr_b16 v[136:137], v6 offset:512
	v_mfma_f32_16x16x32_bf16 v[100:103], v[180:183], v[248:251], v[100:103]
	ds_read_b64_tr_b16 v[138:139], v6 offset:2560
	v_mfma_f32_16x16x32_bf16 v[104:107], v[184:187], v[248:251], v[104:107]
	ds_read_b64_tr_b16 v[140:141], v7 offset:512
	v_mfma_f32_16x16x32_bf16 v[108:111], v[188:191], v[248:251], v[108:111]
	s_waitcnt vmcnt(12)
	ds_read_b64_tr_b16 v[142:143], v7 offset:2560
	v_mfma_f32_16x16x32_bf16 v[112:115], v[176:179], v[252:255], v[112:115]
	v_mfma_f32_16x16x32_bf16 v[116:119], v[180:183], v[252:255], v[116:119]
	v_mfma_f32_16x16x32_bf16 v[120:123], v[184:187], v[252:255], v[120:123]
	v_mfma_f32_16x16x32_bf16 v[124:127], v[188:191], v[252:255], v[124:127]
	s_waitcnt vmcnt(11)
	v_mfma_f32_16x16x32_bf16 v[64:67], a[0:3], v[192:195], v[64:67]
	buffer_load_dwordx4 v[240:243], v11, s[20:23], s66 offen offset:3072 sc1
	v_mfma_f32_16x16x32_bf16 v[68:71], a[4:7], v[192:195], v[68:71]
	buffer_load_dwordx4 v[244:247], v11, s[20:23], s67 offen offset:3072 sc1
	v_mfma_f32_16x16x32_bf16 v[72:75], a[8:11], v[192:195], v[72:75]
	buffer_load_dwordx4 v[248:251], v11, s[20:23], s68 offen offset:3072 sc1
	v_mfma_f32_16x16x32_bf16 v[76:79], a[12:15], v[192:195], v[76:79]
	s_waitcnt vmcnt(13)
	buffer_load_dwordx4 v[252:255], v11, s[20:23], s69 offen offset:3072 sc1
	v_mfma_f32_16x16x32_bf16 v[80:83], a[0:3], v[196:199], v[80:83]
	ds_read_b64_tr_b16 v[144:145], v6 offset:4096
	v_mfma_f32_16x16x32_bf16 v[84:87], a[4:7], v[196:199], v[84:87]
	ds_read_b64_tr_b16 v[146:147], v6 offset:6144
	v_mfma_f32_16x16x32_bf16 v[88:91], a[8:11], v[196:199], v[88:91]
	ds_read_b64_tr_b16 v[148:149], v7 offset:4096
	v_mfma_f32_16x16x32_bf16 v[92:95], a[12:15], v[196:199], v[92:95]
	s_waitcnt vmcnt(13)
	ds_read_b64_tr_b16 v[150:151], v7 offset:6144
	v_mfma_f32_16x16x32_bf16 v[96:99], a[0:3], v[200:203], v[96:99]
	ds_read_b64_tr_b16 v[152:153], v6 offset:4608
	v_mfma_f32_16x16x32_bf16 v[100:103], a[4:7], v[200:203], v[100:103]
	ds_read_b64_tr_b16 v[154:155], v6 offset:6656
	v_mfma_f32_16x16x32_bf16 v[104:107], a[8:11], v[200:203], v[104:107]
	ds_read_b64_tr_b16 v[156:157], v7 offset:4608
	v_mfma_f32_16x16x32_bf16 v[108:111], a[12:15], v[200:203], v[108:111]
	s_waitcnt vmcnt(12)
	ds_read_b64_tr_b16 v[158:159], v7 offset:6656
	v_mfma_f32_16x16x32_bf16 v[112:115], a[0:3], v[204:207], v[112:115]
	v_mfma_f32_16x16x32_bf16 v[116:119], a[4:7], v[204:207], v[116:119]
	v_mfma_f32_16x16x32_bf16 v[120:123], a[8:11], v[204:207], v[120:123]
	v_mfma_f32_16x16x32_bf16 v[124:127], a[12:15], v[204:207], v[124:127]
	s_waitcnt vmcnt(11)
	v_mfma_f32_16x16x32_bf16 v[64:67], a[16:19], v[208:211], v[64:67]
	buffer_load_dwordx4 v[192:195], v24, s[20:23], s66 offen sc1
	v_mfma_f32_16x16x32_bf16 v[68:71], a[20:23], v[208:211], v[68:71]
	buffer_load_dwordx4 v[196:199], v24, s[20:23], s67 offen sc1
	v_mfma_f32_16x16x32_bf16 v[72:75], a[24:27], v[208:211], v[72:75]
	buffer_load_dwordx4 v[200:203], v24, s[20:23], s68 offen sc1
	v_mfma_f32_16x16x32_bf16 v[76:79], a[28:31], v[208:211], v[76:79]
	s_waitcnt vmcnt(13)
	buffer_load_dwordx4 v[204:207], v24, s[20:23], s69 offen sc1
	v_mfma_f32_16x16x32_bf16 v[80:83], a[16:19], v[212:215], v[80:83]
	v_mfma_f32_16x16x32_bf16 v[84:87], a[20:23], v[212:215], v[84:87]
	v_mfma_f32_16x16x32_bf16 v[88:91], a[24:27], v[212:215], v[88:91]
	v_mfma_f32_16x16x32_bf16 v[92:95], a[28:31], v[212:215], v[92:95]
	s_waitcnt vmcnt(13)
	v_mfma_f32_16x16x32_bf16 v[96:99], a[16:19], v[216:219], v[96:99]
	v_mfma_f32_16x16x32_bf16 v[100:103], a[20:23], v[216:219], v[100:103]
	v_mfma_f32_16x16x32_bf16 v[104:107], a[24:27], v[216:219], v[104:107]
	v_mfma_f32_16x16x32_bf16 v[108:111], a[28:31], v[216:219], v[108:111]
	s_waitcnt vmcnt(12)
	v_mfma_f32_16x16x32_bf16 v[112:115], a[16:19], v[220:223], v[112:115]
	v_mfma_f32_16x16x32_bf16 v[116:119], a[20:23], v[220:223], v[116:119]
	v_mfma_f32_16x16x32_bf16 v[120:123], a[24:27], v[220:223], v[120:123]
	v_mfma_f32_16x16x32_bf16 v[124:127], a[28:31], v[220:223], v[124:127]
	s_waitcnt vmcnt(11)
	v_mfma_f32_16x16x32_bf16 v[64:67], a[32:35], v[224:227], v[64:67]
	buffer_load_dwordx4 v[208:211], v24, s[20:23], s66 offen offset:1024 sc1
	v_mfma_f32_16x16x32_bf16 v[68:71], a[36:39], v[224:227], v[68:71]
	buffer_load_dwordx4 v[212:215], v24, s[20:23], s67 offen offset:1024 sc1
	v_mfma_f32_16x16x32_bf16 v[72:75], a[40:43], v[224:227], v[72:75]
	buffer_load_dwordx4 v[216:219], v24, s[20:23], s68 offen offset:1024 sc1
	v_mfma_f32_16x16x32_bf16 v[76:79], a[44:47], v[224:227], v[76:79]
	s_waitcnt vmcnt(13)
	buffer_load_dwordx4 v[220:223], v24, s[20:23], s69 offen offset:1024 sc1
	v_mfma_f32_16x16x32_bf16 v[80:83], a[32:35], v[228:231], v[80:83]
	v_mfma_f32_16x16x32_bf16 v[84:87], a[36:39], v[228:231], v[84:87]
	v_mfma_f32_16x16x32_bf16 v[88:91], a[40:43], v[228:231], v[88:91]
	v_mfma_f32_16x16x32_bf16 v[92:95], a[44:47], v[228:231], v[92:95]
	s_waitcnt vmcnt(13)
	v_mfma_f32_16x16x32_bf16 v[96:99], a[32:35], v[232:235], v[96:99]
	v_mfma_f32_16x16x32_bf16 v[100:103], a[36:39], v[232:235], v[100:103]
	v_mfma_f32_16x16x32_bf16 v[104:107], a[40:43], v[232:235], v[104:107]
	v_mfma_f32_16x16x32_bf16 v[108:111], a[44:47], v[232:235], v[108:111]
	s_waitcnt vmcnt(12)
	v_mfma_f32_16x16x32_bf16 v[112:115], a[32:35], v[236:239], v[112:115]
	v_mfma_f32_16x16x32_bf16 v[116:119], a[36:39], v[236:239], v[116:119]
	v_mfma_f32_16x16x32_bf16 v[120:123], a[40:43], v[236:239], v[120:123]
	v_mfma_f32_16x16x32_bf16 v[124:127], a[44:47], v[236:239], v[124:127]
	s_waitcnt vmcnt(11)
	v_mfma_f32_16x16x32_bf16 v[64:67], a[48:51], v[240:243], v[64:67]
	buffer_load_dwordx4 v[224:227], v24, s[20:23], s66 offen offset:2048 sc1
	v_mfma_f32_16x16x32_bf16 v[68:71], a[52:55], v[240:243], v[68:71]
	buffer_load_dwordx4 v[228:231], v24, s[20:23], s67 offen offset:2048 sc1
	v_mfma_f32_16x16x32_bf16 v[72:75], a[56:59], v[240:243], v[72:75]
	buffer_load_dwordx4 v[232:235], v24, s[20:23], s68 offen offset:2048 sc1
	v_mfma_f32_16x16x32_bf16 v[76:79], a[60:63], v[240:243], v[76:79]
	s_waitcnt vmcnt(13)
	buffer_load_dwordx4 v[236:239], v24, s[20:23], s69 offen offset:2048 sc1
	v_mfma_f32_16x16x32_bf16 v[80:83], a[48:51], v[244:247], v[80:83]
	v_mfma_f32_16x16x32_bf16 v[84:87], a[52:55], v[244:247], v[84:87]
	v_mfma_f32_16x16x32_bf16 v[88:91], a[56:59], v[244:247], v[88:91]
	v_mfma_f32_16x16x32_bf16 v[92:95], a[60:63], v[244:247], v[92:95]
	s_waitcnt vmcnt(13)
	v_mfma_f32_16x16x32_bf16 v[96:99], a[48:51], v[248:251], v[96:99]
	v_mfma_f32_16x16x32_bf16 v[100:103], a[52:55], v[248:251], v[100:103]
	v_mfma_f32_16x16x32_bf16 v[104:107], a[56:59], v[248:251], v[104:107]
	v_mfma_f32_16x16x32_bf16 v[108:111], a[60:63], v[248:251], v[108:111]
	s_waitcnt vmcnt(12)
	v_mfma_f32_16x16x32_bf16 v[112:115], a[48:51], v[252:255], v[112:115]
	v_mfma_f32_16x16x32_bf16 v[116:119], a[52:55], v[252:255], v[116:119]
	v_mfma_f32_16x16x32_bf16 v[120:123], a[56:59], v[252:255], v[120:123]
	v_mfma_f32_16x16x32_bf16 v[124:127], a[60:63], v[252:255], v[124:127]
	s_waitcnt vmcnt(11)
	v_mfma_f32_16x16x32_bf16 v[64:67], a[64:67], v[192:195], v[64:67]
	buffer_load_dwordx4 v[240:243], v24, s[20:23], s66 offen offset:3072 sc1
	v_mfma_f32_16x16x32_bf16 v[68:71], a[68:71], v[192:195], v[68:71]
	buffer_load_dwordx4 v[244:247], v24, s[20:23], s67 offen offset:3072 sc1
	v_mfma_f32_16x16x32_bf16 v[72:75], a[72:75], v[192:195], v[72:75]
	buffer_load_dwordx4 v[248:251], v24, s[20:23], s68 offen offset:3072 sc1
	v_mfma_f32_16x16x32_bf16 v[76:79], a[76:79], v[192:195], v[76:79]
	s_waitcnt vmcnt(13)
	buffer_load_dwordx4 v[252:255], v24, s[20:23], s69 offen offset:3072 sc1
	v_mfma_f32_16x16x32_bf16 v[80:83], a[64:67], v[196:199], v[80:83]
	v_mfma_f32_16x16x32_bf16 v[84:87], a[68:71], v[196:199], v[84:87]
	v_mfma_f32_16x16x32_bf16 v[88:91], a[72:75], v[196:199], v[88:91]
	v_mfma_f32_16x16x32_bf16 v[92:95], a[76:79], v[196:199], v[92:95]
	s_waitcnt vmcnt(13)
	v_mfma_f32_16x16x32_bf16 v[96:99], a[64:67], v[200:203], v[96:99]
	v_mfma_f32_16x16x32_bf16 v[100:103], a[68:71], v[200:203], v[100:103]
	v_mfma_f32_16x16x32_bf16 v[104:107], a[72:75], v[200:203], v[104:107]
	v_mfma_f32_16x16x32_bf16 v[108:111], a[76:79], v[200:203], v[108:111]
	s_waitcnt vmcnt(12)
	v_mfma_f32_16x16x32_bf16 v[112:115], a[64:67], v[204:207], v[112:115]
	v_mfma_f32_16x16x32_bf16 v[116:119], a[68:71], v[204:207], v[116:119]
	v_mfma_f32_16x16x32_bf16 v[120:123], a[72:75], v[204:207], v[120:123]
	v_mfma_f32_16x16x32_bf16 v[124:127], a[76:79], v[204:207], v[124:127]
	s_waitcnt vmcnt(11)
	v_mfma_f32_16x16x32_bf16 v[64:67], a[80:83], v[208:211], v[64:67]
	buffer_load_dwordx4 v[192:195], v25, s[20:23], s66 offen sc1
	v_mfma_f32_16x16x32_bf16 v[68:71], a[84:87], v[208:211], v[68:71]
	buffer_load_dwordx4 v[196:199], v25, s[20:23], s67 offen sc1
	v_mfma_f32_16x16x32_bf16 v[72:75], a[88:91], v[208:211], v[72:75]
	buffer_load_dwordx4 v[200:203], v25, s[20:23], s68 offen sc1
	v_mfma_f32_16x16x32_bf16 v[76:79], a[92:95], v[208:211], v[76:79]
	s_waitcnt vmcnt(13)
	buffer_load_dwordx4 v[204:207], v25, s[20:23], s69 offen sc1
	v_mfma_f32_16x16x32_bf16 v[80:83], a[80:83], v[212:215], v[80:83]
	v_mfma_f32_16x16x32_bf16 v[84:87], a[84:87], v[212:215], v[84:87]
	v_mfma_f32_16x16x32_bf16 v[88:91], a[88:91], v[212:215], v[88:91]
	v_mfma_f32_16x16x32_bf16 v[92:95], a[92:95], v[212:215], v[92:95]
	s_waitcnt vmcnt(13)
	v_mfma_f32_16x16x32_bf16 v[96:99], a[80:83], v[216:219], v[96:99]
	v_mfma_f32_16x16x32_bf16 v[100:103], a[84:87], v[216:219], v[100:103]
	v_mfma_f32_16x16x32_bf16 v[104:107], a[88:91], v[216:219], v[104:107]
	v_mfma_f32_16x16x32_bf16 v[108:111], a[92:95], v[216:219], v[108:111]
	s_waitcnt vmcnt(12)
	v_mfma_f32_16x16x32_bf16 v[112:115], a[80:83], v[220:223], v[112:115]
	v_mfma_f32_16x16x32_bf16 v[116:119], a[84:87], v[220:223], v[116:119]
	v_mfma_f32_16x16x32_bf16 v[120:123], a[88:91], v[220:223], v[120:123]
	v_mfma_f32_16x16x32_bf16 v[124:127], a[92:95], v[220:223], v[124:127]
	s_waitcnt vmcnt(11)
	v_mfma_f32_16x16x32_bf16 v[64:67], a[96:99], v[224:227], v[64:67]
	buffer_load_dwordx4 v[208:211], v25, s[20:23], s66 offen offset:1024 sc1
	v_mfma_f32_16x16x32_bf16 v[68:71], a[100:103], v[224:227], v[68:71]
	buffer_load_dwordx4 v[212:215], v25, s[20:23], s67 offen offset:1024 sc1
	v_mfma_f32_16x16x32_bf16 v[72:75], a[104:107], v[224:227], v[72:75]
	buffer_load_dwordx4 v[216:219], v25, s[20:23], s68 offen offset:1024 sc1
	v_mfma_f32_16x16x32_bf16 v[76:79], a[108:111], v[224:227], v[76:79]
	s_waitcnt vmcnt(13)
	buffer_load_dwordx4 v[220:223], v25, s[20:23], s69 offen offset:1024 sc1
	v_mfma_f32_16x16x32_bf16 v[80:83], a[96:99], v[228:231], v[80:83]
	v_mfma_f32_16x16x32_bf16 v[84:87], a[100:103], v[228:231], v[84:87]
	v_mfma_f32_16x16x32_bf16 v[88:91], a[104:107], v[228:231], v[88:91]
	v_mfma_f32_16x16x32_bf16 v[92:95], a[108:111], v[228:231], v[92:95]
	s_waitcnt vmcnt(13)
	v_mfma_f32_16x16x32_bf16 v[96:99], a[96:99], v[232:235], v[96:99]
	v_mfma_f32_16x16x32_bf16 v[100:103], a[100:103], v[232:235], v[100:103]
	v_mfma_f32_16x16x32_bf16 v[104:107], a[104:107], v[232:235], v[104:107]
	v_mfma_f32_16x16x32_bf16 v[108:111], a[108:111], v[232:235], v[108:111]
	s_waitcnt vmcnt(12)
	v_mfma_f32_16x16x32_bf16 v[112:115], a[96:99], v[236:239], v[112:115]
	v_mfma_f32_16x16x32_bf16 v[116:119], a[100:103], v[236:239], v[116:119]
	v_mfma_f32_16x16x32_bf16 v[120:123], a[104:107], v[236:239], v[120:123]
	v_mfma_f32_16x16x32_bf16 v[124:127], a[108:111], v[236:239], v[124:127]
	s_waitcnt vmcnt(11)
	v_mfma_f32_16x16x32_bf16 v[64:67], a[112:115], v[240:243], v[64:67]
	buffer_load_dwordx4 v[224:227], v25, s[20:23], s66 offen offset:2048 sc1
	v_mfma_f32_16x16x32_bf16 v[68:71], a[116:119], v[240:243], v[68:71]
	buffer_load_dwordx4 v[228:231], v25, s[20:23], s67 offen offset:2048 sc1
	v_mfma_f32_16x16x32_bf16 v[72:75], a[120:123], v[240:243], v[72:75]
	buffer_load_dwordx4 v[232:235], v25, s[20:23], s68 offen offset:2048 sc1
	v_mfma_f32_16x16x32_bf16 v[76:79], a[124:127], v[240:243], v[76:79]
	s_waitcnt vmcnt(13)
	buffer_load_dwordx4 v[236:239], v25, s[20:23], s69 offen offset:2048 sc1
	v_mfma_f32_16x16x32_bf16 v[80:83], a[112:115], v[244:247], v[80:83]
	v_mfma_f32_16x16x32_bf16 v[84:87], a[116:119], v[244:247], v[84:87]
	v_mfma_f32_16x16x32_bf16 v[88:91], a[120:123], v[244:247], v[88:91]
	v_mfma_f32_16x16x32_bf16 v[92:95], a[124:127], v[244:247], v[92:95]
	s_waitcnt vmcnt(13)
	v_mfma_f32_16x16x32_bf16 v[96:99], a[112:115], v[248:251], v[96:99]
	v_mfma_f32_16x16x32_bf16 v[100:103], a[116:119], v[248:251], v[100:103]
	v_mfma_f32_16x16x32_bf16 v[104:107], a[120:123], v[248:251], v[104:107]
	v_mfma_f32_16x16x32_bf16 v[108:111], a[124:127], v[248:251], v[108:111]
	s_waitcnt vmcnt(12)
	v_mfma_f32_16x16x32_bf16 v[112:115], a[112:115], v[252:255], v[112:115]
	v_mfma_f32_16x16x32_bf16 v[116:119], a[116:119], v[252:255], v[116:119]
	v_mfma_f32_16x16x32_bf16 v[120:123], a[120:123], v[252:255], v[120:123]
	v_mfma_f32_16x16x32_bf16 v[124:127], a[124:127], v[252:255], v[124:127]
	s_waitcnt vmcnt(11)
	v_mfma_f32_16x16x32_bf16 v[64:67], v[28:31], v[192:195], v[64:67]
	buffer_load_dwordx4 v[240:243], v25, s[20:23], s66 offen offset:3072 sc1
	v_mfma_f32_16x16x32_bf16 v[68:71], v[32:35], v[192:195], v[68:71]
	buffer_load_dwordx4 v[244:247], v25, s[20:23], s67 offen offset:3072 sc1
	v_mfma_f32_16x16x32_bf16 v[72:75], v[36:39], v[192:195], v[72:75]
	buffer_load_dwordx4 v[248:251], v25, s[20:23], s68 offen offset:3072 sc1
	v_mfma_f32_16x16x32_bf16 v[76:79], v[40:43], v[192:195], v[76:79]
	s_waitcnt vmcnt(13)
	buffer_load_dwordx4 v[252:255], v25, s[20:23], s69 offen offset:3072 sc1
	v_mfma_f32_16x16x32_bf16 v[80:83], v[28:31], v[196:199], v[80:83]
	v_mfma_f32_16x16x32_bf16 v[84:87], v[32:35], v[196:199], v[84:87]
	v_mfma_f32_16x16x32_bf16 v[88:91], v[36:39], v[196:199], v[88:91]
	v_mfma_f32_16x16x32_bf16 v[92:95], v[40:43], v[196:199], v[92:95]
	s_waitcnt vmcnt(13)
	v_mfma_f32_16x16x32_bf16 v[96:99], v[28:31], v[200:203], v[96:99]
	v_mfma_f32_16x16x32_bf16 v[100:103], v[32:35], v[200:203], v[100:103]
	v_mfma_f32_16x16x32_bf16 v[104:107], v[36:39], v[200:203], v[104:107]
	v_mfma_f32_16x16x32_bf16 v[108:111], v[40:43], v[200:203], v[108:111]
	s_waitcnt vmcnt(12)
	v_mfma_f32_16x16x32_bf16 v[112:115], v[28:31], v[204:207], v[112:115]
	v_mfma_f32_16x16x32_bf16 v[116:119], v[32:35], v[204:207], v[116:119]
	v_mfma_f32_16x16x32_bf16 v[120:123], v[36:39], v[204:207], v[120:123]
	v_mfma_f32_16x16x32_bf16 v[124:127], v[40:43], v[204:207], v[124:127]
	s_waitcnt vmcnt(11)
	v_mfma_f32_16x16x32_bf16 v[64:67], v[44:47], v[208:211], v[64:67]
	buffer_load_dwordx4 v[192:195], v26, s[20:23], s66 offen sc1
	v_mfma_f32_16x16x32_bf16 v[68:71], v[48:51], v[208:211], v[68:71]
	buffer_load_dwordx4 v[196:199], v26, s[20:23], s67 offen sc1
	v_mfma_f32_16x16x32_bf16 v[72:75], v[52:55], v[208:211], v[72:75]
	buffer_load_dwordx4 v[200:203], v26, s[20:23], s68 offen sc1
	v_mfma_f32_16x16x32_bf16 v[76:79], v[56:59], v[208:211], v[76:79]
	s_waitcnt vmcnt(13)
	buffer_load_dwordx4 v[204:207], v26, s[20:23], s69 offen sc1
	v_mfma_f32_16x16x32_bf16 v[80:83], v[44:47], v[212:215], v[80:83]
	v_mfma_f32_16x16x32_bf16 v[84:87], v[48:51], v[212:215], v[84:87]
	v_mfma_f32_16x16x32_bf16 v[88:91], v[52:55], v[212:215], v[88:91]
	v_mfma_f32_16x16x32_bf16 v[92:95], v[56:59], v[212:215], v[92:95]
	s_waitcnt vmcnt(13)
	v_mfma_f32_16x16x32_bf16 v[96:99], v[44:47], v[216:219], v[96:99]
	v_mfma_f32_16x16x32_bf16 v[100:103], v[48:51], v[216:219], v[100:103]
	v_mfma_f32_16x16x32_bf16 v[104:107], v[52:55], v[216:219], v[104:107]
	v_mfma_f32_16x16x32_bf16 v[108:111], v[56:59], v[216:219], v[108:111]
	s_waitcnt vmcnt(12)
	v_mfma_f32_16x16x32_bf16 v[112:115], v[44:47], v[220:223], v[112:115]
	v_mfma_f32_16x16x32_bf16 v[116:119], v[48:51], v[220:223], v[116:119]
	v_mfma_f32_16x16x32_bf16 v[120:123], v[52:55], v[220:223], v[120:123]
	v_mfma_f32_16x16x32_bf16 v[124:127], v[56:59], v[220:223], v[124:127]
	s_waitcnt vmcnt(11) lgkmcnt(15)
	v_mfma_f32_16x16x32_bf16 v[64:67], a[128:131], v[224:227], v[64:67]
	buffer_load_dwordx4 v[208:211], v26, s[20:23], s66 offen offset:1024 sc1
	v_mfma_f32_16x16x32_bf16 v[68:71], a[132:135], v[224:227], v[68:71]
	buffer_load_dwordx4 v[212:215], v26, s[20:23], s67 offen offset:1024 sc1
	v_mfma_f32_16x16x32_bf16 v[72:75], a[136:139], v[224:227], v[72:75]
	buffer_load_dwordx4 v[216:219], v26, s[20:23], s68 offen offset:1024 sc1
	v_mfma_f32_16x16x32_bf16 v[76:79], a[140:143], v[224:227], v[76:79]
	s_waitcnt vmcnt(13)
	buffer_load_dwordx4 v[220:223], v26, s[20:23], s69 offen offset:1024 sc1
	v_mfma_f32_16x16x32_bf16 v[80:83], a[128:131], v[228:231], v[80:83]
	v_mfma_f32_16x16x32_bf16 v[84:87], a[132:135], v[228:231], v[84:87]
	v_mfma_f32_16x16x32_bf16 v[88:91], a[136:139], v[228:231], v[88:91]
	v_mfma_f32_16x16x32_bf16 v[92:95], a[140:143], v[228:231], v[92:95]
	s_waitcnt vmcnt(13)
	v_mfma_f32_16x16x32_bf16 v[96:99], a[128:131], v[232:235], v[96:99]
	v_mfma_f32_16x16x32_bf16 v[100:103], a[132:135], v[232:235], v[100:103]
	v_mfma_f32_16x16x32_bf16 v[104:107], a[136:139], v[232:235], v[104:107]
	v_mfma_f32_16x16x32_bf16 v[108:111], a[140:143], v[232:235], v[108:111]
	s_waitcnt vmcnt(12)
	v_mfma_f32_16x16x32_bf16 v[112:115], a[128:131], v[236:239], v[112:115]
	v_mfma_f32_16x16x32_bf16 v[116:119], a[132:135], v[236:239], v[116:119]
	v_mfma_f32_16x16x32_bf16 v[120:123], a[136:139], v[236:239], v[120:123]
	v_mfma_f32_16x16x32_bf16 v[124:127], a[140:143], v[236:239], v[124:127]
	s_waitcnt vmcnt(11)
	v_mfma_f32_16x16x32_bf16 v[64:67], a[144:147], v[240:243], v[64:67]
	buffer_load_dwordx4 v[224:227], v26, s[20:23], s66 offen offset:2048 sc1
	v_mfma_f32_16x16x32_bf16 v[68:71], a[148:151], v[240:243], v[68:71]
	buffer_load_dwordx4 v[228:231], v26, s[20:23], s67 offen offset:2048 sc1
	v_mfma_f32_16x16x32_bf16 v[72:75], a[152:155], v[240:243], v[72:75]
	buffer_load_dwordx4 v[232:235], v26, s[20:23], s68 offen offset:2048 sc1
	v_mfma_f32_16x16x32_bf16 v[76:79], a[156:159], v[240:243], v[76:79]
	s_waitcnt vmcnt(13)
	buffer_load_dwordx4 v[236:239], v26, s[20:23], s69 offen offset:2048 sc1
	v_mfma_f32_16x16x32_bf16 v[80:83], a[144:147], v[244:247], v[80:83]
	v_mfma_f32_16x16x32_bf16 v[84:87], a[148:151], v[244:247], v[84:87]
	v_mfma_f32_16x16x32_bf16 v[88:91], a[152:155], v[244:247], v[88:91]
	v_mfma_f32_16x16x32_bf16 v[92:95], a[156:159], v[244:247], v[92:95]
	s_waitcnt vmcnt(13)
	v_mfma_f32_16x16x32_bf16 v[96:99], a[144:147], v[248:251], v[96:99]
	v_mfma_f32_16x16x32_bf16 v[100:103], a[148:151], v[248:251], v[100:103]
	v_mfma_f32_16x16x32_bf16 v[104:107], a[152:155], v[248:251], v[104:107]
	v_mfma_f32_16x16x32_bf16 v[108:111], a[156:159], v[248:251], v[108:111]
	s_waitcnt vmcnt(12)
	v_mfma_f32_16x16x32_bf16 v[112:115], a[144:147], v[252:255], v[112:115]
	v_mfma_f32_16x16x32_bf16 v[116:119], a[148:151], v[252:255], v[116:119]
	v_mfma_f32_16x16x32_bf16 v[120:123], a[152:155], v[252:255], v[120:123]
	v_mfma_f32_16x16x32_bf16 v[124:127], a[156:159], v[252:255], v[124:127]
	s_waitcnt vmcnt(11)
	v_mfma_f32_16x16x32_bf16 v[64:67], a[160:163], v[192:195], v[64:67]
	buffer_load_dwordx4 v[240:243], v26, s[20:23], s66 offen offset:3072 sc1
	v_mfma_f32_16x16x32_bf16 v[68:71], a[164:167], v[192:195], v[68:71]
	buffer_load_dwordx4 v[244:247], v26, s[20:23], s67 offen offset:3072 sc1
	v_mfma_f32_16x16x32_bf16 v[72:75], a[168:171], v[192:195], v[72:75]
	buffer_load_dwordx4 v[248:251], v26, s[20:23], s68 offen offset:3072 sc1
	v_mfma_f32_16x16x32_bf16 v[76:79], a[172:175], v[192:195], v[76:79]
	s_waitcnt vmcnt(13)
	buffer_load_dwordx4 v[252:255], v26, s[20:23], s69 offen offset:3072 sc1
	v_mfma_f32_16x16x32_bf16 v[80:83], a[160:163], v[196:199], v[80:83]
	v_mfma_f32_16x16x32_bf16 v[84:87], a[164:167], v[196:199], v[84:87]
	v_mfma_f32_16x16x32_bf16 v[88:91], a[168:171], v[196:199], v[88:91]
	v_mfma_f32_16x16x32_bf16 v[92:95], a[172:175], v[196:199], v[92:95]
	s_waitcnt vmcnt(13)
	v_mfma_f32_16x16x32_bf16 v[96:99], a[160:163], v[200:203], v[96:99]
	v_mfma_f32_16x16x32_bf16 v[100:103], a[164:167], v[200:203], v[100:103]
	v_mfma_f32_16x16x32_bf16 v[104:107], a[168:171], v[200:203], v[104:107]
	v_mfma_f32_16x16x32_bf16 v[108:111], a[172:175], v[200:203], v[108:111]
	s_waitcnt vmcnt(12)
	v_mfma_f32_16x16x32_bf16 v[112:115], a[160:163], v[204:207], v[112:115]
	v_mfma_f32_16x16x32_bf16 v[116:119], a[164:167], v[204:207], v[116:119]
	v_mfma_f32_16x16x32_bf16 v[120:123], a[168:171], v[204:207], v[120:123]
	v_mfma_f32_16x16x32_bf16 v[124:127], a[172:175], v[204:207], v[124:127]
	s_waitcnt vmcnt(11)
	v_mfma_f32_16x16x32_bf16 v[64:67], a[176:179], v[208:211], v[64:67]
	buffer_load_dwordx4 v[192:195], v27, s[20:23], s66 offen sc1
	v_mfma_f32_16x16x32_bf16 v[68:71], a[180:183], v[208:211], v[68:71]
	buffer_load_dwordx4 v[196:199], v27, s[20:23], s67 offen sc1
	v_mfma_f32_16x16x32_bf16 v[72:75], a[184:187], v[208:211], v[72:75]
	buffer_load_dwordx4 v[200:203], v27, s[20:23], s68 offen sc1
	v_mfma_f32_16x16x32_bf16 v[76:79], a[188:191], v[208:211], v[76:79]
	s_waitcnt vmcnt(13)
	buffer_load_dwordx4 v[204:207], v27, s[20:23], s69 offen sc1
	v_mfma_f32_16x16x32_bf16 v[80:83], a[176:179], v[212:215], v[80:83]
	v_mfma_f32_16x16x32_bf16 v[84:87], a[180:183], v[212:215], v[84:87]
	v_mfma_f32_16x16x32_bf16 v[88:91], a[184:187], v[212:215], v[88:91]
	v_mfma_f32_16x16x32_bf16 v[92:95], a[188:191], v[212:215], v[92:95]
	s_waitcnt vmcnt(13)
	v_mfma_f32_16x16x32_bf16 v[96:99], a[176:179], v[216:219], v[96:99]
	v_mfma_f32_16x16x32_bf16 v[100:103], a[180:183], v[216:219], v[100:103]
	v_mfma_f32_16x16x32_bf16 v[104:107], a[184:187], v[216:219], v[104:107]
	v_mfma_f32_16x16x32_bf16 v[108:111], a[188:191], v[216:219], v[108:111]
	s_waitcnt vmcnt(12)
	v_mfma_f32_16x16x32_bf16 v[112:115], a[176:179], v[220:223], v[112:115]
	v_mfma_f32_16x16x32_bf16 v[116:119], a[180:183], v[220:223], v[116:119]
	v_mfma_f32_16x16x32_bf16 v[120:123], a[184:187], v[220:223], v[120:123]
	v_mfma_f32_16x16x32_bf16 v[124:127], a[188:191], v[220:223], v[124:127]
	s_waitcnt vmcnt(11)
	v_mfma_f32_16x16x32_bf16 v[64:67], a[192:195], v[224:227], v[64:67]
	buffer_load_dwordx4 v[208:211], v27, s[20:23], s66 offen offset:1024 sc1
	v_mfma_f32_16x16x32_bf16 v[68:71], a[196:199], v[224:227], v[68:71]
	buffer_load_dwordx4 v[212:215], v27, s[20:23], s67 offen offset:1024 sc1
	v_mfma_f32_16x16x32_bf16 v[72:75], a[200:203], v[224:227], v[72:75]
	buffer_load_dwordx4 v[216:219], v27, s[20:23], s68 offen offset:1024 sc1
	v_mfma_f32_16x16x32_bf16 v[76:79], a[204:207], v[224:227], v[76:79]
	s_waitcnt vmcnt(13)
	buffer_load_dwordx4 v[220:223], v27, s[20:23], s69 offen offset:1024 sc1
	v_mfma_f32_16x16x32_bf16 v[80:83], a[192:195], v[228:231], v[80:83]
	v_mfma_f32_16x16x32_bf16 v[84:87], a[196:199], v[228:231], v[84:87]
	v_mfma_f32_16x16x32_bf16 v[88:91], a[200:203], v[228:231], v[88:91]
	v_mfma_f32_16x16x32_bf16 v[92:95], a[204:207], v[228:231], v[92:95]
	s_waitcnt vmcnt(13)
	v_mfma_f32_16x16x32_bf16 v[96:99], a[192:195], v[232:235], v[96:99]
	v_mfma_f32_16x16x32_bf16 v[100:103], a[196:199], v[232:235], v[100:103]
	v_mfma_f32_16x16x32_bf16 v[104:107], a[200:203], v[232:235], v[104:107]
	v_mfma_f32_16x16x32_bf16 v[108:111], a[204:207], v[232:235], v[108:111]
	s_waitcnt vmcnt(12)
	v_mfma_f32_16x16x32_bf16 v[112:115], a[192:195], v[236:239], v[112:115]
	v_mfma_f32_16x16x32_bf16 v[116:119], a[196:199], v[236:239], v[116:119]
	v_mfma_f32_16x16x32_bf16 v[120:123], a[200:203], v[236:239], v[120:123]
	v_mfma_f32_16x16x32_bf16 v[124:127], a[204:207], v[236:239], v[124:127]
	s_waitcnt vmcnt(11)
	v_mfma_f32_16x16x32_bf16 v[64:67], a[208:211], v[240:243], v[64:67]
	buffer_load_dwordx4 v[224:227], v27, s[20:23], s66 offen offset:2048 sc1
	v_mfma_f32_16x16x32_bf16 v[68:71], a[212:215], v[240:243], v[68:71]
	buffer_load_dwordx4 v[228:231], v27, s[20:23], s67 offen offset:2048 sc1
	v_mfma_f32_16x16x32_bf16 v[72:75], a[216:219], v[240:243], v[72:75]
	buffer_load_dwordx4 v[232:235], v27, s[20:23], s68 offen offset:2048 sc1
	v_mfma_f32_16x16x32_bf16 v[76:79], a[220:223], v[240:243], v[76:79]
	s_waitcnt vmcnt(13)
	buffer_load_dwordx4 v[236:239], v27, s[20:23], s69 offen offset:2048 sc1
	v_mfma_f32_16x16x32_bf16 v[80:83], a[208:211], v[244:247], v[80:83]
	v_mfma_f32_16x16x32_bf16 v[84:87], a[212:215], v[244:247], v[84:87]
	v_mfma_f32_16x16x32_bf16 v[88:91], a[216:219], v[244:247], v[88:91]
	v_mfma_f32_16x16x32_bf16 v[92:95], a[220:223], v[244:247], v[92:95]
	s_waitcnt vmcnt(13)
	v_mfma_f32_16x16x32_bf16 v[96:99], a[208:211], v[248:251], v[96:99]
	v_mfma_f32_16x16x32_bf16 v[100:103], a[212:215], v[248:251], v[100:103]
	v_mfma_f32_16x16x32_bf16 v[104:107], a[216:219], v[248:251], v[104:107]
	v_mfma_f32_16x16x32_bf16 v[108:111], a[220:223], v[248:251], v[108:111]
	s_waitcnt vmcnt(12)
	v_mfma_f32_16x16x32_bf16 v[112:115], a[208:211], v[252:255], v[112:115]
	v_mfma_f32_16x16x32_bf16 v[116:119], a[212:215], v[252:255], v[116:119]
	v_mfma_f32_16x16x32_bf16 v[120:123], a[216:219], v[252:255], v[120:123]
	v_mfma_f32_16x16x32_bf16 v[124:127], a[220:223], v[252:255], v[124:127]
	s_waitcnt vmcnt(11)
	v_mfma_f32_16x16x32_bf16 v[64:67], a[224:227], v[192:195], v[64:67]
	buffer_load_dwordx4 v[240:243], v27, s[20:23], s66 offen offset:3072 sc1
	v_mfma_f32_16x16x32_bf16 v[68:71], a[228:231], v[192:195], v[68:71]
	buffer_load_dwordx4 v[244:247], v27, s[20:23], s67 offen offset:3072 sc1
	v_mfma_f32_16x16x32_bf16 v[72:75], a[232:235], v[192:195], v[72:75]
	buffer_load_dwordx4 v[248:251], v27, s[20:23], s68 offen offset:3072 sc1
	v_mfma_f32_16x16x32_bf16 v[76:79], a[236:239], v[192:195], v[76:79]
	s_waitcnt vmcnt(13)
	buffer_load_dwordx4 v[252:255], v27, s[20:23], s69 offen offset:3072 sc1
	v_mfma_f32_16x16x32_bf16 v[80:83], a[224:227], v[196:199], v[80:83]
	v_mfma_f32_16x16x32_bf16 v[84:87], a[228:231], v[196:199], v[84:87]
	v_mfma_f32_16x16x32_bf16 v[88:91], a[232:235], v[196:199], v[88:91]
	v_mfma_f32_16x16x32_bf16 v[92:95], a[236:239], v[196:199], v[92:95]
	s_waitcnt vmcnt(13)
	v_mfma_f32_16x16x32_bf16 v[96:99], a[224:227], v[200:203], v[96:99]
	v_mfma_f32_16x16x32_bf16 v[100:103], a[228:231], v[200:203], v[100:103]
	v_mfma_f32_16x16x32_bf16 v[104:107], a[232:235], v[200:203], v[104:107]
	v_mfma_f32_16x16x32_bf16 v[108:111], a[236:239], v[200:203], v[108:111]
	s_waitcnt vmcnt(12)
	v_mfma_f32_16x16x32_bf16 v[112:115], a[224:227], v[204:207], v[112:115]
	v_mfma_f32_16x16x32_bf16 v[116:119], a[228:231], v[204:207], v[116:119]
	v_mfma_f32_16x16x32_bf16 v[120:123], a[232:235], v[204:207], v[120:123]
	v_mfma_f32_16x16x32_bf16 v[124:127], a[236:239], v[204:207], v[124:127]
	v_add_u32 v20, s62, v2
	s_lshl_b32 s70, s42, 15
	s_lshl_b32 s71, s41, 12
	s_add_u32 s70, s70, s71
	v_add_u32 v16, s70, v2
	s_lshl_b32 s70, s58, 2
	s_add_u32 s70, s70, s40
	s_mul_i32 s70, s70, 18432
	s_lshl_b32 s71, s59, 7
	s_add_u32 s70, s70, s71
	s_waitcnt vmcnt(11)
	v_mfma_f32_16x16x32_bf16 v[64:67], a[240:243], v[208:211], v[64:67]
	v_bfe_u32 v22, v2, 4, 4
	v_mfma_f32_16x16x32_bf16 v[68:71], a[244:247], v[208:211], v[68:71]
	v_mul_u32_u24 v22, 1152, v22
	v_mfma_f32_16x16x32_bf16 v[72:75], a[248:251], v[208:211], v[72:75]
	v_bfe_u32 v18, v2, 8, 1
	v_mfma_f32_16x16x32_bf16 v[76:79], a[252:255], v[208:211], v[76:79]
	s_waitcnt vmcnt(7) lgkmcnt(14)
	v_lshl_add_u32 v22, v18, 5, v22
	v_mfma_f32_16x16x32_bf16 v[64:67], v[128:131], v[224:227], v[64:67]
	s_waitcnt lgkmcnt(12)
	v_lshrrev_b32 v18, 9, v2
	v_mfma_f32_16x16x32_bf16 v[68:71], v[132:135], v[224:227], v[68:71]
	s_waitcnt lgkmcnt(10)
	v_lshl_add_u32 v22, v18, 4, v22
	v_mfma_f32_16x16x32_bf16 v[72:75], v[136:139], v[224:227], v[72:75]
	s_waitcnt lgkmcnt(8)
	v_mfma_f32_16x16x32_bf16 v[76:79], v[140:143], v[224:227], v[76:79]
	s_waitcnt vmcnt(3) lgkmcnt(6)
	v_mfma_f32_16x16x32_bf16 v[64:67], v[144:147], v[240:243], v[64:67]
	s_waitcnt lgkmcnt(4)
	v_mfma_f32_16x16x32_bf16 v[68:71], v[148:151], v[240:243], v[68:71]
	s_waitcnt lgkmcnt(2)
	v_mfma_f32_16x16x32_bf16 v[72:75], v[152:155], v[240:243], v[72:75]
	s_waitcnt lgkmcnt(0)
	v_mfma_f32_16x16x32_bf16 v[76:79], v[156:159], v[240:243], v[76:79]
	v_mfma_f32_16x16x32_bf16 v[80:83], a[240:243], v[212:215], v[80:83]
	v_mfma_f32_16x16x32_bf16 v[84:87], a[244:247], v[212:215], v[84:87]
	v_mfma_f32_16x16x32_bf16 v[88:91], a[248:251], v[212:215], v[88:91]
	v_mfma_f32_16x16x32_bf16 v[92:95], a[252:255], v[212:215], v[92:95]
	v_mfma_f32_16x16x32_bf16 v[80:83], v[128:131], v[228:231], v[80:83]
	ds_write_b128 v20, v[64:67] offset:0
	v_mfma_f32_16x16x32_bf16 v[84:87], v[132:135], v[228:231], v[84:87]
	v_mfma_f32_16x16x32_bf16 v[88:91], v[136:139], v[228:231], v[88:91]
	ds_write_b128 v20, v[68:71] offset:1024
	v_mfma_f32_16x16x32_bf16 v[92:95], v[140:143], v[228:231], v[92:95]
	s_waitcnt vmcnt(2)
	v_mfma_f32_16x16x32_bf16 v[80:83], v[144:147], v[244:247], v[80:83]
	ds_write_b128 v20, v[72:75] offset:2048
	v_mfma_f32_16x16x32_bf16 v[84:87], v[148:151], v[244:247], v[84:87]
	v_mfma_f32_16x16x32_bf16 v[88:91], v[152:155], v[244:247], v[88:91]
	ds_write_b128 v20, v[76:79] offset:3072
	v_mfma_f32_16x16x32_bf16 v[92:95], v[156:159], v[244:247], v[92:95]
	v_mfma_f32_16x16x32_bf16 v[96:99], a[240:243], v[216:219], v[96:99]
	v_mfma_f32_16x16x32_bf16 v[100:103], a[244:247], v[216:219], v[100:103]
	v_mfma_f32_16x16x32_bf16 v[104:107], a[248:251], v[216:219], v[104:107]
	v_mfma_f32_16x16x32_bf16 v[108:111], a[252:255], v[216:219], v[108:111]
	v_mfma_f32_16x16x32_bf16 v[96:99], v[128:131], v[232:235], v[96:99]
	ds_write_b128 v20, v[80:83] offset:4096
	v_mfma_f32_16x16x32_bf16 v[100:103], v[132:135], v[232:235], v[100:103]
	v_mfma_f32_16x16x32_bf16 v[104:107], v[136:139], v[232:235], v[104:107]
	ds_write_b128 v20, v[84:87] offset:5120
	v_mfma_f32_16x16x32_bf16 v[108:111], v[140:143], v[232:235], v[108:111]
	s_waitcnt vmcnt(1)
	v_mfma_f32_16x16x32_bf16 v[96:99], v[144:147], v[248:251], v[96:99]
	ds_write_b128 v20, v[88:91] offset:6144
	v_mfma_f32_16x16x32_bf16 v[100:103], v[148:151], v[248:251], v[100:103]
	v_mfma_f32_16x16x32_bf16 v[104:107], v[152:155], v[248:251], v[104:107]
	ds_write_b128 v20, v[92:95] offset:7168
	v_mfma_f32_16x16x32_bf16 v[108:111], v[156:159], v[248:251], v[108:111]
	v_mfma_f32_16x16x32_bf16 v[112:115], a[240:243], v[220:223], v[112:115]
	v_mfma_f32_16x16x32_bf16 v[116:119], a[244:247], v[220:223], v[116:119]
	v_mfma_f32_16x16x32_bf16 v[120:123], a[248:251], v[220:223], v[120:123]
	v_mfma_f32_16x16x32_bf16 v[124:127], a[252:255], v[220:223], v[124:127]
	v_mfma_f32_16x16x32_bf16 v[112:115], v[128:131], v[236:239], v[112:115]
	ds_write_b128 v20, v[96:99] offset:32768
	v_mfma_f32_16x16x32_bf16 v[116:119], v[132:135], v[236:239], v[116:119]
	v_mfma_f32_16x16x32_bf16 v[120:123], v[136:139], v[236:239], v[120:123]
	ds_write_b128 v20, v[100:103] offset:33792
	v_mfma_f32_16x16x32_bf16 v[124:127], v[140:143], v[236:239], v[124:127]
	s_waitcnt vmcnt(0)
	v_mfma_f32_16x16x32_bf16 v[112:115], v[144:147], v[252:255], v[112:115]
	ds_write_b128 v20, v[104:107] offset:34816
	v_mfma_f32_16x16x32_bf16 v[116:119], v[148:151], v[252:255], v[116:119]
	v_mfma_f32_16x16x32_bf16 v[120:123], v[152:155], v[252:255], v[120:123]
	ds_write_b128 v20, v[108:111] offset:35840
	v_mfma_f32_16x16x32_bf16 v[124:127], v[156:159], v[252:255], v[124:127]
	s_nop 2
	ds_write_b128 v20, v[112:115] offset:36864
	s_nop 0
	ds_write_b128 v20, v[116:119] offset:37888
	ds_write_b128 v20, v[120:123] offset:38912
	s_nop 0
	ds_write_b128 v20, v[124:127] offset:39936
	s_waitcnt lgkmcnt(0)
	s_barrier
	ds_read_b128 v[128:131], v16 offset:0
	ds_read_b128 v[132:135], v16 offset:1024
	ds_read_b128 v[136:139], v16 offset:2048
	ds_read_b128 v[140:143], v16 offset:3072
	ds_read_b128 v[144:147], v16 offset:8192
	ds_read_b128 v[148:151], v16 offset:9216
	ds_read_b128 v[152:155], v16 offset:10240
	ds_read_b128 v[156:159], v16 offset:11264
	ds_read_b128 v[160:163], v16 offset:16384
	ds_read_b128 v[164:167], v16 offset:17408
	ds_read_b128 v[168:171], v16 offset:18432
	ds_read_b128 v[172:175], v16 offset:19456
	ds_read_b128 v[176:179], v16 offset:24576
	ds_read_b128 v[180:183], v16 offset:25600
	ds_read_b128 v[184:187], v16 offset:26624
	ds_read_b128 v[188:191], v16 offset:27648
	s_waitcnt lgkmcnt(11)
	v_pk_add_f32 v[128:129], v[128:129], v[144:145]
	v_pk_add_f32 v[130:131], v[130:131], v[146:147]
	s_waitcnt lgkmcnt(10)
	v_pk_add_f32 v[132:133], v[132:133], v[148:149]
	v_pk_add_f32 v[134:135], v[134:135], v[150:151]
	s_waitcnt lgkmcnt(9)
	v_pk_add_f32 v[136:137], v[136:137], v[152:153]
	v_pk_add_f32 v[138:139], v[138:139], v[154:155]
	s_waitcnt lgkmcnt(8)
	v_pk_add_f32 v[140:141], v[140:141], v[156:157]
	v_pk_add_f32 v[142:143], v[142:143], v[158:159]
	s_waitcnt lgkmcnt(3)
	v_pk_add_f32 v[160:161], v[160:161], v[176:177]
	v_pk_add_f32 v[162:163], v[162:163], v[178:179]
	s_waitcnt lgkmcnt(2)
	v_pk_add_f32 v[164:165], v[164:165], v[180:181]
	v_pk_add_f32 v[166:167], v[166:167], v[182:183]
	s_waitcnt lgkmcnt(1)
	v_pk_add_f32 v[168:169], v[168:169], v[184:185]
	v_pk_add_f32 v[170:171], v[170:171], v[186:187]
	s_waitcnt lgkmcnt(0)
	v_pk_add_f32 v[172:173], v[172:173], v[188:189]
	v_pk_add_f32 v[174:175], v[174:175], v[190:191]
	v_pk_add_f32 v[128:129], v[128:129], v[160:161]
	v_pk_add_f32 v[130:131], v[130:131], v[162:163]
	v_pk_add_f32 v[132:133], v[132:133], v[164:165]
	v_pk_add_f32 v[134:135], v[134:135], v[166:167]
	v_pk_add_f32 v[136:137], v[136:137], v[168:169]
	v_pk_add_f32 v[138:139], v[138:139], v[170:171]
	v_pk_add_f32 v[140:141], v[140:141], v[172:173]
	v_pk_add_f32 v[142:143], v[142:143], v[174:175]
	v_cvt_pk_bf16_f32 v64, v128, v129
	v_cvt_pk_bf16_f32 v65, v130, v131
	v_cvt_pk_bf16_f32 v66, v132, v133
	v_cvt_pk_bf16_f32 v67, v134, v135
	v_cvt_pk_bf16_f32 v68, v136, v137
	v_cvt_pk_bf16_f32 v69, v138, v139
	v_cvt_pk_bf16_f32 v70, v140, v141
	v_cvt_pk_bf16_f32 v71, v142, v143
	v_permlane16_swap_b32 v64, v66
	v_permlane16_swap_b32 v65, v67
	v_permlane16_swap_b32 v68, v70
	v_permlane16_swap_b32 v69, v71
	buffer_store_dwordx4 v[64:67], v22, s[28:31], s70 offen
	buffer_store_dwordx4 v[68:71], v22, s[28:31], s70 offen offset:64
L_fin:
L_end:
	s_endpgm
L_slow:
	s_mov_b32 s65, -1
	s_waitcnt vmcnt(0) lgkmcnt(0)
	s_barrier
	v_mov_b32 v36, 0xff800000
	v_mov_b32 v37, 0xff800000
	v_mov_b32 v38, 0xff800000
	v_mov_b32 v39, 0xff800000
	s_mov_b32 s70, 0
L_slow1:
	s_add_u32 m0, s48, 32768
	s_add_u32 s49, s70, 0
	buffer_load_dwordx4 v3, s[12:15], s49 offen lds
	buffer_load_dwordx4 v3, s[12:15], s49 offen offset:2048 lds
	s_add_u32 m0, s48, 49152
	s_add_u32 s49, s70, 8192
	buffer_load_dwordx4 v3, s[12:15], s49 offen lds
	buffer_load_dwordx4 v3, s[12:15], s49 offen offset:2048 lds
	s_waitcnt vmcnt(0)
	s_barrier
	ds_read_b128 a[64:67], v8 offset:32768
	ds_read_b128 a[68:71], v8 offset:33024
	ds_read_b128 a[72:75], v12 offset:32768
	ds_read_b128 a[76:79], v12 offset:33024
	ds_read_b128 a[80:83], v8 offset:36864
	ds_read_b128 a[84:87], v8 offset:37120
	ds_read_b128 a[88:91], v12 offset:36864
	ds_read_b128 a[92:95], v12 offset:37120
	s_waitcnt lgkmcnt(7)
	v_mfma_f32_16x16x32_bf16 v[40:43], a[64:67], v[64:67], 0
	s_waitcnt lgkmcnt(6)
	v_mfma_f32_16x16x32_bf16 v[40:43], a[68:71], v[68:71], v[40:43]
	s_waitcnt lgkmcnt(5)
	v_mfma_f32_16x16x32_bf16 v[40:43], a[72:75], v[72:75], v[40:43]
	s_waitcnt lgkmcnt(4)
	v_mfma_f32_16x16x32_bf16 v[40:43], a[76:79], v[76:79], v[40:43]
	s_waitcnt lgkmcnt(3)
	v_mfma_f32_16x16x32_bf16 v[44:47], a[80:83], v[64:67], 0
	s_waitcnt lgkmcnt(2)
	v_mfma_f32_16x16x32_bf16 v[44:47], a[84:87], v[68:71], v[44:47]
	s_waitcnt lgkmcnt(1)
	v_mfma_f32_16x16x32_bf16 v[44:47], a[88:91], v[72:75], v[44:47]
	s_waitcnt lgkmcnt(0)
	v_mfma_f32_16x16x32_bf16 v[44:47], a[92:95], v[76:79], v[44:47]
	v_max3_f32 v36, v36, v40, v41
	v_max3_f32 v36, v36, v42, v43
	s_nop 5
	v_max3_f32 v36, v36, v44, v45
	v_max3_f32 v36, v36, v46, v47
	v_mfma_f32_16x16x32_bf16 v[40:43], a[64:67], v[80:83], 0
	v_mfma_f32_16x16x32_bf16 v[40:43], a[68:71], v[84:87], v[40:43]
	v_mfma_f32_16x16x32_bf16 v[40:43], a[72:75], v[88:91], v[40:43]
	v_mfma_f32_16x16x32_bf16 v[40:43], a[76:79], v[92:95], v[40:43]
	v_mfma_f32_16x16x32_bf16 v[44:47], a[80:83], v[80:83], 0
	v_mfma_f32_16x16x32_bf16 v[44:47], a[84:87], v[84:87], v[44:47]
	v_mfma_f32_16x16x32_bf16 v[44:47], a[88:91], v[88:91], v[44:47]
	v_mfma_f32_16x16x32_bf16 v[44:47], a[92:95], v[92:95], v[44:47]
	s_nop 3
	v_max3_f32 v37, v37, v40, v41
	v_max3_f32 v37, v37, v42, v43
	s_nop 1
	v_max3_f32 v37, v37, v44, v45
	v_max3_f32 v37, v37, v46, v47
	v_mfma_f32_16x16x32_bf16 v[40:43], a[64:67], v[96:99], 0
	v_mfma_f32_16x16x32_bf16 v[40:43], a[68:71], v[100:103], v[40:43]
	v_mfma_f32_16x16x32_bf16 v[40:43], a[72:75], v[104:107], v[40:43]
	v_mfma_f32_16x16x32_bf16 v[40:43], a[76:79], v[108:111], v[40:43]
	v_mfma_f32_16x16x32_bf16 v[44:47], a[80:83], v[96:99], 0
	v_mfma_f32_16x16x32_bf16 v[44:47], a[84:87], v[100:103], v[44:47]
	v_mfma_f32_16x16x32_bf16 v[44:47], a[88:91], v[104:107], v[44:47]
	v_mfma_f32_16x16x32_bf16 v[44:47], a[92:95], v[108:111], v[44:47]
	s_nop 3
	v_max3_f32 v38, v38, v40, v41
	v_max3_f32 v38, v38, v42, v43
	s_nop 1
	v_max3_f32 v38, v38, v44, v45
	v_max3_f32 v38, v38, v46, v47
	v_mfma_f32_16x16x32_bf16 v[40:43], a[64:67], v[112:115], 0
	v_mfma_f32_16x16x32_bf16 v[40:43], a[68:71], v[116:119], v[40:43]
	v_mfma_f32_16x16x32_bf16 v[40:43], a[72:75], v[120:123], v[40:43]
	v_mfma_f32_16x16x32_bf16 v[40:43], a[76:79], v[124:127], v[40:43]
	v_mfma_f32_16x16x32_bf16 v[44:47], a[80:83], v[112:115], 0
	v_mfma_f32_16x16x32_bf16 v[44:47], a[84:87], v[116:119], v[44:47]
	v_mfma_f32_16x16x32_bf16 v[44:47], a[88:91], v[120:123], v[44:47]
	v_mfma_f32_16x16x32_bf16 v[44:47], a[92:95], v[124:127], v[44:47]
	s_nop 3
	v_max3_f32 v39, v39, v40, v41
	v_max3_f32 v39, v39, v42, v43
	s_nop 1
	v_max3_f32 v39, v39, v44, v45
	v_max3_f32 v39, v39, v46, v47
	ds_read_b128 a[64:67], v10 offset:32768
	ds_read_b128 a[68:71], v10 offset:33024
	ds_read_b128 a[72:75], v14 offset:32768
	ds_read_b128 a[76:79], v14 offset:33024
	ds_read_b128 a[80:83], v10 offset:36864
	ds_read_b128 a[84:87], v10 offset:37120
	ds_read_b128 a[88:91], v14 offset:36864
	ds_read_b128 a[92:95], v14 offset:37120
	s_waitcnt lgkmcnt(7)
	v_mfma_f32_16x16x32_bf16 v[40:43], a[64:67], v[64:67], 0
	s_waitcnt lgkmcnt(6)
	v_mfma_f32_16x16x32_bf16 v[40:43], a[68:71], v[68:71], v[40:43]
	s_waitcnt lgkmcnt(5)
	v_mfma_f32_16x16x32_bf16 v[40:43], a[72:75], v[72:75], v[40:43]
	s_waitcnt lgkmcnt(4)
	v_mfma_f32_16x16x32_bf16 v[40:43], a[76:79], v[76:79], v[40:43]
	s_waitcnt lgkmcnt(3)
	v_mfma_f32_16x16x32_bf16 v[44:47], a[80:83], v[64:67], 0
	s_waitcnt lgkmcnt(2)
	v_mfma_f32_16x16x32_bf16 v[44:47], a[84:87], v[68:71], v[44:47]
	s_waitcnt lgkmcnt(1)
	v_mfma_f32_16x16x32_bf16 v[44:47], a[88:91], v[72:75], v[44:47]
	s_waitcnt lgkmcnt(0)
	v_mfma_f32_16x16x32_bf16 v[44:47], a[92:95], v[76:79], v[44:47]
	v_max3_f32 v36, v36, v40, v41
	v_max3_f32 v36, v36, v42, v43
	s_nop 5
	v_max3_f32 v36, v36, v44, v45
	v_max3_f32 v36, v36, v46, v47
	v_mfma_f32_16x16x32_bf16 v[40:43], a[64:67], v[80:83], 0
	v_mfma_f32_16x16x32_bf16 v[40:43], a[68:71], v[84:87], v[40:43]
	v_mfma_f32_16x16x32_bf16 v[40:43], a[72:75], v[88:91], v[40:43]
	v_mfma_f32_16x16x32_bf16 v[40:43], a[76:79], v[92:95], v[40:43]
	v_mfma_f32_16x16x32_bf16 v[44:47], a[80:83], v[80:83], 0
	v_mfma_f32_16x16x32_bf16 v[44:47], a[84:87], v[84:87], v[44:47]
	v_mfma_f32_16x16x32_bf16 v[44:47], a[88:91], v[88:91], v[44:47]
	v_mfma_f32_16x16x32_bf16 v[44:47], a[92:95], v[92:95], v[44:47]
	s_nop 3
	v_max3_f32 v37, v37, v40, v41
	v_max3_f32 v37, v37, v42, v43
	s_nop 1
	v_max3_f32 v37, v37, v44, v45
	v_max3_f32 v37, v37, v46, v47
	v_mfma_f32_16x16x32_bf16 v[40:43], a[64:67], v[96:99], 0
	v_mfma_f32_16x16x32_bf16 v[40:43], a[68:71], v[100:103], v[40:43]
	v_mfma_f32_16x16x32_bf16 v[40:43], a[72:75], v[104:107], v[40:43]
	v_mfma_f32_16x16x32_bf16 v[40:43], a[76:79], v[108:111], v[40:43]
	v_mfma_f32_16x16x32_bf16 v[44:47], a[80:83], v[96:99], 0
	v_mfma_f32_16x16x32_bf16 v[44:47], a[84:87], v[100:103], v[44:47]
	v_mfma_f32_16x16x32_bf16 v[44:47], a[88:91], v[104:107], v[44:47]
	v_mfma_f32_16x16x32_bf16 v[44:47], a[92:95], v[108:111], v[44:47]
	s_nop 3
	v_max3_f32 v38, v38, v40, v41
	v_max3_f32 v38, v38, v42, v43
	s_nop 1
	v_max3_f32 v38, v38, v44, v45
	v_max3_f32 v38, v38, v46, v47
	v_mfma_f32_16x16x32_bf16 v[40:43], a[64:67], v[112:115], 0
	v_mfma_f32_16x16x32_bf16 v[40:43], a[68:71], v[116:119], v[40:43]
	v_mfma_f32_16x16x32_bf16 v[40:43], a[72:75], v[120:123], v[40:43]
	v_mfma_f32_16x16x32_bf16 v[40:43], a[76:79], v[124:127], v[40:43]
	v_mfma_f32_16x16x32_bf16 v[44:47], a[80:83], v[112:115], 0
	v_mfma_f32_16x16x32_bf16 v[44:47], a[84:87], v[116:119], v[44:47]
	v_mfma_f32_16x16x32_bf16 v[44:47], a[88:91], v[120:123], v[44:47]
	v_mfma_f32_16x16x32_bf16 v[44:47], a[92:95], v[124:127], v[44:47]
	s_nop 3
	v_max3_f32 v39, v39, v40, v41
	v_max3_f32 v39, v39, v42, v43
	s_nop 1
	v_max3_f32 v39, v39, v44, v45
	v_max3_f32 v39, v39, v46, v47
	s_waitcnt lgkmcnt(0)
	s_nop 7
	s_nop 7
	s_barrier
	s_add_u32 s70, s70, 16384
	s_cmp_lt_u32 s70, 0x20000
	s_cbranch_scc1 L_slow1
	v_mov_b32 v40, v36
	v_mov_b32 v41, v37
	v_mov_b32 v42, v38
	v_mov_b32 v43, v39
	v_permlane32_swap_b32 v36, v40
	v_permlane32_swap_b32 v37, v41
	v_permlane32_swap_b32 v38, v42
	v_permlane32_swap_b32 v39, v43
	v_max_f32 v36, v36, v40
	v_max_f32 v37, v37, v41
	v_max_f32 v38, v38, v42
	v_max_f32 v39, v39, v43
	v_mov_b32 v40, v36
	v_mov_b32 v41, v37
	v_mov_b32 v42, v38
	v_mov_b32 v43, v39
	v_permlane16_swap_b32 v36, v40
	v_permlane16_swap_b32 v37, v41
	v_permlane16_swap_b32 v38, v42
	v_permlane16_swap_b32 v39, v43
	v_max_f32 v36, v36, v40
	v_max_f32 v37, v37, v41
	v_max_f32 v38, v38, v42
	v_max_f32 v39, v39, v43
	v_mov_b32 v128, 0
	v_mov_b32 v129, 0
	v_mov_b32 v130, 0
	v_mov_b32 v131, 0
	v_mov_b32 v132, 0
	v_mov_b32 v133, 0
	v_mov_b32 v134, 0
	v_mov_b32 v135, 0
	v_mov_b32 v136, 0
	v_mov_b32 v137, 0
	v_mov_b32 v138, 0
	v_mov_b32 v139, 0
	v_mov_b32 v140, 0
	v_mov_b32 v141, 0
	v_mov_b32 v142, 0
	v_mov_b32 v143, 0
	v_mov_b32 v144, 0
	v_mov_b32 v145, 0
	v_mov_b32 v146, 0
	v_mov_b32 v147, 0
	v_mov_b32 v148, 0
	v_mov_b32 v149, 0
	v_mov_b32 v150, 0
	v_mov_b32 v151, 0
	v_mov_b32 v152, 0
	v_mov_b32 v153, 0
	v_mov_b32 v154, 0
	v_mov_b32 v155, 0
	v_mov_b32 v156, 0
	v_mov_b32 v157, 0
	v_mov_b32 v158, 0
	v_mov_b32 v159, 0
	v_mov_b32 v160, 0
	v_mov_b32 v161, 0
	v_mov_b32 v162, 0
	v_mov_b32 v163, 0
	v_mov_b32 v164, 0
	v_mov_b32 v165, 0
	v_mov_b32 v166, 0
	v_mov_b32 v167, 0
	v_mov_b32 v168, 0
	v_mov_b32 v169, 0
	v_mov_b32 v170, 0
	v_mov_b32 v171, 0
	v_mov_b32 v172, 0
	v_mov_b32 v173, 0
	v_mov_b32 v174, 0
	v_mov_b32 v175, 0
	v_mov_b32 v176, 0
	v_mov_b32 v177, 0
	v_mov_b32 v178, 0
	v_mov_b32 v179, 0
	v_mov_b32 v180, 0
	v_mov_b32 v181, 0
	v_mov_b32 v182, 0
	v_mov_b32 v183, 0
	v_mov_b32 v184, 0
	v_mov_b32 v185, 0
	v_mov_b32 v186, 0
	v_mov_b32 v187, 0
	v_mov_b32 v188, 0
	v_mov_b32 v189, 0
	v_mov_b32 v190, 0
	v_mov_b32 v191, 0
	v_mov_b32 v192, 0
	v_mov_b32 v193, 0
	v_mov_b32 v194, 0
	v_mov_b32 v195, 0
	v_mov_b32 v196, 0
	v_mov_b32 v197, 0
	v_mov_b32 v198, 0
	v_mov_b32 v199, 0
	v_mov_b32 v200, 0
	v_mov_b32 v201, 0
	v_mov_b32 v202, 0
	v_mov_b32 v203, 0
	v_mov_b32 v204, 0
	v_mov_b32 v205, 0
	v_mov_b32 v206, 0
	v_mov_b32 v207, 0
	v_mov_b32 v208, 0
	v_mov_b32 v209, 0
	v_mov_b32 v210, 0
	v_mov_b32 v211, 0
	v_mov_b32 v212, 0
	v_mov_b32 v213, 0
	v_mov_b32 v214, 0
	v_mov_b32 v215, 0
	v_mov_b32 v216, 0
	v_mov_b32 v217, 0
	v_mov_b32 v218, 0
	v_mov_b32 v219, 0
	v_mov_b32 v220, 0
	v_mov_b32 v221, 0
	v_mov_b32 v222, 0
	v_mov_b32 v223, 0
	v_mov_b32 v224, 0
	v_mov_b32 v225, 0
	v_mov_b32 v226, 0
	v_mov_b32 v227, 0
	v_mov_b32 v228, 0
	v_mov_b32 v229, 0
	v_mov_b32 v230, 0
	v_mov_b32 v231, 0
	v_mov_b32 v232, 0
	v_mov_b32 v233, 0
	v_mov_b32 v234, 0
	v_mov_b32 v235, 0
	v_mov_b32 v236, 0
	v_mov_b32 v237, 0
	v_mov_b32 v238, 0
	v_mov_b32 v239, 0
	v_mov_b32 v240, 0
	v_mov_b32 v241, 0
	v_mov_b32 v242, 0
	v_mov_b32 v243, 0
	v_mov_b32 v244, 0
	v_mov_b32 v245, 0
	v_mov_b32 v246, 0
	v_mov_b32 v247, 0
	v_mov_b32 v248, 0
	v_mov_b32 v249, 0
	v_mov_b32 v250, 0
	v_mov_b32 v251, 0
	v_mov_b32 v252, 0
	v_mov_b32 v253, 0
	v_mov_b32 v254, 0
	v_mov_b32 v255, 0
	v_mov_b32 v24, 0
	v_mov_b32 v25, 0
	v_mov_b32 v26, 0
	v_mov_b32 v27, 0
	s_mov_b32 s70, 0
L_slow2:
	s_add_u32 m0, s48, 32768
	s_add_u32 s49, s70, 0
	buffer_load_dwordx4 v3, s[12:15], s49 offen lds
	buffer_load_dwordx4 v3, s[12:15], s49 offen offset:2048 lds
	s_add_u32 m0, s48, 40960
	s_add_u32 s49, s70, 0
	buffer_load_dwordx4 v4, s[16:19], s49 offen lds
	buffer_load_dwordx4 v4, s[16:19], s49 offen offset:2048 lds
	s_add_u32 m0, s48, 49152
	s_add_u32 s49, s70, 8192
	buffer_load_dwordx4 v3, s[12:15], s49 offen lds
	buffer_load_dwordx4 v3, s[12:15], s49 offen offset:2048 lds
	s_add_u32 m0, s48, 57344
	s_add_u32 s49, s70, 8192
	buffer_load_dwordx4 v4, s[16:19], s49 offen lds
	buffer_load_dwordx4 v4, s[16:19], s49 offen offset:2048 lds
	s_waitcnt vmcnt(0)
	s_barrier
	ds_read_b128 a[64:67], v8 offset:32768
	ds_read_b128 a[68:71], v8 offset:33024
	ds_read_b128 a[72:75], v12 offset:32768
	ds_read_b128 a[76:79], v12 offset:33024
	ds_read_b128 a[80:83], v8 offset:36864
	ds_read_b128 a[84:87], v8 offset:37120
	ds_read_b128 a[88:91], v12 offset:36864
	ds_read_b128 a[92:95], v12 offset:37120
	ds_read_b64_tr_b16 a[96:97], v16 offset:40960
	ds_read_b64_tr_b16 a[98:99], v16 offset:45056
	ds_read_b64_tr_b16 a[100:101], v20 offset:40960
	ds_read_b64_tr_b16 a[102:103], v20 offset:45056
	ds_read_b64_tr_b16 a[104:105], v16 offset:41216
	ds_read_b64_tr_b16 a[106:107], v16 offset:45312
	ds_read_b64_tr_b16 a[108:109], v20 offset:41216
	ds_read_b64_tr_b16 a[110:111], v20 offset:45312
	ds_read_b64_tr_b16 a[112:113], v16 offset:41472
	ds_read_b64_tr_b16 a[114:115], v16 offset:45568
	ds_read_b64_tr_b16 a[116:117], v20 offset:41472
	ds_read_b64_tr_b16 a[118:119], v20 offset:45568
	ds_read_b64_tr_b16 a[120:121], v16 offset:41728
	ds_read_b64_tr_b16 a[122:123], v16 offset:45824
	ds_read_b64_tr_b16 a[124:125], v20 offset:41728
	ds_read_b64_tr_b16 a[126:127], v20 offset:45824
	s_waitcnt lgkmcnt(15)
	v_mfma_f32_16x16x32_bf16 v[40:43], a[64:67], v[64:67], 0
	v_mfma_f32_16x16x32_bf16 v[40:43], a[68:71], v[68:71], v[40:43]
	v_mfma_f32_16x16x32_bf16 v[40:43], a[72:75], v[72:75], v[40:43]
	v_mfma_f32_16x16x32_bf16 v[40:43], a[76:79], v[76:79], v[40:43]
	v_mfma_f32_16x16x32_bf16 v[44:47], a[80:83], v[64:67], 0
	v_mfma_f32_16x16x32_bf16 v[44:47], a[84:87], v[68:71], v[44:47]
	v_mfma_f32_16x16x32_bf16 v[44:47], a[88:91], v[72:75], v[44:47]
	v_mfma_f32_16x16x32_bf16 v[44:47], a[92:95], v[76:79], v[44:47]
	s_nop 3
	v_sub_f32 v40, v40, v36
	v_sub_f32 v41, v41, v36
	v_sub_f32 v42, v42, v36
	v_sub_f32 v43, v43, v36
	v_sub_f32 v44, v44, v36
	v_sub_f32 v45, v45, v36
	v_sub_f32 v46, v46, v36
	v_sub_f32 v47, v47, v36
	v_exp_f32 v40, v40
	v_exp_f32 v41, v41
	v_exp_f32 v42, v42
	v_exp_f32 v43, v43
	v_exp_f32 v44, v44
	v_exp_f32 v45, v45
	v_exp_f32 v46, v46
	v_exp_f32 v47, v47
	v_add_f32 v24, v24, v40
	v_add_f32 v24, v24, v41
	v_add_f32 v24, v24, v42
	v_add_f32 v24, v24, v43
	v_add_f32 v24, v24, v44
	v_add_f32 v24, v24, v45
	v_add_f32 v24, v24, v46
	v_add_f32 v24, v24, v47
	v_cvt_pk_bf16_f32 v28, v40, v41
	v_cvt_pk_bf16_f32 v29, v42, v43
	v_cvt_pk_bf16_f32 v30, v44, v45
	v_cvt_pk_bf16_f32 v31, v46, v47
	s_waitcnt lgkmcnt(14)
	s_nop 0
	v_mfma_f32_16x16x32_bf16 v[128:131], a[96:99], v[28:31], v[128:131]
	s_waitcnt lgkmcnt(12)
	v_mfma_f32_16x16x32_bf16 v[132:135], a[100:103], v[28:31], v[132:135]
	s_waitcnt lgkmcnt(10)
	v_mfma_f32_16x16x32_bf16 v[136:139], a[104:107], v[28:31], v[136:139]
	s_waitcnt lgkmcnt(8)
	v_mfma_f32_16x16x32_bf16 v[140:143], a[108:111], v[28:31], v[140:143]
	s_waitcnt lgkmcnt(6)
	v_mfma_f32_16x16x32_bf16 v[144:147], a[112:115], v[28:31], v[144:147]
	s_waitcnt lgkmcnt(4)
	v_mfma_f32_16x16x32_bf16 v[148:151], a[116:119], v[28:31], v[148:151]
	s_waitcnt lgkmcnt(2)
	v_mfma_f32_16x16x32_bf16 v[152:155], a[120:123], v[28:31], v[152:155]
	s_waitcnt lgkmcnt(0)
	v_mfma_f32_16x16x32_bf16 v[156:159], a[124:127], v[28:31], v[156:159]
	v_mfma_f32_16x16x32_bf16 v[40:43], a[64:67], v[80:83], 0
	v_mfma_f32_16x16x32_bf16 v[40:43], a[68:71], v[84:87], v[40:43]
	v_mfma_f32_16x16x32_bf16 v[40:43], a[72:75], v[88:91], v[40:43]
	v_mfma_f32_16x16x32_bf16 v[40:43], a[76:79], v[92:95], v[40:43]
	v_mfma_f32_16x16x32_bf16 v[44:47], a[80:83], v[80:83], 0
	v_mfma_f32_16x16x32_bf16 v[44:47], a[84:87], v[84:87], v[44:47]
	v_mfma_f32_16x16x32_bf16 v[44:47], a[88:91], v[88:91], v[44:47]
	v_mfma_f32_16x16x32_bf16 v[44:47], a[92:95], v[92:95], v[44:47]
	s_nop 3
	v_sub_f32 v40, v40, v37
	v_sub_f32 v41, v41, v37
	v_sub_f32 v42, v42, v37
	v_sub_f32 v43, v43, v37
	v_sub_f32 v44, v44, v37
	v_sub_f32 v45, v45, v37
	v_sub_f32 v46, v46, v37
	v_sub_f32 v47, v47, v37
	v_exp_f32 v40, v40
	v_exp_f32 v41, v41
	v_exp_f32 v42, v42
	v_exp_f32 v43, v43
	v_exp_f32 v44, v44
	v_exp_f32 v45, v45
	v_exp_f32 v46, v46
	v_exp_f32 v47, v47
	v_add_f32 v25, v25, v40
	v_add_f32 v25, v25, v41
	v_add_f32 v25, v25, v42
	v_add_f32 v25, v25, v43
	v_add_f32 v25, v25, v44
	v_add_f32 v25, v25, v45
	v_add_f32 v25, v25, v46
	v_add_f32 v25, v25, v47
	v_cvt_pk_bf16_f32 v28, v40, v41
	v_cvt_pk_bf16_f32 v29, v42, v43
	v_cvt_pk_bf16_f32 v30, v44, v45
	v_cvt_pk_bf16_f32 v31, v46, v47
	s_nop 1
	v_mfma_f32_16x16x32_bf16 v[160:163], a[96:99], v[28:31], v[160:163]
	v_mfma_f32_16x16x32_bf16 v[164:167], a[100:103], v[28:31], v[164:167]
	v_mfma_f32_16x16x32_bf16 v[168:171], a[104:107], v[28:31], v[168:171]
	v_mfma_f32_16x16x32_bf16 v[172:175], a[108:111], v[28:31], v[172:175]
	v_mfma_f32_16x16x32_bf16 v[176:179], a[112:115], v[28:31], v[176:179]
	v_mfma_f32_16x16x32_bf16 v[180:183], a[116:119], v[28:31], v[180:183]
	v_mfma_f32_16x16x32_bf16 v[184:187], a[120:123], v[28:31], v[184:187]
	v_mfma_f32_16x16x32_bf16 v[188:191], a[124:127], v[28:31], v[188:191]
	v_mfma_f32_16x16x32_bf16 v[40:43], a[64:67], v[96:99], 0
	v_mfma_f32_16x16x32_bf16 v[40:43], a[68:71], v[100:103], v[40:43]
	v_mfma_f32_16x16x32_bf16 v[40:43], a[72:75], v[104:107], v[40:43]
	v_mfma_f32_16x16x32_bf16 v[40:43], a[76:79], v[108:111], v[40:43]
	v_mfma_f32_16x16x32_bf16 v[44:47], a[80:83], v[96:99], 0
	v_mfma_f32_16x16x32_bf16 v[44:47], a[84:87], v[100:103], v[44:47]
	v_mfma_f32_16x16x32_bf16 v[44:47], a[88:91], v[104:107], v[44:47]
	v_mfma_f32_16x16x32_bf16 v[44:47], a[92:95], v[108:111], v[44:47]
	s_nop 3
	v_sub_f32 v40, v40, v38
	v_sub_f32 v41, v41, v38
	v_sub_f32 v42, v42, v38
	v_sub_f32 v43, v43, v38
	v_sub_f32 v44, v44, v38
	v_sub_f32 v45, v45, v38
	v_sub_f32 v46, v46, v38
	v_sub_f32 v47, v47, v38
	v_exp_f32 v40, v40
	v_exp_f32 v41, v41
	v_exp_f32 v42, v42
	v_exp_f32 v43, v43
	v_exp_f32 v44, v44
	v_exp_f32 v45, v45
	v_exp_f32 v46, v46
	v_exp_f32 v47, v47
	v_add_f32 v26, v26, v40
	v_add_f32 v26, v26, v41
	v_add_f32 v26, v26, v42
	v_add_f32 v26, v26, v43
	v_add_f32 v26, v26, v44
	v_add_f32 v26, v26, v45
	v_add_f32 v26, v26, v46
	v_add_f32 v26, v26, v47
	v_cvt_pk_bf16_f32 v28, v40, v41
	v_cvt_pk_bf16_f32 v29, v42, v43
	v_cvt_pk_bf16_f32 v30, v44, v45
	v_cvt_pk_bf16_f32 v31, v46, v47
	s_nop 1
	v_mfma_f32_16x16x32_bf16 v[192:195], a[96:99], v[28:31], v[192:195]
	v_mfma_f32_16x16x32_bf16 v[196:199], a[100:103], v[28:31], v[196:199]
	v_mfma_f32_16x16x32_bf16 v[200:203], a[104:107], v[28:31], v[200:203]
	v_mfma_f32_16x16x32_bf16 v[204:207], a[108:111], v[28:31], v[204:207]
	v_mfma_f32_16x16x32_bf16 v[208:211], a[112:115], v[28:31], v[208:211]
	v_mfma_f32_16x16x32_bf16 v[212:215], a[116:119], v[28:31], v[212:215]
	v_mfma_f32_16x16x32_bf16 v[216:219], a[120:123], v[28:31], v[216:219]
	v_mfma_f32_16x16x32_bf16 v[220:223], a[124:127], v[28:31], v[220:223]
	v_mfma_f32_16x16x32_bf16 v[40:43], a[64:67], v[112:115], 0
	v_mfma_f32_16x16x32_bf16 v[40:43], a[68:71], v[116:119], v[40:43]
	v_mfma_f32_16x16x32_bf16 v[40:43], a[72:75], v[120:123], v[40:43]
	v_mfma_f32_16x16x32_bf16 v[40:43], a[76:79], v[124:127], v[40:43]
	v_mfma_f32_16x16x32_bf16 v[44:47], a[80:83], v[112:115], 0
	v_mfma_f32_16x16x32_bf16 v[44:47], a[84:87], v[116:119], v[44:47]
	v_mfma_f32_16x16x32_bf16 v[44:47], a[88:91], v[120:123], v[44:47]
	v_mfma_f32_16x16x32_bf16 v[44:47], a[92:95], v[124:127], v[44:47]
	s_nop 3
	v_sub_f32 v40, v40, v39
	v_sub_f32 v41, v41, v39
	v_sub_f32 v42, v42, v39
	v_sub_f32 v43, v43, v39
	v_sub_f32 v44, v44, v39
	v_sub_f32 v45, v45, v39
	v_sub_f32 v46, v46, v39
	v_sub_f32 v47, v47, v39
	v_exp_f32 v40, v40
	v_exp_f32 v41, v41
	v_exp_f32 v42, v42
	v_exp_f32 v43, v43
	v_exp_f32 v44, v44
	v_exp_f32 v45, v45
	v_exp_f32 v46, v46
	v_exp_f32 v47, v47
	v_add_f32 v27, v27, v40
	v_add_f32 v27, v27, v41
	v_add_f32 v27, v27, v42
	v_add_f32 v27, v27, v43
	v_add_f32 v27, v27, v44
	v_add_f32 v27, v27, v45
	v_add_f32 v27, v27, v46
	v_add_f32 v27, v27, v47
	v_cvt_pk_bf16_f32 v28, v40, v41
	v_cvt_pk_bf16_f32 v29, v42, v43
	v_cvt_pk_bf16_f32 v30, v44, v45
	v_cvt_pk_bf16_f32 v31, v46, v47
	s_nop 1
	v_mfma_f32_16x16x32_bf16 v[224:227], a[96:99], v[28:31], v[224:227]
	v_mfma_f32_16x16x32_bf16 v[228:231], a[100:103], v[28:31], v[228:231]
	v_mfma_f32_16x16x32_bf16 v[232:235], a[104:107], v[28:31], v[232:235]
	v_mfma_f32_16x16x32_bf16 v[236:239], a[108:111], v[28:31], v[236:239]
	v_mfma_f32_16x16x32_bf16 v[240:243], a[112:115], v[28:31], v[240:243]
	v_mfma_f32_16x16x32_bf16 v[244:247], a[116:119], v[28:31], v[244:247]
	v_mfma_f32_16x16x32_bf16 v[248:251], a[120:123], v[28:31], v[248:251]
	v_mfma_f32_16x16x32_bf16 v[252:255], a[124:127], v[28:31], v[252:255]
	ds_read_b128 a[64:67], v10 offset:32768
	ds_read_b128 a[68:71], v10 offset:33024
	ds_read_b128 a[72:75], v14 offset:32768
	ds_read_b128 a[76:79], v14 offset:33024
	ds_read_b128 a[80:83], v10 offset:36864
	ds_read_b128 a[84:87], v10 offset:37120
	ds_read_b128 a[88:91], v14 offset:36864
	ds_read_b128 a[92:95], v14 offset:37120
	ds_read_b64_tr_b16 a[96:97], v18 offset:40960
	ds_read_b64_tr_b16 a[98:99], v18 offset:45056
	ds_read_b64_tr_b16 a[100:101], v22 offset:40960
	ds_read_b64_tr_b16 a[102:103], v22 offset:45056
	ds_read_b64_tr_b16 a[104:105], v18 offset:41216
	ds_read_b64_tr_b16 a[106:107], v18 offset:45312
	ds_read_b64_tr_b16 a[108:109], v22 offset:41216
	ds_read_b64_tr_b16 a[110:111], v22 offset:45312
	ds_read_b64_tr_b16 a[112:113], v18 offset:41472
	ds_read_b64_tr_b16 a[114:115], v18 offset:45568
	ds_read_b64_tr_b16 a[116:117], v22 offset:41472
	ds_read_b64_tr_b16 a[118:119], v22 offset:45568
	ds_read_b64_tr_b16 a[120:121], v18 offset:41728
	ds_read_b64_tr_b16 a[122:123], v18 offset:45824
	ds_read_b64_tr_b16 a[124:125], v22 offset:41728
	ds_read_b64_tr_b16 a[126:127], v22 offset:45824
	s_waitcnt lgkmcnt(15)
	v_mfma_f32_16x16x32_bf16 v[40:43], a[64:67], v[64:67], 0
	v_mfma_f32_16x16x32_bf16 v[40:43], a[68:71], v[68:71], v[40:43]
	v_mfma_f32_16x16x32_bf16 v[40:43], a[72:75], v[72:75], v[40:43]
	v_mfma_f32_16x16x32_bf16 v[40:43], a[76:79], v[76:79], v[40:43]
	v_mfma_f32_16x16x32_bf16 v[44:47], a[80:83], v[64:67], 0
	v_mfma_f32_16x16x32_bf16 v[44:47], a[84:87], v[68:71], v[44:47]
	v_mfma_f32_16x16x32_bf16 v[44:47], a[88:91], v[72:75], v[44:47]
	v_mfma_f32_16x16x32_bf16 v[44:47], a[92:95], v[76:79], v[44:47]
	s_nop 3
	v_sub_f32 v40, v40, v36
	v_sub_f32 v41, v41, v36
	v_sub_f32 v42, v42, v36
	v_sub_f32 v43, v43, v36
	v_sub_f32 v44, v44, v36
	v_sub_f32 v45, v45, v36
	v_sub_f32 v46, v46, v36
	v_sub_f32 v47, v47, v36
	v_exp_f32 v40, v40
	v_exp_f32 v41, v41
	v_exp_f32 v42, v42
	v_exp_f32 v43, v43
	v_exp_f32 v44, v44
	v_exp_f32 v45, v45
	v_exp_f32 v46, v46
	v_exp_f32 v47, v47
	v_add_f32 v24, v24, v40
	v_add_f32 v24, v24, v41
	v_add_f32 v24, v24, v42
	v_add_f32 v24, v24, v43
	v_add_f32 v24, v24, v44
	v_add_f32 v24, v24, v45
	v_add_f32 v24, v24, v46
	v_add_f32 v24, v24, v47
	v_cvt_pk_bf16_f32 v28, v40, v41
	v_cvt_pk_bf16_f32 v29, v42, v43
	v_cvt_pk_bf16_f32 v30, v44, v45
	v_cvt_pk_bf16_f32 v31, v46, v47
	s_waitcnt lgkmcnt(14)
	s_nop 0
	v_mfma_f32_16x16x32_bf16 v[128:131], a[96:99], v[28:31], v[128:131]
	s_waitcnt lgkmcnt(12)
	v_mfma_f32_16x16x32_bf16 v[132:135], a[100:103], v[28:31], v[132:135]
	s_waitcnt lgkmcnt(10)
	v_mfma_f32_16x16x32_bf16 v[136:139], a[104:107], v[28:31], v[136:139]
	s_waitcnt lgkmcnt(8)
	v_mfma_f32_16x16x32_bf16 v[140:143], a[108:111], v[28:31], v[140:143]
	s_waitcnt lgkmcnt(6)
	v_mfma_f32_16x16x32_bf16 v[144:147], a[112:115], v[28:31], v[144:147]
	s_waitcnt lgkmcnt(4)
	v_mfma_f32_16x16x32_bf16 v[148:151], a[116:119], v[28:31], v[148:151]
	s_waitcnt lgkmcnt(2)
	v_mfma_f32_16x16x32_bf16 v[152:155], a[120:123], v[28:31], v[152:155]
	s_waitcnt lgkmcnt(0)
	v_mfma_f32_16x16x32_bf16 v[156:159], a[124:127], v[28:31], v[156:159]
	v_mfma_f32_16x16x32_bf16 v[40:43], a[64:67], v[80:83], 0
	v_mfma_f32_16x16x32_bf16 v[40:43], a[68:71], v[84:87], v[40:43]
	v_mfma_f32_16x16x32_bf16 v[40:43], a[72:75], v[88:91], v[40:43]
	v_mfma_f32_16x16x32_bf16 v[40:43], a[76:79], v[92:95], v[40:43]
	v_mfma_f32_16x16x32_bf16 v[44:47], a[80:83], v[80:83], 0
	v_mfma_f32_16x16x32_bf16 v[44:47], a[84:87], v[84:87], v[44:47]
	v_mfma_f32_16x16x32_bf16 v[44:47], a[88:91], v[88:91], v[44:47]
	v_mfma_f32_16x16x32_bf16 v[44:47], a[92:95], v[92:95], v[44:47]
	s_nop 3
	v_sub_f32 v40, v40, v37
	v_sub_f32 v41, v41, v37
	v_sub_f32 v42, v42, v37
	v_sub_f32 v43, v43, v37
	v_sub_f32 v44, v44, v37
	v_sub_f32 v45, v45, v37
	v_sub_f32 v46, v46, v37
	v_sub_f32 v47, v47, v37
	v_exp_f32 v40, v40
	v_exp_f32 v41, v41
	v_exp_f32 v42, v42
	v_exp_f32 v43, v43
	v_exp_f32 v44, v44
	v_exp_f32 v45, v45
	v_exp_f32 v46, v46
	v_exp_f32 v47, v47
	v_add_f32 v25, v25, v40
	v_add_f32 v25, v25, v41
	v_add_f32 v25, v25, v42
	v_add_f32 v25, v25, v43
	v_add_f32 v25, v25, v44
	v_add_f32 v25, v25, v45
	v_add_f32 v25, v25, v46
	v_add_f32 v25, v25, v47
	v_cvt_pk_bf16_f32 v28, v40, v41
	v_cvt_pk_bf16_f32 v29, v42, v43
	v_cvt_pk_bf16_f32 v30, v44, v45
	v_cvt_pk_bf16_f32 v31, v46, v47
	s_nop 1
	v_mfma_f32_16x16x32_bf16 v[160:163], a[96:99], v[28:31], v[160:163]
	v_mfma_f32_16x16x32_bf16 v[164:167], a[100:103], v[28:31], v[164:167]
	v_mfma_f32_16x16x32_bf16 v[168:171], a[104:107], v[28:31], v[168:171]
	v_mfma_f32_16x16x32_bf16 v[172:175], a[108:111], v[28:31], v[172:175]
	v_mfma_f32_16x16x32_bf16 v[176:179], a[112:115], v[28:31], v[176:179]
	v_mfma_f32_16x16x32_bf16 v[180:183], a[116:119], v[28:31], v[180:183]
	v_mfma_f32_16x16x32_bf16 v[184:187], a[120:123], v[28:31], v[184:187]
	v_mfma_f32_16x16x32_bf16 v[188:191], a[124:127], v[28:31], v[188:191]
	v_mfma_f32_16x16x32_bf16 v[40:43], a[64:67], v[96:99], 0
	v_mfma_f32_16x16x32_bf16 v[40:43], a[68:71], v[100:103], v[40:43]
	v_mfma_f32_16x16x32_bf16 v[40:43], a[72:75], v[104:107], v[40:43]
	v_mfma_f32_16x16x32_bf16 v[40:43], a[76:79], v[108:111], v[40:43]
	v_mfma_f32_16x16x32_bf16 v[44:47], a[80:83], v[96:99], 0
	v_mfma_f32_16x16x32_bf16 v[44:47], a[84:87], v[100:103], v[44:47]
	v_mfma_f32_16x16x32_bf16 v[44:47], a[88:91], v[104:107], v[44:47]
	v_mfma_f32_16x16x32_bf16 v[44:47], a[92:95], v[108:111], v[44:47]
	s_nop 3
	v_sub_f32 v40, v40, v38
	v_sub_f32 v41, v41, v38
	v_sub_f32 v42, v42, v38
	v_sub_f32 v43, v43, v38
	v_sub_f32 v44, v44, v38
	v_sub_f32 v45, v45, v38
	v_sub_f32 v46, v46, v38
	v_sub_f32 v47, v47, v38
	v_exp_f32 v40, v40
	v_exp_f32 v41, v41
	v_exp_f32 v42, v42
	v_exp_f32 v43, v43
	v_exp_f32 v44, v44
	v_exp_f32 v45, v45
	v_exp_f32 v46, v46
	v_exp_f32 v47, v47
	v_add_f32 v26, v26, v40
	v_add_f32 v26, v26, v41
	v_add_f32 v26, v26, v42
	v_add_f32 v26, v26, v43
	v_add_f32 v26, v26, v44
	v_add_f32 v26, v26, v45
	v_add_f32 v26, v26, v46
	v_add_f32 v26, v26, v47
	v_cvt_pk_bf16_f32 v28, v40, v41
	v_cvt_pk_bf16_f32 v29, v42, v43
	v_cvt_pk_bf16_f32 v30, v44, v45
	v_cvt_pk_bf16_f32 v31, v46, v47
	s_nop 1
	v_mfma_f32_16x16x32_bf16 v[192:195], a[96:99], v[28:31], v[192:195]
	v_mfma_f32_16x16x32_bf16 v[196:199], a[100:103], v[28:31], v[196:199]
	v_mfma_f32_16x16x32_bf16 v[200:203], a[104:107], v[28:31], v[200:203]
	v_mfma_f32_16x16x32_bf16 v[204:207], a[108:111], v[28:31], v[204:207]
	v_mfma_f32_16x16x32_bf16 v[208:211], a[112:115], v[28:31], v[208:211]
	v_mfma_f32_16x16x32_bf16 v[212:215], a[116:119], v[28:31], v[212:215]
	v_mfma_f32_16x16x32_bf16 v[216:219], a[120:123], v[28:31], v[216:219]
	v_mfma_f32_16x16x32_bf16 v[220:223], a[124:127], v[28:31], v[220:223]
	s_waitcnt lgkmcnt(0)
	s_nop 7
	s_nop 7
	s_barrier
	s_add_u32 s70, s70, 16384
	s_cmp_lt_u32 s70, 0x20000
	s_cbranch_scc1 L_slow2
	v_mov_b32 v40, v24
	s_nop 1
	v_permlane32_swap_b32 v24, v40
	v_add_f32 v24, v24, v40
	v_mov_b32 v40, v24
	s_nop 1
	v_permlane16_swap_b32 v24, v40
	v_add_f32 v24, v24, v40
	v_rcp_f32 v9, v24
	s_nop 0
	v_pk_mul_f32 v[128:129], v[128:129], v[8:9] op_sel:[0,1] op_sel_hi:[1,1]
	v_pk_mul_f32 v[130:131], v[130:131], v[8:9] op_sel:[0,1] op_sel_hi:[1,1]
	v_pk_mul_f32 v[132:133], v[132:133], v[8:9] op_sel:[0,1] op_sel_hi:[1,1]
	v_pk_mul_f32 v[134:135], v[134:135], v[8:9] op_sel:[0,1] op_sel_hi:[1,1]
	v_cvt_pk_bf16_f32 v128, v128, v129
	v_cvt_pk_bf16_f32 v129, v130, v131
	v_cvt_pk_bf16_f32 v130, v132, v133
	v_cvt_pk_bf16_f32 v131, v134, v135
	buffer_store_dwordx4 v[128:131], v2, s[20:23], s52 offen sc1
	v_pk_mul_f32 v[136:137], v[136:137], v[8:9] op_sel:[0,1] op_sel_hi:[1,1]
	v_pk_mul_f32 v[138:139], v[138:139], v[8:9] op_sel:[0,1] op_sel_hi:[1,1]
	v_pk_mul_f32 v[140:141], v[140:141], v[8:9] op_sel:[0,1] op_sel_hi:[1,1]
	v_pk_mul_f32 v[142:143], v[142:143], v[8:9] op_sel:[0,1] op_sel_hi:[1,1]
	v_cvt_pk_bf16_f32 v136, v136, v137
	v_cvt_pk_bf16_f32 v137, v138, v139
	v_cvt_pk_bf16_f32 v138, v140, v141
	v_cvt_pk_bf16_f32 v139, v142, v143
	buffer_store_dwordx4 v[136:139], v2, s[20:23], s52 offen offset:1024 sc1
	v_pk_mul_f32 v[144:145], v[144:145], v[8:9] op_sel:[0,1] op_sel_hi:[1,1]
	v_pk_mul_f32 v[146:147], v[146:147], v[8:9] op_sel:[0,1] op_sel_hi:[1,1]
	v_pk_mul_f32 v[148:149], v[148:149], v[8:9] op_sel:[0,1] op_sel_hi:[1,1]
	v_pk_mul_f32 v[150:151], v[150:151], v[8:9] op_sel:[0,1] op_sel_hi:[1,1]
	v_cvt_pk_bf16_f32 v144, v144, v145
	v_cvt_pk_bf16_f32 v145, v146, v147
	v_cvt_pk_bf16_f32 v146, v148, v149
	v_cvt_pk_bf16_f32 v147, v150, v151
	buffer_store_dwordx4 v[144:147], v2, s[20:23], s52 offen offset:2048 sc1
	v_pk_mul_f32 v[152:153], v[152:153], v[8:9] op_sel:[0,1] op_sel_hi:[1,1]
	v_pk_mul_f32 v[154:155], v[154:155], v[8:9] op_sel:[0,1] op_sel_hi:[1,1]
	v_pk_mul_f32 v[156:157], v[156:157], v[8:9] op_sel:[0,1] op_sel_hi:[1,1]
	v_pk_mul_f32 v[158:159], v[158:159], v[8:9] op_sel:[0,1] op_sel_hi:[1,1]
	v_cvt_pk_bf16_f32 v152, v152, v153
	v_cvt_pk_bf16_f32 v153, v154, v155
	v_cvt_pk_bf16_f32 v154, v156, v157
	v_cvt_pk_bf16_f32 v155, v158, v159
	buffer_store_dwordx4 v[152:155], v2, s[20:23], s52 offen offset:3072 sc1
	v_mov_b32 v40, v25
	s_nop 1
	v_permlane32_swap_b32 v25, v40
	v_add_f32 v25, v25, v40
	v_mov_b32 v40, v25
	s_nop 1
	v_permlane16_swap_b32 v25, v40
	v_add_f32 v25, v25, v40
	v_rcp_f32 v11, v25
	s_nop 0
	v_pk_mul_f32 v[160:161], v[160:161], v[10:11] op_sel:[0,1] op_sel_hi:[1,1]
	v_pk_mul_f32 v[162:163], v[162:163], v[10:11] op_sel:[0,1] op_sel_hi:[1,1]
	v_pk_mul_f32 v[164:165], v[164:165], v[10:11] op_sel:[0,1] op_sel_hi:[1,1]
	v_pk_mul_f32 v[166:167], v[166:167], v[10:11] op_sel:[0,1] op_sel_hi:[1,1]
	v_cvt_pk_bf16_f32 v160, v160, v161
	v_cvt_pk_bf16_f32 v161, v162, v163
	v_cvt_pk_bf16_f32 v162, v164, v165
	v_cvt_pk_bf16_f32 v163, v166, v167
	buffer_store_dwordx4 v[160:163], v2, s[20:23], s53 offen sc1
	v_pk_mul_f32 v[168:169], v[168:169], v[10:11] op_sel:[0,1] op_sel_hi:[1,1]
	v_pk_mul_f32 v[170:171], v[170:171], v[10:11] op_sel:[0,1] op_sel_hi:[1,1]
	v_pk_mul_f32 v[172:173], v[172:173], v[10:11] op_sel:[0,1] op_sel_hi:[1,1]
	v_pk_mul_f32 v[174:175], v[174:175], v[10:11] op_sel:[0,1] op_sel_hi:[1,1]
	v_cvt_pk_bf16_f32 v168, v168, v169
	v_cvt_pk_bf16_f32 v169, v170, v171
	v_cvt_pk_bf16_f32 v170, v172, v173
	v_cvt_pk_bf16_f32 v171, v174, v175
	buffer_store_dwordx4 v[168:171], v2, s[20:23], s53 offen offset:1024 sc1
	v_pk_mul_f32 v[176:177], v[176:177], v[10:11] op_sel:[0,1] op_sel_hi:[1,1]
	v_pk_mul_f32 v[178:179], v[178:179], v[10:11] op_sel:[0,1] op_sel_hi:[1,1]
	v_pk_mul_f32 v[180:181], v[180:181], v[10:11] op_sel:[0,1] op_sel_hi:[1,1]
	v_pk_mul_f32 v[182:183], v[182:183], v[10:11] op_sel:[0,1] op_sel_hi:[1,1]
	v_cvt_pk_bf16_f32 v176, v176, v177
	v_cvt_pk_bf16_f32 v177, v178, v179
	v_cvt_pk_bf16_f32 v178, v180, v181
	v_cvt_pk_bf16_f32 v179, v182, v183
	buffer_store_dwordx4 v[176:179], v2, s[20:23], s53 offen offset:2048 sc1
	v_pk_mul_f32 v[184:185], v[184:185], v[10:11] op_sel:[0,1] op_sel_hi:[1,1]
	v_pk_mul_f32 v[186:187], v[186:187], v[10:11] op_sel:[0,1] op_sel_hi:[1,1]
	v_pk_mul_f32 v[188:189], v[188:189], v[10:11] op_sel:[0,1] op_sel_hi:[1,1]
	v_pk_mul_f32 v[190:191], v[190:191], v[10:11] op_sel:[0,1] op_sel_hi:[1,1]
	v_cvt_pk_bf16_f32 v184, v184, v185
	v_cvt_pk_bf16_f32 v185, v186, v187
	v_cvt_pk_bf16_f32 v186, v188, v189
	v_cvt_pk_bf16_f32 v187, v190, v191
	buffer_store_dwordx4 v[184:187], v2, s[20:23], s53 offen offset:3072 sc1
	s_add_u32 m0, s62, 32768
	s_add_u32 s50, s6, 0
	buffer_load_dwordx4 v5, s[24:27], s50 offen lds
	s_add_u32 m0, s62, 33792
	s_add_u32 s50, s6, 9216
	buffer_load_dwordx4 v5, s[24:27], s50 offen lds
	s_add_u32 m0, s62, 34816
	s_add_u32 s50, s6, 18432
	buffer_load_dwordx4 v5, s[24:27], s50 offen lds
	s_add_u32 m0, s62, 35840
	s_add_u32 s50, s6, 27648
	buffer_load_dwordx4 v5, s[24:27], s50 offen lds
	s_add_u32 m0, s62, 36864
	s_add_u32 s50, s6, 36864
	buffer_load_dwordx4 v5, s[24:27], s50 offen lds
	s_add_u32 m0, s62, 37888
	s_add_u32 s50, s6, 46080
	buffer_load_dwordx4 v5, s[24:27], s50 offen lds
	s_add_u32 m0, s62, 38912
	s_add_u32 s50, s6, 55296
	buffer_load_dwordx4 v5, s[24:27], s50 offen lds
	s_add_u32 m0, s62, 39936
	s_add_u32 s50, s6, 64512
	buffer_load_dwordx4 v5, s[24:27], s50 offen lds
	s_waitcnt vmcnt(4)
	ds_read_b64_tr_b16 v[128:129], v21 offset:32768
	ds_read_b64_tr_b16 v[130:131], v21 offset:34816
	ds_read_b64_tr_b16 v[132:133], v23 offset:32768
	ds_read_b64_tr_b16 v[134:135], v23 offset:34816
	ds_read_b64_tr_b16 v[136:137], v21 offset:33280
	ds_read_b64_tr_b16 v[138:139], v21 offset:35328
	ds_read_b64_tr_b16 v[140:141], v23 offset:33280
	ds_read_b64_tr_b16 v[142:143], v23 offset:35328
	s_waitcnt vmcnt(0)
	ds_read_b64_tr_b16 v[144:145], v21 offset:36864
	ds_read_b64_tr_b16 v[146:147], v21 offset:38912
	ds_read_b64_tr_b16 v[148:149], v23 offset:36864
	ds_read_b64_tr_b16 v[150:151], v23 offset:38912
	ds_read_b64_tr_b16 v[152:153], v21 offset:37376
	ds_read_b64_tr_b16 v[154:155], v21 offset:39424
	ds_read_b64_tr_b16 v[156:157], v23 offset:37376
	ds_read_b64_tr_b16 v[158:159], v23 offset:39424
	s_waitcnt vmcnt(0) lgkmcnt(0)
	s_barrier
	s_cmp_eq_u32 s41, 1
	s_cbranch_scc1 L_xw1b
	ds_write_b128 v17, v[240:243] offset:0
	ds_write_b128 v17, v[244:247] offset:1024
	ds_write_b128 v17, v[248:251] offset:2048
	ds_write_b128 v17, v[252:255] offset:3072
	s_branch L_xwdb
L_xw1b:
	ds_write_b128 v17, v[224:227] offset:0
	ds_write_b128 v17, v[228:231] offset:1024
	ds_write_b128 v17, v[232:235] offset:2048
	ds_write_b128 v17, v[236:239] offset:3072
L_xwdb:
	ds_write_b32 v17, v27 offset:4096
	s_nop 7
	s_branch L_epi
.fill 8192, 4, 0xbf800000
.section .rodata,"a"
.p2align 6
.amdhsa_kernel standalone__mha_block_cached__near_ridge_kernel
  .amdhsa_next_free_vgpr 512
  .amdhsa_next_free_sgpr 102
  .amdhsa_accum_offset 256
  .amdhsa_group_segment_fixed_size 0
  .amdhsa_kernarg_size 64
  .amdhsa_user_sgpr_count 2
  .amdhsa_user_sgpr_kernarg_segment_ptr 1
  .amdhsa_system_sgpr_workgroup_id_x 1
  .amdhsa_float_denorm_mode_32 3
.end_amdhsa_kernel
```
